```python
import torch

def _softmax(x, axis=-1):
    return torch.softmax(x, dim=axis)
def _gelu(x):
    return torch.nn.functional.gelu(x, approximate="tanh")
def _silu(x):
    return torch.nn.functional.silu(x)
def _sigmoid(x):
    return torch.sigmoid(x)
def _layernorm(x, axis=-1, eps=1e-5):
    m = x.mean(dim=axis, keepdim=True)
    v = x.var(dim=axis, keepdim=True, unbiased=False)
    return (x - m) / torch.sqrt(v + eps)
def _scatter_add(tgt, idx, src, axis=0):
    return tgt.clone().index_add_(axis, idx, src)
def _segment_sum(src, seg, n):
    out = torch.zeros((n,) + src.shape[1:], dtype=src.dtype)
    return out.index_add_(0, seg, src)
def _pad(x, pw):
    flat = tuple(v for pair in reversed(pw) for v in pair)
    return torch.nn.functional.pad(x, flat)

kernel_name = 'sequential_preLN__mha_block__swiglu_ffn__prompt'

def setup_inputs():

    _w = (lambda a: (lambda t: t.to(torch.bfloat16) if t.is_floating_point() else t)(torch.as_tensor(a)))
    def _A_setup():
        B, S, D, H = 1, 2048, 1024, 32
        return {
            "x": _w((lambda *s: torch.randn(*s, dtype=torch.bfloat16) * 0.05)(B, S, D)),
            "wqkv": _w((lambda *s: torch.randn(*s, dtype=torch.bfloat16) * 0.05)(D, 3 * D)),
            "wo": _w((lambda *s: torch.randn(*s, dtype=torch.bfloat16) * 0.05)(D, D)),
        }
    _A_in = _A_setup()

    def _B_setup():
        B, S, D, F = 1, 2048, 1024, 3584
        return {
            "x": _w((lambda *s: torch.randn(*s, dtype=torch.bfloat16) * 0.05)(B, S, D)),
            "w_gate": _w((lambda *s: torch.randn(*s, dtype=torch.bfloat16) * 0.05)(D, F)),
            "w_up": _w((lambda *s: torch.randn(*s, dtype=torch.bfloat16) * 0.05)(D, F)),
            "w_down": _w((lambda *s: torch.randn(*s, dtype=torch.bfloat16) * 0.05)(F, D)),
        }
    _B_in = _B_setup()

    return {
        "A_x": _A_in["x"],
        "A_wqkv": _A_in["wqkv"],
        "A_wo": _A_in["wo"],
        "B_x": _B_in["x"],
        "B_w_gate": _B_in["w_gate"],
        "B_w_up": _B_in["w_up"],
        "B_w_down": _B_in["w_down"],
    }

def reference(A_x, A_wqkv, A_wo, B_x, B_w_gate, B_w_up, B_w_down):
    def _A_ref(x, wqkv, wo):
        B, S, D = x.shape
        H = 32
        Dh = D // H
        qkv = (lambda x, *d: x.permute(*d))((x @ wqkv).reshape(B, S, 3, H, Dh), 2, 0, 3, 1, 4)
        q, k, v = qkv[0], qkv[1], qkv[2]
        scores = torch.einsum("bhqd,bhkd->bhqk", q, k) * (Dh ** -0.5)
        p = _softmax(scores, axis=-1)
        o = torch.einsum("bhqk,bhkd->bhqd", p, v)
        return (lambda x, *d: x.permute(*d))(o, 0, 2, 1, 3).reshape(B, S, D) @ wo

    def _B_ref(x, w_gate, w_up, w_down):
        g = _silu(x @ w_gate)
        u = x @ w_up
        return (g * u) @ w_down

    x = A_x
    h = x + _A_ref(_layernorm(x, axis=-1), A_wqkv, A_wo)
    h2 = h + _B_ref(_layernorm(h, axis=-1), B_w_gate, B_w_up, B_w_down)
    return h2
```

```asm
; @launch kernel=qkv_kernel grid=(256,1,1) block=(512,1,1) lds=163840
.amdgcn_target "amdgcn-amd-amdhsa--gfx950"
.text
.globl qkv_kernel
.p2align 8
.type qkv_kernel,@function
qkv_kernel:
    s_cmp_ge_u32 s2, 256
    s_cbranch_scc1 qkv_kernel_end
    s_load_dwordx2 s[24:25], s[0:1], 0
    s_load_dwordx2 s[4:5], s[0:1], 8
    s_load_dwordx2 s[6:7], s[0:1], 72
    s_load_dwordx2 s[26:27], s[0:1], 64
    s_load_dwordx2 s[28:29], s[0:1], 16
    s_load_dwordx16 s[68:83], s[0:1], 0
    s_load_dwordx4 s[84:87], s[0:1], 64
    v_lshrrev_b32 v1, 6, v0
    v_and_b32 v0, 63, v0
    v_readfirstlane_b32 s3, v1
    s_and_b32 s90, s2, 7
    s_lshr_b32 s91, s2, 3
    s_mov_b32 s93, s3
    s_lshr_b32 s30, s90, 1
    s_lshl_b32 s30, s30, 2
    s_lshr_b32 s92, s91, 3
    s_add_u32 s30, s30, s92
    s_and_b32 s31, s90, 1
    s_lshl_b32 s31, s31, 3
    s_and_b32 s92, s91, 7
    s_add_u32 s31, s31, s92
    s_mul_i32 s59, s30, 5
    s_mul_i32 s58, s31, 9
    s_add_u32 s59, s59, s58
    s_and_b32 s59, s59, 15
    s_add_u32 s52, s31, 2
    s_and_b32 s52, s52, 15
    s_add_u32 s53, s31, 4
    s_and_b32 s53, s53, 15
    s_mul_i32 s55, s90, 0
    s_sub_u32 s54, s59, s55
    s_and_b32 s54, s54, 15
    s_cmp_ge_u32 s3, 4
    s_cbranch_scc0 qkv_comp
    s_sub_u32 s3, s3, 4
    s_lshl_b32 s32, s30, 2
    s_add_u32 s32, s32, s3
    s_lshl_b32 s33, s32, 16
    v_lshrrev_b32 v1, 3, v0
    v_lshlrev_b32 v1, 11, v1
    v_lshrrev_b32 v2, 4, v0
    v_and_b32 v3, 7, v0
    v_xor_b32 v2, v2, v3
    v_lshlrev_b32 v2, 4, v2
    v_add3_u32 v8, s33, v1, v2
    v_xor_b32 v9, 64, v8
    v_add_u32 v9, 16384, v9
    v_add_u32 v10, 32768, v8
    v_add_u32 v11, 32768, v9
    v_lshrrev_b32 v3, 5, v0
    v_lshlrev_b32 v3, 2, v3
    v_bfe_u32 v4, v0, 2, 2
    v_add_u32 v3, v3, v4
    s_mov_b32 s92, 6144
    v_mul_lo_u32 v2, v3, s92
    v_bfe_u32 v3, v0, 4, 1
    v_lshlrev_b32 v3, 6, v3
    v_and_b32 v4, 3, v0
    v_lshlrev_b32 v4, 4, v4
    v_add3_u32 v2, v2, v3, v4
    s_mul_i32 s33, s3, 16*6144
    s_lshl_b32 s34, s31, 7
    s_add_u32 s34, s33, s34
    v_add_u32 v12, s34, v2
    s_add_u32 s33, s33, 2048
    s_lshl_b32 s34, s52, 7
    s_add_u32 s34, s33, s34
    v_add_u32 v13, s34, v2
    s_add_u32 s33, s33, 2048
    s_lshl_b32 s34, s53, 7
    s_add_u32 s34, s33, s34
    v_add_u32 v14, s34, v2
qkv_g0:
    v_add_u32 v15, 49152, v12
    v_add_u32 v16, 49152, v13
    v_add_u32 v17, 49152, v14
    s_mov_b32 s58, 0
    s_lshl_b32 s40, s59, 7
    s_mul_i32 s41, s59, 393216
    s_lshl_b32 s42, s3, 12
    s_mul_i32 s43, s3, 6144
    s_add_u32 s43, s43, 16384
    s_mov_b32 s62, 0
    s_waitcnt lgkmcnt(0)
    s_mov_b32 s8, s24
    s_mov_b32 s9, s25
    s_mov_b32 s10, 0x400000
    s_mov_b32 s11, 0x00020000
    s_mov_b32 s12, s4
    s_mov_b32 s13, s5
    s_mov_b32 s14, 0x600000
    s_mov_b32 s15, 0x00020000
    s_mov_b32 s64, 40960
    s_mov_b32 s65, -122880
    s_add_u32 m0, s42, 0
    s_nop 0
    buffer_load_dwordx4 v8, s[8:11], s40 offen lds
    s_add_u32 m0, s42, 1024
    s_nop 0
    buffer_load_dwordx4 v9, s[8:11], s40 offen lds
    s_add_u32 m0, s42, 2048
    s_nop 0
    buffer_load_dwordx4 v10, s[8:11], s40 offen lds
    s_add_u32 m0, s42, 3072
    s_nop 0
    buffer_load_dwordx4 v11, s[8:11], s40 offen lds
    s_add_u32 m0, s43, 0
    s_nop 0
    buffer_load_dwordx4 v12, s[12:15], s41 offen lds
    s_add_u32 m0, s43, 1024
    s_nop 0
    buffer_load_dwordx4 v13, s[12:15], s41 offen lds
    s_add_u32 m0, s43, 2048
    s_nop 0
    buffer_load_dwordx4 v14, s[12:15], s41 offen lds
    s_add_u32 m0, s43, 3072
    s_nop 0
    buffer_load_dwordx4 v15, s[12:15], s41 offen lds
    s_add_u32 m0, s43, 4096
    s_nop 0
    buffer_load_dwordx4 v16, s[12:15], s41 offen lds
    s_add_u32 m0, s43, 5120
    s_nop 0
    buffer_load_dwordx4 v17, s[12:15], s41 offen lds
    s_add_u32 s58, s58, 1
    s_add_u32 s56, s58, s59
    s_and_b32 s56, s56, 15
    s_andn2_b32 s57, s58, 15
    s_or_b32 s56, s56, s57
    s_lshl_b32 s40, s56, 7
    s_mul_i32 s41, s56, 393216
    s_add_u32 s62, s62, 1
    s_cmp_ge_u32 s62, 4
    s_cselect_b32 s62, 0, s62
    s_cselect_b32 s63, s65, s64
    s_add_u32 s42, s42, s63
    s_add_u32 s43, s43, s63
    s_add_u32 m0, s42, 0
    s_nop 0
    buffer_load_dwordx4 v8, s[8:11], s40 offen lds
    s_add_u32 m0, s42, 1024
    s_nop 0
    buffer_load_dwordx4 v9, s[8:11], s40 offen lds
    s_add_u32 m0, s42, 2048
    s_nop 0
    buffer_load_dwordx4 v10, s[8:11], s40 offen lds
    s_add_u32 m0, s42, 3072
    s_nop 0
    buffer_load_dwordx4 v11, s[8:11], s40 offen lds
    s_add_u32 m0, s43, 0
    s_nop 0
    buffer_load_dwordx4 v12, s[12:15], s41 offen lds
    s_add_u32 m0, s43, 1024
    s_nop 0
    buffer_load_dwordx4 v13, s[12:15], s41 offen lds
    s_add_u32 m0, s43, 2048
    s_nop 0
    buffer_load_dwordx4 v14, s[12:15], s41 offen lds
    s_add_u32 m0, s43, 3072
    s_nop 0
    buffer_load_dwordx4 v15, s[12:15], s41 offen lds
    s_add_u32 m0, s43, 4096
    s_nop 0
    buffer_load_dwordx4 v16, s[12:15], s41 offen lds
    s_add_u32 m0, s43, 5120
    s_nop 0
    buffer_load_dwordx4 v17, s[12:15], s41 offen lds
    s_add_u32 s58, s58, 1
    s_add_u32 s56, s58, s59
    s_and_b32 s56, s56, 15
    s_andn2_b32 s57, s58, 15
    s_or_b32 s56, s56, s57
    s_lshl_b32 s40, s56, 7
    s_mul_i32 s41, s56, 393216
    s_add_u32 s62, s62, 1
    s_cmp_ge_u32 s62, 4
    s_cselect_b32 s62, 0, s62
    s_cselect_b32 s63, s65, s64
    s_add_u32 s42, s42, s63
    s_add_u32 s43, s43, s63
    s_mov_b32 s16, s6
    s_mov_b32 s17, s7
    s_mov_b32 s18, 0x80000
    s_mov_b32 s19, 0x00020000
    s_mov_b32 s20, s26
    s_mov_b32 s21, s27
    s_mov_b32 s22, 0x100
    s_mov_b32 s23, 0x00020000
    s_mov_b32 s44, s28
    s_mov_b32 s45, s29
    s_mov_b32 s46, 0x200000
    s_mov_b32 s47, 0x00020000
    s_add_u32 s48, s6, 0x2900000
    s_addc_u32 s49, s7, 0
    s_mov_b32 s50, 0x8000
    s_mov_b32 s51, 0x00020000
    v_lshlrev_b32 v20, 4, v0
    s_lshl_b32 s33, s3, 12
    v_add_u32 v1, s33, v20
    v_lshrrev_b32 v2, 2, v0
    v_cmp_eq_u32 vcc, s30, v2
    s_nop 1
    v_cndmask_b32 v21, 0, 15, vcc
    s_lshr_b32 s34, s31, 2
    s_and_b32 s35, s31, 3
    s_lshl_b32 s35, 1, s35
    v_and_b32 v2, 3, v0
    v_mov_b32 v3, s35
    v_cmp_eq_u32 vcc, s34, v2
    s_nop 1
    v_cndmask_b32 v3, 0, v3, vcc
    v_mov_b32 v21, 15
    v_lshlrev_b32 v2, 6, v2
    v_lshrrev_b32 v3, 3, v0
    v_lshlrev_b32 v3, 3, v3
    v_and_b32 v22, 4, v0
    v_add3_u32 v22, v22, v2, v3
    s_lshl_b32 s36, s32, 12
    s_lshl_b32 s37, s59, 8
    s_add_u32 s37, s37, s36
    s_lshl_b32 s38, s31, 2
    s_add_u32 s38, s38, s3
    s_lshl_b32 s38, s38, 12
    s_add_u32 s38, s38, 262144
    s_cmp_eq_u32 s3, 3
    s_cselect_b32 s38, 1073741824, s38
    s_waitcnt vmcnt(10)
    ds_read_b128 v[24:27], v1 offset:0
    ds_read_b128 v[28:31], v1 offset:1024
    ds_read_b128 v[32:35], v1 offset:2048
    ds_read_b128 v[36:39], v1 offset:3072
    s_barrier
qkv_g1:
padc0:
    s_cbranch_execz pad0_1
    s_add_u32 m0, s42, 0
    s_nop 0
    buffer_load_dwordx4 v8, s[8:11], s40 offen lds
    s_add_u32 m0, s42, 1024
    s_nop 0
    buffer_load_dwordx4 v9, s[8:11], s40 offen lds
    s_add_u32 m0, s42, 2048
    s_nop 0
    buffer_load_dwordx4 v10, s[8:11], s40 offen lds
    s_add_u32 m0, s42, 3072
    s_nop 0
    buffer_load_dwordx4 v11, s[8:11], s40 offen lds
    s_add_u32 m0, s43, 0
    s_nop 0
    buffer_load_dwordx4 v12, s[12:15], s41 offen lds
    s_add_u32 m0, s43, 1024
    s_nop 0
    buffer_load_dwordx4 v13, s[12:15], s41 offen lds
    s_add_u32 m0, s43, 2048
    s_nop 0
    buffer_load_dwordx4 v14, s[12:15], s41 offen lds
    s_add_u32 m0, s43, 3072
    s_nop 0
    buffer_load_dwordx4 v15, s[12:15], s41 offen lds
    s_add_u32 m0, s43, 4096
    s_nop 0
    buffer_load_dwordx4 v16, s[12:15], s41 offen lds
    s_add_u32 m0, s43, 5120
    s_nop 0
    buffer_load_dwordx4 v17, s[12:15], s41 offen lds
    s_add_u32 s58, s58, 1
    s_add_u32 s56, s58, s59
    s_and_b32 s56, s56, 15
    s_andn2_b32 s57, s58, 15
    s_or_b32 s56, s56, s57
    s_lshl_b32 s40, s56, 7
    s_mul_i32 s41, s56, 393216
    s_add_u32 s62, s62, 1
    s_cmp_ge_u32 s62, 4
    s_cselect_b32 s62, 0, s62
    s_cselect_b32 s63, s65, s64
    s_add_u32 s42, s42, s63
    s_add_u32 s43, s43, s63
    s_waitcnt lgkmcnt(0)
    v_lshlrev_b32 v48, 16, v24
    v_and_b32 v49, 0xffff0000, v24
    v_lshlrev_b32 v50, 16, v28
    v_and_b32 v51, 0xffff0000, v28
    v_lshlrev_b32 v52, 16, v32
    v_and_b32 v53, 0xffff0000, v32
    v_lshlrev_b32 v54, 16, v36
    v_and_b32 v55, 0xffff0000, v36
    v_add_f32 v40, v48, v49
    v_mul_f32 v44, v48, v48
    v_add_f32 v41, v50, v51
    v_mul_f32 v45, v50, v50
    v_add_f32 v42, v52, v53
    v_mul_f32 v46, v52, v52
    v_add_f32 v43, v54, v55
    v_mul_f32 v47, v54, v54
    v_fmac_f32 v44, v49, v49
    v_fmac_f32 v45, v51, v51
    v_fmac_f32 v46, v53, v53
    v_fmac_f32 v47, v55, v55
    v_lshlrev_b32 v48, 16, v25
    v_and_b32 v49, 0xffff0000, v25
    v_lshlrev_b32 v50, 16, v29
    v_and_b32 v51, 0xffff0000, v29
    v_lshlrev_b32 v52, 16, v33
    v_and_b32 v53, 0xffff0000, v33
    v_lshlrev_b32 v54, 16, v37
    v_and_b32 v55, 0xffff0000, v37
    v_add_f32 v40, v40, v48
    v_fmac_f32 v44, v48, v48
    v_add_f32 v41, v41, v50
    v_fmac_f32 v45, v50, v50
    v_add_f32 v42, v42, v52
    v_fmac_f32 v46, v52, v52
    v_add_f32 v43, v43, v54
    v_fmac_f32 v47, v54, v54
    v_add_f32 v40, v40, v49
    v_fmac_f32 v44, v49, v49
    v_add_f32 v41, v41, v51
    v_fmac_f32 v45, v51, v51
    v_add_f32 v42, v42, v53
pad0_1:
    s_cbranch_execz pad0_2
    v_fmac_f32 v46, v53, v53
    v_add_f32 v43, v43, v55
    v_fmac_f32 v47, v55, v55
    v_lshlrev_b32 v48, 16, v26
    v_and_b32 v49, 0xffff0000, v26
    v_lshlrev_b32 v50, 16, v30
    v_and_b32 v51, 0xffff0000, v30
    v_lshlrev_b32 v52, 16, v34
    v_and_b32 v53, 0xffff0000, v34
    v_lshlrev_b32 v54, 16, v38
    v_and_b32 v55, 0xffff0000, v38
    v_add_f32 v40, v40, v48
    v_fmac_f32 v44, v48, v48
    v_add_f32 v41, v41, v50
    v_fmac_f32 v45, v50, v50
    v_add_f32 v42, v42, v52
    v_fmac_f32 v46, v52, v52
    v_add_f32 v43, v43, v54
    v_fmac_f32 v47, v54, v54
    v_add_f32 v40, v40, v49
    v_fmac_f32 v44, v49, v49
    v_add_f32 v41, v41, v51
    v_fmac_f32 v45, v51, v51
    v_add_f32 v42, v42, v53
    v_fmac_f32 v46, v53, v53
    v_add_f32 v43, v43, v55
    v_fmac_f32 v47, v55, v55
    v_lshlrev_b32 v48, 16, v27
    v_and_b32 v49, 0xffff0000, v27
    v_lshlrev_b32 v50, 16, v31
    v_and_b32 v51, 0xffff0000, v31
    v_lshlrev_b32 v52, 16, v35
    v_and_b32 v53, 0xffff0000, v35
    v_lshlrev_b32 v54, 16, v39
    v_and_b32 v55, 0xffff0000, v39
    v_add_f32 v40, v40, v48
    v_fmac_f32 v44, v48, v48
    v_add_f32 v41, v41, v50
    v_fmac_f32 v45, v50, v50
    v_add_f32 v42, v42, v52
    v_fmac_f32 v46, v52, v52
    v_add_f32 v43, v43, v54
    v_fmac_f32 v47, v54, v54
    v_add_f32 v40, v40, v49
    v_fmac_f32 v44, v49, v49
    v_add_f32 v41, v41, v51
    v_fmac_f32 v45, v51, v51
    v_add_f32 v42, v42, v53
    v_fmac_f32 v46, v53, v53
    v_add_f32 v43, v43, v55
    v_fmac_f32 v47, v55, v55
    v_add_f32_dpp v40, v40, v40 quad_perm:[1,0,3,2] row_mask:0xf bank_mask:0xf
    v_add_f32_dpp v41, v41, v41 quad_perm:[1,0,3,2] row_mask:0xf bank_mask:0xf
    v_add_f32_dpp v42, v42, v42 quad_perm:[1,0,3,2] row_mask:0xf bank_mask:0xf
    v_add_f32_dpp v43, v43, v43 quad_perm:[1,0,3,2] row_mask:0xf bank_mask:0xf
    v_add_f32_dpp v44, v44, v44 quad_perm:[1,0,3,2] row_mask:0xf bank_mask:0xf
    v_add_f32_dpp v45, v45, v45 quad_perm:[1,0,3,2] row_mask:0xf bank_mask:0xf
    v_add_f32_dpp v46, v46, v46 quad_perm:[1,0,3,2] row_mask:0xf bank_mask:0xf
    v_add_f32_dpp v47, v47, v47 quad_perm:[1,0,3,2] row_mask:0xf bank_mask:0xf
    v_add_f32_dpp v40, v40, v40 quad_perm:[2,3,0,1] row_mask:0xf bank_mask:0xf
    v_add_f32_dpp v41, v41, v41 quad_perm:[2,3,0,1] row_mask:0xf bank_mask:0xf
    v_add_f32_dpp v42, v42, v42 quad_perm:[2,3,0,1] row_mask:0xf bank_mask:0xf
    v_add_f32_dpp v43, v43, v43 quad_perm:[2,3,0,1] row_mask:0xf bank_mask:0xf
    v_add_f32_dpp v44, v44, v44 quad_perm:[2,3,0,1] row_mask:0xf bank_mask:0xf
    v_add_f32_dpp v45, v45, v45 quad_perm:[2,3,0,1] row_mask:0xf bank_mask:0xf
    v_add_f32_dpp v46, v46, v46 quad_perm:[2,3,0,1] row_mask:0xf bank_mask:0xf
    v_add_f32_dpp v47, v47, v47 quad_perm:[2,3,0,1] row_mask:0xf bank_mask:0xf
    v_add_f32_dpp v40, v40, v40 row_half_mirror row_mask:0xf bank_mask:0xf
    v_add_f32_dpp v41, v41, v41 row_half_mirror row_mask:0xf bank_mask:0xf
    v_add_f32_dpp v42, v42, v42 row_half_mirror row_mask:0xf bank_mask:0xf
    v_add_f32_dpp v43, v43, v43 row_half_mirror row_mask:0xf bank_mask:0xf
    v_add_f32_dpp v44, v44, v44 row_half_mirror row_mask:0xf bank_mask:0xf
    v_add_f32_dpp v45, v45, v45 row_half_mirror row_mask:0xf bank_mask:0xf
    v_add_f32_dpp v46, v46, v46 row_half_mirror row_mask:0xf bank_mask:0xf
    v_add_f32_dpp v47, v47, v47 row_half_mirror row_mask:0xf bank_mask:0xf
    v_and_b32 v2, 7, v0
    v_cmp_eq_u32 vcc, 1, v2
    s_nop 1
    v_cndmask_b32 v40, v40, v41, vcc
    v_cmp_eq_u32 vcc, 2, v2
    s_nop 1
    v_cndmask_b32 v40, v40, v42, vcc
    v_cmp_eq_u32 vcc, 3, v2
    s_nop 1
    v_cndmask_b32 v40, v40, v43, vcc
    v_cmp_eq_u32 vcc, 4, v2
    s_nop 1
    v_cndmask_b32 v40, v40, v44, vcc
    v_cmp_eq_u32 vcc, 5, v2
    s_nop 1
    v_cndmask_b32 v40, v40, v45, vcc
    v_cmp_eq_u32 vcc, 6, v2
    s_nop 1
    v_cndmask_b32 v40, v40, v46, vcc
    v_cmp_eq_u32 vcc, 7, v2
pad0_2:
    s_cbranch_execz pad0_3
    s_nop 1
    v_cndmask_b32 v40, v40, v47, vcc
    buffer_store_dword v40, v22, s[16:19], s37 offen sc1
    s_waitcnt vmcnt(11)
    s_barrier
    s_add_u32 m0, s42, 0
    s_nop 0
    buffer_load_dwordx4 v8, s[8:11], s40 offen lds
    s_add_u32 m0, s42, 1024
    s_nop 0
    buffer_load_dwordx4 v9, s[8:11], s40 offen lds
    s_add_u32 m0, s42, 2048
    s_nop 0
    buffer_load_dwordx4 v10, s[8:11], s40 offen lds
    s_add_u32 m0, s42, 3072
    s_nop 0
    buffer_load_dwordx4 v11, s[8:11], s40 offen lds
    s_add_u32 m0, s43, 0
    s_nop 0
    buffer_load_dwordx4 v12, s[12:15], s41 offen lds
    s_add_u32 m0, s43, 1024
    s_nop 0
    buffer_load_dwordx4 v13, s[12:15], s41 offen lds
    s_add_u32 m0, s43, 2048
    s_nop 0
    buffer_load_dwordx4 v14, s[12:15], s41 offen lds
    s_add_u32 m0, s43, 3072
    s_nop 0
    buffer_load_dwordx4 v15, s[12:15], s41 offen lds
    s_add_u32 m0, s43, 4096
    s_nop 0
    buffer_load_dwordx4 v16, s[12:15], s41 offen lds
    s_add_u32 m0, s43, 5120
    s_nop 0
    buffer_load_dwordx4 v17, s[12:15], s41 offen lds
    s_add_u32 s58, s58, 1
    s_add_u32 s56, s58, s59
    s_and_b32 s56, s56, 15
    s_andn2_b32 s57, s58, 15
    s_or_b32 s56, s56, s57
    s_lshl_b32 s40, s56, 7
    s_mul_i32 s41, s56, 393216
    s_add_u32 s62, s62, 1
    s_cmp_ge_u32 s62, 4
    s_cselect_b32 s62, 0, s62
    s_cselect_b32 s63, s65, s64
    s_add_u32 s42, s42, s63
    s_add_u32 s43, s43, s63
    s_add_u32 m0, s42, 0
    s_nop 0
    buffer_load_dwordx4 v8, s[8:11], s40 offen lds
    s_add_u32 m0, s42, 1024
    s_nop 0
    buffer_load_dwordx4 v9, s[8:11], s40 offen lds
    s_add_u32 m0, s42, 2048
    s_nop 0
    buffer_load_dwordx4 v10, s[8:11], s40 offen lds
    s_add_u32 m0, s42, 3072
    s_nop 0
    buffer_load_dwordx4 v11, s[8:11], s40 offen lds
    s_add_u32 m0, s43, 0
    s_nop 0
    buffer_load_dwordx4 v12, s[12:15], s41 offen lds
    s_add_u32 m0, s43, 1024
    s_nop 0
    buffer_load_dwordx4 v13, s[12:15], s41 offen lds
    s_add_u32 m0, s43, 2048
    s_nop 0
    buffer_load_dwordx4 v14, s[12:15], s41 offen lds
    s_add_u32 m0, s43, 3072
    s_nop 0
    buffer_load_dwordx4 v15, s[12:15], s41 offen lds
    s_add_u32 m0, s43, 4096
    s_nop 0
    buffer_load_dwordx4 v16, s[12:15], s41 offen lds
    s_add_u32 m0, s43, 5120
    s_nop 0
    buffer_load_dwordx4 v17, s[12:15], s41 offen lds
    s_add_u32 s58, s58, 1
    s_add_u32 s56, s58, s59
    s_and_b32 s56, s56, 15
    s_andn2_b32 s57, s58, 15
    s_or_b32 s56, s56, s57
    s_lshl_b32 s40, s56, 7
    s_mul_i32 s41, s56, 393216
    s_add_u32 s62, s62, 1
    s_cmp_ge_u32 s62, 4
    s_cselect_b32 s62, 0, s62
pad0_3:
    s_cbranch_execz pad0_4
    s_cselect_b32 s63, s65, s64
    s_add_u32 s42, s42, s63
    s_add_u32 s43, s43, s63
    s_waitcnt vmcnt(21)
    s_barrier
    s_add_u32 m0, s42, 0
    s_nop 0
    buffer_load_dwordx4 v8, s[8:11], s40 offen lds
    s_add_u32 m0, s42, 1024
    s_nop 0
    buffer_load_dwordx4 v9, s[8:11], s40 offen lds
    s_add_u32 m0, s42, 2048
    s_nop 0
    buffer_load_dwordx4 v10, s[8:11], s40 offen lds
    s_add_u32 m0, s42, 3072
    s_nop 0
    buffer_load_dwordx4 v11, s[8:11], s40 offen lds
    s_add_u32 m0, s43, 0
    s_nop 0
    buffer_load_dwordx4 v12, s[12:15], s41 offen lds
    s_add_u32 m0, s43, 1024
    s_nop 0
    buffer_load_dwordx4 v13, s[12:15], s41 offen lds
    s_add_u32 m0, s43, 2048
    s_nop 0
    buffer_load_dwordx4 v14, s[12:15], s41 offen lds
    s_add_u32 m0, s43, 3072
    s_nop 0
    buffer_load_dwordx4 v15, s[12:15], s41 offen lds
    s_add_u32 m0, s43, 4096
    s_nop 0
    buffer_load_dwordx4 v16, s[12:15], s41 offen lds
    s_add_u32 m0, s43, 5120
    s_nop 0
    buffer_load_dwordx4 v17, s[12:15], s41 offen lds
    s_add_u32 s58, s58, 1
    s_add_u32 s56, s58, s59
    s_and_b32 s56, s56, 15
    s_andn2_b32 s57, s58, 15
    s_or_b32 s56, s56, s57
    s_lshl_b32 s40, s56, 7
    s_mul_i32 s41, s56, 393216
    s_add_u32 s62, s62, 1
    s_cmp_ge_u32 s62, 4
    s_cselect_b32 s62, 0, s62
    s_cselect_b32 s63, s65, s64
    s_add_u32 s42, s42, s63
    s_add_u32 s43, s43, s63
    s_waitcnt vmcnt(20)
    s_barrier
    s_add_u32 m0, s42, 0
    s_nop 0
    buffer_load_dwordx4 v8, s[8:11], s40 offen lds
    s_add_u32 m0, s42, 1024
    s_nop 0
    buffer_load_dwordx4 v9, s[8:11], s40 offen lds
    s_add_u32 m0, s42, 2048
    s_nop 0
    buffer_load_dwordx4 v10, s[8:11], s40 offen lds
    s_add_u32 m0, s42, 3072
    s_nop 0
    buffer_load_dwordx4 v11, s[8:11], s40 offen lds
    s_add_u32 m0, s43, 0
    s_nop 0
    buffer_load_dwordx4 v12, s[12:15], s41 offen lds
    s_add_u32 m0, s43, 1024
    s_nop 0
    buffer_load_dwordx4 v13, s[12:15], s41 offen lds
    s_add_u32 m0, s43, 2048
    s_nop 0
    buffer_load_dwordx4 v14, s[12:15], s41 offen lds
    s_add_u32 m0, s43, 3072
    s_nop 0
    buffer_load_dwordx4 v15, s[12:15], s41 offen lds
    s_add_u32 m0, s43, 4096
    s_nop 0
    buffer_load_dwordx4 v16, s[12:15], s41 offen lds
    s_add_u32 m0, s43, 5120
    s_nop 0
    buffer_load_dwordx4 v17, s[12:15], s41 offen lds
    s_add_u32 s58, s58, 1
    s_add_u32 s56, s58, s59
    s_and_b32 s56, s56, 15
    s_andn2_b32 s57, s58, 15
    s_or_b32 s56, s56, s57
    s_lshl_b32 s40, s56, 7
    s_mul_i32 s41, s56, 393216
    s_add_u32 s62, s62, 1
    s_cmp_ge_u32 s62, 4
pad0_4:
    s_cbranch_execz qkv_warm_ret
    s_cselect_b32 s62, 0, s62
    s_cselect_b32 s63, s65, s64
    s_add_u32 s42, s42, s63
    s_add_u32 s43, s43, s63
    s_waitcnt vmcnt(20)
    s_barrier
    s_add_u32 m0, s42, 0
    s_nop 0
    buffer_load_dwordx4 v8, s[8:11], s40 offen lds
    s_add_u32 m0, s42, 1024
    s_nop 0
    buffer_load_dwordx4 v9, s[8:11], s40 offen lds
    s_add_u32 m0, s42, 2048
    s_nop 0
    buffer_load_dwordx4 v10, s[8:11], s40 offen lds
    s_add_u32 m0, s42, 3072
    s_nop 0
    buffer_load_dwordx4 v11, s[8:11], s40 offen lds
    s_add_u32 m0, s43, 0
    s_nop 0
    buffer_load_dwordx4 v12, s[12:15], s41 offen lds
    s_add_u32 m0, s43, 1024
    s_nop 0
    buffer_load_dwordx4 v13, s[12:15], s41 offen lds
    s_add_u32 m0, s43, 2048
    s_nop 0
    buffer_load_dwordx4 v14, s[12:15], s41 offen lds
    s_add_u32 m0, s43, 3072
    s_nop 0
    buffer_load_dwordx4 v15, s[12:15], s41 offen lds
    s_add_u32 m0, s43, 4096
    s_nop 0
    buffer_load_dwordx4 v16, s[12:15], s41 offen lds
    s_add_u32 m0, s43, 5120
    s_nop 0
    buffer_load_dwordx4 v17, s[12:15], s41 offen lds
    s_add_u32 s58, s58, 1
    s_add_u32 s56, s58, s59
    s_and_b32 s56, s56, 15
    s_andn2_b32 s57, s58, 15
    s_or_b32 s56, s56, s57
    s_lshl_b32 s40, s56, 7
    s_mul_i32 s41, s56, 393216
    s_add_u32 s62, s62, 1
    s_cmp_ge_u32 s62, 4
    s_cselect_b32 s62, 0, s62
    s_cselect_b32 s63, s65, s64
    s_add_u32 s42, s42, s63
    s_add_u32 s43, s43, s63
    s_waitcnt vmcnt(20)
    s_barrier
    s_add_u32 m0, s42, 0
    s_nop 0
    buffer_load_dwordx4 v8, s[8:11], s40 offen lds
    s_add_u32 m0, s42, 1024
    s_nop 0
    buffer_load_dwordx4 v9, s[8:11], s40 offen lds
    s_add_u32 m0, s42, 2048
    s_nop 0
    buffer_load_dwordx4 v10, s[8:11], s40 offen lds
    s_add_u32 m0, s42, 3072
    s_nop 0
    buffer_load_dwordx4 v11, s[8:11], s40 offen lds
    s_add_u32 m0, s43, 0
    s_nop 0
    buffer_load_dwordx4 v12, s[12:15], s41 offen lds
    s_add_u32 m0, s43, 1024
    s_nop 0
    buffer_load_dwordx4 v13, s[12:15], s41 offen lds
    s_add_u32 m0, s43, 2048
    s_nop 0
    buffer_load_dwordx4 v14, s[12:15], s41 offen lds
    s_add_u32 m0, s43, 3072
    s_nop 0
    buffer_load_dwordx4 v15, s[12:15], s41 offen lds
    s_add_u32 m0, s43, 4096
    s_nop 0
    buffer_load_dwordx4 v16, s[12:15], s41 offen lds
    s_add_u32 m0, s43, 5120
    s_nop 0
    buffer_load_dwordx4 v17, s[12:15], s41 offen lds
    s_add_u32 s58, s58, 1
    s_add_u32 s56, s58, s59
    s_and_b32 s56, s56, 15
    s_andn2_b32 s57, s58, 15
    s_or_b32 s56, s56, s57
    s_lshl_b32 s40, s56, 7
    s_mul_i32 s41, s56, 393216
    s_add_u32 s62, s62, 1
padc1:
    s_cbranch_execz pad1_1
    s_cmp_ge_u32 s62, 4
    s_cselect_b32 s62, 0, s62
    s_cselect_b32 s63, s65, s64
    s_add_u32 s42, s42, s63
    s_add_u32 s43, s43, s63
    s_waitcnt vmcnt(20)
    s_barrier
    s_add_u32 m0, s42, 0
    s_nop 0
    buffer_load_dwordx4 v8, s[8:11], s40 offen lds
    s_add_u32 m0, s42, 1024
    s_nop 0
    buffer_load_dwordx4 v9, s[8:11], s40 offen lds
    s_add_u32 m0, s42, 2048
    s_nop 0
    buffer_load_dwordx4 v10, s[8:11], s40 offen lds
    s_add_u32 m0, s42, 3072
    s_nop 0
    buffer_load_dwordx4 v11, s[8:11], s40 offen lds
    s_add_u32 m0, s43, 0
    s_nop 0
    buffer_load_dwordx4 v12, s[12:15], s41 offen lds
    s_add_u32 m0, s43, 1024
    s_nop 0
    buffer_load_dwordx4 v13, s[12:15], s41 offen lds
    s_add_u32 m0, s43, 2048
    s_nop 0
    buffer_load_dwordx4 v14, s[12:15], s41 offen lds
    s_add_u32 m0, s43, 3072
    s_nop 0
    buffer_load_dwordx4 v15, s[12:15], s41 offen lds
    s_add_u32 m0, s43, 4096
    s_nop 0
    buffer_load_dwordx4 v16, s[12:15], s41 offen lds
    s_add_u32 m0, s43, 5120
    s_nop 0
    buffer_load_dwordx4 v17, s[12:15], s41 offen lds
    s_add_u32 s58, s58, 1
    s_add_u32 s56, s58, s59
    s_and_b32 s56, s56, 15
    s_andn2_b32 s57, s58, 15
    s_or_b32 s56, s56, s57
    s_lshl_b32 s40, s56, 7
    s_mul_i32 s41, s56, 393216
    s_add_u32 s62, s62, 1
    s_cmp_ge_u32 s62, 4
    s_cselect_b32 s62, 0, s62
    s_cselect_b32 s63, s65, s64
    s_add_u32 s42, s42, s63
    s_add_u32 s43, s43, s63
    s_waitcnt vmcnt(20)
    s_barrier
    s_add_u32 m0, s42, 0
    s_nop 0
    buffer_load_dwordx4 v8, s[8:11], s40 offen lds
    s_add_u32 m0, s42, 1024
    s_nop 0
    buffer_load_dwordx4 v9, s[8:11], s40 offen lds
    s_add_u32 m0, s42, 2048
    s_nop 0
    buffer_load_dwordx4 v10, s[8:11], s40 offen lds
    s_add_u32 m0, s42, 3072
    s_nop 0
    buffer_load_dwordx4 v11, s[8:11], s40 offen lds
    s_add_u32 m0, s43, 0
    s_nop 0
    buffer_load_dwordx4 v12, s[12:15], s41 offen lds
    s_add_u32 m0, s43, 1024
    s_nop 0
    buffer_load_dwordx4 v13, s[12:15], s41 offen lds
    s_add_u32 m0, s43, 2048
    s_nop 0
    buffer_load_dwordx4 v14, s[12:15], s41 offen lds
    s_add_u32 m0, s43, 3072
    s_nop 0
    buffer_load_dwordx4 v15, s[12:15], s41 offen lds
    s_add_u32 m0, s43, 4096
    s_nop 0
    buffer_load_dwordx4 v16, s[12:15], s41 offen lds
    s_add_u32 m0, s43, 5120
    s_nop 0
    buffer_load_dwordx4 v17, s[12:15], s41 offen lds
    s_add_u32 s58, s58, 1
    s_add_u32 s56, s58, s59
    s_and_b32 s56, s56, 15
    s_andn2_b32 s57, s58, 15
    s_or_b32 s56, s56, s57
    s_lshl_b32 s40, s56, 7
    s_mul_i32 s41, s56, 393216
pad1_1:
    s_cbranch_execz pad1_2
    s_add_u32 s62, s62, 1
    s_cmp_ge_u32 s62, 4
    s_cselect_b32 s62, 0, s62
    s_cselect_b32 s63, s65, s64
    s_add_u32 s42, s42, s63
    s_add_u32 s43, s43, s63
    s_waitcnt vmcnt(20)
    s_barrier
    s_add_u32 m0, s42, 0
    s_nop 0
    buffer_load_dwordx4 v8, s[8:11], s40 offen lds
    s_add_u32 m0, s42, 1024
    s_nop 0
    buffer_load_dwordx4 v9, s[8:11], s40 offen lds
    s_add_u32 m0, s42, 2048
    s_nop 0
    buffer_load_dwordx4 v10, s[8:11], s40 offen lds
    s_add_u32 m0, s42, 3072
    s_nop 0
    buffer_load_dwordx4 v11, s[8:11], s40 offen lds
    s_add_u32 m0, s43, 0
    s_nop 0
    buffer_load_dwordx4 v12, s[12:15], s41 offen lds
    s_add_u32 m0, s43, 1024
    s_nop 0
    buffer_load_dwordx4 v13, s[12:15], s41 offen lds
    s_add_u32 m0, s43, 2048
    s_nop 0
    buffer_load_dwordx4 v14, s[12:15], s41 offen lds
    s_add_u32 m0, s43, 3072
    s_nop 0
    buffer_load_dwordx4 v15, s[12:15], s41 offen lds
    s_add_u32 m0, s43, 4096
    s_nop 0
    buffer_load_dwordx4 v16, s[12:15], s41 offen lds
    s_add_u32 m0, s43, 5120
    s_nop 0
    buffer_load_dwordx4 v17, s[12:15], s41 offen lds
    s_add_u32 s58, s58, 1
    s_add_u32 s56, s58, s59
    s_and_b32 s56, s56, 15
    s_andn2_b32 s57, s58, 15
    s_or_b32 s56, s56, s57
    s_lshl_b32 s40, s56, 7
    s_mul_i32 s41, s56, 393216
    s_add_u32 s62, s62, 1
    s_cmp_ge_u32 s62, 4
    s_cselect_b32 s62, 0, s62
    s_cselect_b32 s63, s65, s64
    s_add_u32 s42, s42, s63
    s_add_u32 s43, s43, s63
    s_waitcnt vmcnt(20)
    s_barrier
    v_lshlrev_b32 v1, 2, v0
    buffer_load_dword v23, v1, s[20:23], 0 offen sc1
    s_add_u32 m0, s42, 0
    s_nop 0
    buffer_load_dwordx4 v8, s[8:11], s40 offen lds
    s_add_u32 m0, s42, 1024
    s_nop 0
    buffer_load_dwordx4 v9, s[8:11], s40 offen lds
    s_add_u32 m0, s42, 2048
    s_nop 0
    buffer_load_dwordx4 v10, s[8:11], s40 offen lds
    s_add_u32 m0, s42, 3072
    s_nop 0
    buffer_load_dwordx4 v11, s[8:11], s40 offen lds
    s_add_u32 m0, s43, 0
    s_nop 0
    buffer_load_dwordx4 v12, s[12:15], s41 offen lds
    s_add_u32 m0, s43, 1024
    s_nop 0
    buffer_load_dwordx4 v13, s[12:15], s41 offen lds
    s_add_u32 m0, s43, 2048
    s_nop 0
    buffer_load_dwordx4 v14, s[12:15], s41 offen lds
    s_add_u32 m0, s43, 3072
    s_nop 0
    buffer_load_dwordx4 v15, s[12:15], s41 offen lds
    s_add_u32 m0, s43, 4096
    s_nop 0
    buffer_load_dwordx4 v16, s[12:15], s41 offen lds
    s_add_u32 m0, s43, 5120
    s_nop 0
    buffer_load_dwordx4 v17, s[12:15], s41 offen lds
    s_add_u32 s58, s58, 1
    s_add_u32 s56, s58, s59
    s_and_b32 s56, s56, 15
    s_andn2_b32 s57, s58, 15
pad1_2:
    s_cbranch_execz pad1_3
    s_or_b32 s56, s56, s57
    s_lshl_b32 s40, s56, 7
    s_mul_i32 s41, s56, 393216
    s_add_u32 s62, s62, 1
    s_cmp_ge_u32 s62, 4
    s_cselect_b32 s62, 0, s62
    s_cselect_b32 s63, s65, s64
    s_add_u32 s42, s42, s63
    s_add_u32 s43, s43, s63
    s_waitcnt vmcnt(21)
    s_barrier
    s_add_u32 m0, s42, 0
    s_nop 0
    buffer_load_dwordx4 v8, s[8:11], s40 offen lds
    s_add_u32 m0, s42, 1024
    s_nop 0
    buffer_load_dwordx4 v9, s[8:11], s40 offen lds
    s_add_u32 m0, s42, 2048
    s_nop 0
    buffer_load_dwordx4 v10, s[8:11], s40 offen lds
    s_add_u32 m0, s42, 3072
    s_nop 0
    buffer_load_dwordx4 v11, s[8:11], s40 offen lds
    s_add_u32 m0, s43, 0
    s_nop 0
    buffer_load_dwordx4 v12, s[12:15], s41 offen lds
    s_add_u32 m0, s43, 1024
    s_nop 0
    buffer_load_dwordx4 v13, s[12:15], s41 offen lds
    s_add_u32 m0, s43, 2048
    s_nop 0
    buffer_load_dwordx4 v14, s[12:15], s41 offen lds
    s_add_u32 m0, s43, 3072
    s_nop 0
    buffer_load_dwordx4 v15, s[12:15], s41 offen lds
    s_add_u32 m0, s43, 4096
    s_nop 0
    buffer_load_dwordx4 v16, s[12:15], s41 offen lds
    s_add_u32 m0, s43, 5120
    s_nop 0
    buffer_load_dwordx4 v17, s[12:15], s41 offen lds
    s_add_u32 s58, s58, 1
    s_add_u32 s56, s58, s59
    s_and_b32 s56, s56, 15
    s_andn2_b32 s57, s58, 15
    s_or_b32 s56, s56, s57
    s_lshl_b32 s40, s56, 7
    s_mul_i32 s41, s56, 393216
    s_add_u32 s62, s62, 1
    s_cmp_ge_u32 s62, 4
    s_cselect_b32 s62, 0, s62
    s_cselect_b32 s63, s65, s64
    s_add_u32 s42, s42, s63
    s_add_u32 s43, s43, s63
    s_waitcnt vmcnt(20)
    s_barrier
    s_mov_b32 s39, 0x40000
qkv_poll:
    v_and_b32 v23, v23, v21
    v_cmp_ne_u32 vcc, v23, v21
    s_sub_u32 s39, s39, 1
    s_cselect_b64 vcc, 0, vcc
    s_nop 0
    s_cbranch_vccz qkv_ready
    buffer_load_dword v23, v1, s[20:23], 0 offen sc1
    s_waitcnt vmcnt(0)
    s_branch qkv_poll
qkv_ready:
    buffer_load_dwordx4 v[24:27], v20, s[16:19], s36 offen offset:0 sc1
    buffer_load_dwordx4 v[28:31], v20, s[16:19], s36 offen offset:1024 sc1
    buffer_load_dwordx4 v[32:35], v20, s[16:19], s36 offen offset:2048 sc1
    buffer_load_dwordx4 v[36:39], v20, s[16:19], s36 offen offset:3072 sc1
    buffer_load_dwordx4 v[40:43], v20, s[16:19], s38 offen offset:0 sc1
    buffer_load_dwordx4 v[44:47], v20, s[16:19], s38 offen offset:1024 sc1
    buffer_load_dwordx4 v[48:51], v20, s[16:19], s38 offen offset:2048 sc1
    buffer_load_dwordx4 v[52:55], v20, s[16:19], s38 offen offset:3072 sc1
    s_add_u32 m0, s42, 0
    s_nop 0
    buffer_load_dwordx4 v8, s[8:11], s40 offen lds
    s_add_u32 m0, s42, 1024
    s_nop 0
    buffer_load_dwordx4 v9, s[8:11], s40 offen lds
    s_add_u32 m0, s42, 2048
    s_nop 0
    buffer_load_dwordx4 v10, s[8:11], s40 offen lds
    s_add_u32 m0, s42, 3072
    s_nop 0
    buffer_load_dwordx4 v11, s[8:11], s40 offen lds
    s_add_u32 m0, s43, 0
    s_nop 0
    buffer_load_dwordx4 v12, s[12:15], s41 offen lds
pad1_3:
    s_cbranch_execz pad1_4
    s_add_u32 m0, s43, 1024
    s_nop 0
    buffer_load_dwordx4 v13, s[12:15], s41 offen lds
    s_add_u32 m0, s43, 2048
    s_nop 0
    buffer_load_dwordx4 v14, s[12:15], s41 offen lds
    s_add_u32 m0, s43, 3072
    s_nop 0
    buffer_load_dwordx4 v15, s[12:15], s41 offen lds
    s_add_u32 m0, s43, 4096
    s_nop 0
    buffer_load_dwordx4 v16, s[12:15], s41 offen lds
    s_add_u32 m0, s43, 5120
    s_nop 0
    buffer_load_dwordx4 v17, s[12:15], s41 offen lds
    s_add_u32 s58, s58, 1
    s_add_u32 s56, s58, s59
    s_and_b32 s56, s56, 15
    s_andn2_b32 s57, s58, 15
    s_or_b32 s56, s56, s57
    s_lshl_b32 s40, s56, 7
    s_mul_i32 s41, s56, 393216
    s_add_u32 s62, s62, 1
    s_cmp_ge_u32 s62, 4
    s_cselect_b32 s62, 0, s62
    s_cselect_b32 s63, s65, s64
    s_add_u32 s42, s42, s63
    s_add_u32 s43, s43, s63
    s_waitcnt vmcnt(28)
    s_barrier
    s_add_u32 m0, s42, 0
    s_nop 0
    buffer_load_dwordx4 v8, s[8:11], s40 offen lds
    s_add_u32 m0, s42, 1024
    s_nop 0
    buffer_load_dwordx4 v9, s[8:11], s40 offen lds
    s_add_u32 m0, s42, 2048
    s_nop 0
    buffer_load_dwordx4 v10, s[8:11], s40 offen lds
    s_add_u32 m0, s42, 3072
    s_nop 0
    buffer_load_dwordx4 v11, s[8:11], s40 offen lds
    s_add_u32 m0, s43, 0
    s_nop 0
    buffer_load_dwordx4 v12, s[12:15], s41 offen lds
    s_add_u32 m0, s43, 1024
    s_nop 0
    buffer_load_dwordx4 v13, s[12:15], s41 offen lds
    s_add_u32 m0, s43, 2048
    s_nop 0
    buffer_load_dwordx4 v14, s[12:15], s41 offen lds
    s_add_u32 m0, s43, 3072
    s_nop 0
    buffer_load_dwordx4 v15, s[12:15], s41 offen lds
    s_add_u32 m0, s43, 4096
    s_nop 0
    buffer_load_dwordx4 v16, s[12:15], s41 offen lds
    s_add_u32 m0, s43, 5120
    s_nop 0
    buffer_load_dwordx4 v17, s[12:15], s41 offen lds
    s_add_u32 s58, s58, 1
    s_add_u32 s56, s58, s59
    s_and_b32 s56, s56, 15
    s_andn2_b32 s57, s58, 15
    s_or_b32 s56, s56, s57
    s_lshl_b32 s40, s56, 7
    s_mul_i32 s41, s56, 393216
    s_add_u32 s62, s62, 1
    s_cmp_ge_u32 s62, 4
    s_cselect_b32 s62, 0, s62
    s_cselect_b32 s63, s65, s64
    s_add_u32 s42, s42, s63
    s_add_u32 s43, s43, s63
    s_waitcnt vmcnt(20)
    s_barrier
    s_lshl_b32 s34, s52, 4
    s_add_u32 s34, s34, s30
    s_lshl_b32 s34, s34, 2
    s_add_u32 s34, s34, s3
    s_lshl_b32 s35, s34, 11
    buffer_load_dwordx4 v[56:59], v20, s[44:47], s35 offen
    buffer_load_dwordx4 v[60:63], v20, s[44:47], s35 offen offset:1024
    v_add_f32 v24, v24, v28
    v_add_f32 v32, v32, v36
    v_add_f32 v25, v25, v29
    v_add_f32 v33, v33, v37
    v_add_f32 v26, v26, v30
    v_add_f32 v34, v34, v38
    v_add_f32 v27, v27, v31
    v_add_f32 v35, v35, v39
    v_add_f32 v24, v24, v32
    v_add_f32 v25, v25, v33
    v_add_f32 v26, v26, v34
    v_add_f32 v27, v27, v35
    v_mov_b32 v28, v24
pad1_4:
    s_cbranch_execz qkv_warm_ret
    v_mov_b32 v29, v25
    v_mov_b32 v30, v26
    v_mov_b32 v31, v27
    v_permlane16_swap_b32 v24, v28
    v_permlane16_swap_b32 v25, v29
    v_permlane16_swap_b32 v26, v30
    v_permlane16_swap_b32 v27, v31
    v_add_f32 v24, v24, v28
    v_add_f32 v25, v25, v29
    v_add_f32 v26, v26, v30
    v_add_f32 v27, v27, v31
    v_mov_b32 v28, v24
    v_mov_b32 v29, v25
    v_mov_b32 v30, v26
    v_mov_b32 v31, v27
    v_permlane32_swap_b32 v24, v28
    v_permlane32_swap_b32 v25, v29
    v_permlane32_swap_b32 v26, v30
    v_permlane32_swap_b32 v27, v31
    v_add_f32 v24, v24, v28
    v_add_f32 v25, v25, v29
    v_add_f32 v26, v26, v30
    v_add_f32 v27, v27, v31
    v_mul_f32 v24, 0x3a800000, v24
    v_mul_f32 v28, 0x3a800000, v25
    v_mul_f32 v25, 0x3a800000, v26
    v_mul_f32 v29, 0x3a800000, v27
    v_fma_f32 v28, -v24, v24, v28
    v_fma_f32 v29, -v25, v25, v29
    v_max_f32 v28, 0, v28
    v_max_f32 v29, 0, v29
    v_add_f32 v28, 0x3727c5ac, v28
    v_add_f32 v29, 0x3727c5ac, v29
    v_rsq_f32 v28, v28
    v_rsq_f32 v29, v29
    v_lshlrev_b32 v1, 3, v0
    s_lshl_b32 s33, s3, 7
    v_add_u32 v2, s33, v1
    v_mul_f32 v30, -v24, v28
    v_mul_f32 v31, -v25, v29
    s_lshl_b32 s33, s32, 7
    s_cmp_eq_u32 s31, 0
    s_cselect_b32 s33, s33, 1073741824
    s_mov_b64 exec, 0xffff
    ds_write_b64 v2, v[28:29]
    ds_write_b64 v2, v[30:31] offset:512
    buffer_store_dwordx2 v[24:25], v1, s[48:51], s33 offen sc1
    s_mov_b64 exec, -1
    v_mov_b32 v2, 2048
    v_mov_b32 v3, 0
    ds_write_b32 v2, v3
    s_getpc_b64 s[8:9]
qkv_here1:
    s_add_u32 s8, s8, attn_begin-qkv_here1
    s_addc_u32 s9, s9, 0
    s_mov_b32 s10, gu_begin-attn_begin
    s_mov_b32 s11, 0x00020000
    v_lshlrev_b32 v10, 7, v0
    s_mul_i32 s33, s3, (gu_begin-attn_begin)/4
    buffer_load_dword v8, v10, s[8:11], s33 offen
    s_waitcnt vmcnt(14)
    s_barrier
    v_add_f32 v40, v40, v44
    v_add_f32 v48, v48, v52
    v_add_f32 v41, v41, v45
    v_add_f32 v49, v49, v53
    v_add_f32 v42, v42, v46
    v_add_f32 v50, v50, v54
    v_add_f32 v43, v43, v47
    v_add_f32 v51, v51, v55
    v_add_f32 v40, v40, v48
    v_add_f32 v41, v41, v49
    v_add_f32 v42, v42, v50
    v_add_f32 v43, v43, v51
    v_mov_b32 v44, v40
    v_mov_b32 v45, v41
    v_mov_b32 v46, v42
    v_mov_b32 v47, v43
    v_permlane16_swap_b32 v40, v44
    v_permlane16_swap_b32 v41, v45
    v_permlane16_swap_b32 v42, v46
    v_permlane16_swap_b32 v43, v47
    v_add_f32 v40, v40, v44
    v_add_f32 v41, v41, v45
    v_add_f32 v42, v42, v46
    v_add_f32 v43, v43, v47
    v_mov_b32 v44, v40
    v_mov_b32 v45, v41
    v_mov_b32 v46, v42
    v_mov_b32 v47, v43
    v_permlane32_swap_b32 v40, v44
    v_permlane32_swap_b32 v41, v45
    v_permlane32_swap_b32 v42, v46
    v_permlane32_swap_b32 v43, v47
    v_add_f32 v40, v40, v44
    v_add_f32 v41, v41, v45
    v_add_f32 v42, v42, v46
    v_add_f32 v43, v43, v47
    s_lshl_b32 s33, s3, 8
    v_add_u32 v2, s33, v20
    s_mov_b64 exec, 0xffff
    ds_write_b128 v2, v[40:43] offset:1024
    s_mov_b64 exec, -1
    s_waitcnt lgkmcnt(0)
    s_waitcnt vmcnt(4)
padc2:
    s_cbranch_execz pad2_1
    s_barrier
    s_waitcnt vmcnt(2)
    v_lshlrev_b32 v2, 16, v56
    v_and_b32 v3, 0xffff0000, v56
    v_lshlrev_b32 v4, 16, v57
    v_and_b32 v5, 0xffff0000, v57
    v_add_f32 v2, v2, v4
    v_add_f32 v3, v3, v5
    v_lshlrev_b32 v4, 16, v58
    v_and_b32 v5, 0xffff0000, v58
    v_add_f32 v2, v2, v4
    v_add_f32 v3, v3, v5
    v_lshlrev_b32 v4, 16, v59
    v_and_b32 v5, 0xffff0000, v59
    v_add_f32 v2, v2, v4
    v_add_f32 v3, v3, v5
    v_lshlrev_b32 v4, 16, v60
    v_and_b32 v5, 0xffff0000, v60
    v_add_f32 v2, v2, v4
    v_add_f32 v3, v3, v5
    v_lshlrev_b32 v4, 16, v61
    v_and_b32 v5, 0xffff0000, v61
    v_add_f32 v2, v2, v4
    v_add_f32 v3, v3, v5
    v_lshlrev_b32 v4, 16, v62
    v_and_b32 v5, 0xffff0000, v62
    v_add_f32 v2, v2, v4
    v_add_f32 v3, v3, v5
    v_lshlrev_b32 v4, 16, v63
    v_and_b32 v5, 0xffff0000, v63
    v_add_f32 v2, v2, v4
    v_add_f32 v3, v3, v5
    v_add_f32 v2, v2, v3
    s_nop 1
    v_add_f32_dpp v2, v2, v2 quad_perm:[1,0,3,2] row_mask:0xf bank_mask:0xf
    s_nop 1
    v_add_f32_dpp v2, v2, v2 quad_perm:[2,3,0,1] row_mask:0xf bank_mask:0xf
    s_nop 1
    v_add_f32_dpp v2, v2, v2 row_half_mirror row_mask:0xf bank_mask:0xf
    s_nop 1
    v_add_f32_dpp v2, v2, v2 row_ror:8 row_mask:0xf bank_mask:0xf
    v_mov_b32 v3, v2
    s_nop 1
    v_permlane16_swap_b32 v2, v3
    v_add_f32 v2, v2, v3
    v_mov_b32 v3, v2
    s_nop 1
    v_permlane32_swap_b32 v2, v3
    v_add_f32 v2, v2, v3
    v_mul_f32 v2, 0x3a800000, v2
    s_lshl_b32 s34, s34, 2
    s_add_u32 s34, s34, 16384
    v_mov_b32 v3, 0
    s_mov_b64 exec, 1
    buffer_store_dword v2, v3, s[48:51], s34 offen sc1
    s_waitcnt vmcnt(1)
    s_mov_b64 exec, 0
    s_cmp_eq_u32 s3, 0
    s_cbranch_scc1 padc4
    s_cmp_eq_u32 s3, 1
    s_cbranch_scc1 padc5
    s_cmp_eq_u32 s3, 2
    s_cbranch_scc1 padc6
    s_cmp_eq_u32 s3, 3
    s_cbranch_scc1 padc7
qkv_ld_ret:
    s_mov_b64 exec, -1
    s_mov_b64 exec, -1
    s_add_u32 s96, s86, 0x4400000
    s_addc_u32 s97, s87, 0
    s_mov_b32 s98, 0x8000
    s_mov_b32 s99, 0x00020000
    v_mov_b32 v24, 2048
    v_mov_b32 v25, 1
    s_lshl_b32 s38, s52, 11
    s_add_u32 s38, s38, 96
    s_lshl_b32 s39, s53, 11
    s_add_u32 s39, s39, -1936
    v_mov_b32 v26, s38
    v_mov_b32 v27, s39
    v_cmp_lt_u32 vcc, 15, v0
    s_nop 1
    v_cndmask_b32 v26, v26, v27, vcc
    v_lshl_add_u32 v26, v0, 7, v26
    v_add_u32 v26, s30, v26
    s_lshl_b32 s38, s31, 4
    s_lshr_b32 s39, s30, 1
    s_add_u32 s38, s38, s39
    s_lshl_b32 s38, s38, 7
    s_and_b32 s39, s30, 1
    s_add_u32 s38, s38, s39
    s_add_u32 s38, s38, -32676
    v_lshlrev_b32 v27, 10, v0
    v_add_u32 v27, s38, v27
    v_cmp_lt_u32 vcc, 31, v0
    s_nop 1
    v_cndmask_b32 v26, v26, v27, vcc
    s_mov_b64 exec, 1
    s_waitcnt vmcnt(0)
    ds_add_rtn_u32 v24, v24, v25
    s_waitcnt lgkmcnt(0)
    v_readfirstlane_b32 s89, v24
    s_nop 0
    s_cmp_eq_u32 s89, 7
    s_cbranch_scc0 qkv_sg2
    s_bfm_b64 exec, 34, 0
    buffer_store_byte v25, v26, s[96:99], 0 offen sc1
qkv_sg2:
    s_mov_b64 exec, -1
pad2_1:
    s_cbranch_execz pad2_2
    s_branch attn_begin
qkv_comp:
    s_getpc_b64 s[12:13]
qkv_here3:
    s_add_u32 s12, s12, qkv_kernel-qkv_here3
    s_addc_u32 s13, s13, -1
    s_mov_b32 s14, attn_begin-qkv_kernel
    s_mov_b32 s15, 0x00020000
    v_lshlrev_b32 v1, 7, v0
    s_mul_i32 s44, s3, (attn_begin-qkv_kernel)/4
    buffer_load_dword v104, v1, s[12:15], s44 offen
    s_lshr_b32 s32, s3, 1
    s_and_b32 s33, s3, 1
    s_lshl_b32 s34, s32, 13
    v_lshlrev_b32 v225, 4, v0
    v_and_b32 v1, 31, v0
    v_lshlrev_b32 v2, 7, v1
    v_bfe_u32 v3, v0, 1, 3
    v_lshrrev_b32 v4, 5, v0
    v_xor_b32 v3, v3, v4
    v_lshlrev_b32 v3, 4, v3
    v_add3_u32 v223, s34, v2, v3
    v_lshlrev_b32 v229, 4, v4
    v_lshlrev_b32 v230, 2, v1
    s_lshl_b32 s34, s32, 8
    s_lshl_b32 s35, s33, 7
    v_cmp_gt_u32 vcc, 32, v0
    v_mov_b32 v5, 1073741824
    s_nop 0
    v_cndmask_b32 v226, v5, v230, vcc
    s_cmp_eq_u32 s32, 0
    s_cselect_b32 s44, 0, 1073741824
    v_add_u32 v226, s44, v226
    v_cmp_eq_u32 vcc, 0, v0
    s_nop 1
    v_cndmask_b32 v227, v5, 0, vcc
    s_cmp_eq_u32 s3, 0
    s_cselect_b32 s44, 0, 1073741824
    v_add_u32 v227, s44, v227
    s_and_b32 s44, s31, 3
    s_lshl_b32 s44, 1, s44
    v_mov_b32 v228, s44
    s_lshl_b32 s45, s30, 2
    s_lshr_b32 s44, s31, 2
    s_add_u32 s45, s45, s44
    s_lshl_b32 s45, s45, 2
    s_lshl_b32 s46, s31, 14
    s_lshl_b32 s44, s59, 8
    s_add_u32 s46, s46, s44
    s_add_u32 s46, s46, s35
    s_add_u32 s46, s46, 262144
    s_add_u32 s47, s46, 4096
    s_add_u32 s48, s46, 8192
    v_bfe_u32 v1, v0, 2, 1
    v_bfe_u32 v2, v0, 4, 1
    v_cmp_eq_u32 vcc, v1, v2
    v_mov_b32 v1, 0x3f803f80
    s_nop 0
    v_cndmask_b32 v144, 0, v1, vcc
    v_mov_b32 v145, v144
    v_mov_b32 v146, v144
    v_mov_b32 v147, v144
    v_add_u32 v4, s34, v229
    v_add_u32 v5, s35, v229
    v_add_u32 v6, s34, v230
    v_add_u32 v7, s35, v230
    v_lshrrev_b32 v2, 5, v0
    v_mul_u32_u24 v224, 3072, v2
    v_bfe_u32 v2, v0, 2, 2
    v_lshlrev_b32 v2, 6, v2
    v_add_u32 v224, v224, v2
    v_bfe_u32 v2, v0, 4, 1
    v_mul_u32_u24 v2, 32, v2
    v_add_u32 v224, v224, v2
    v_and_b32 v2, 1, v0
    v_lshlrev_b32 v2, 4, v2
    v_bfe_u32 v3, v0, 1, 1
    v_lshlrev_b32 v3, 3, v3
    v_add3_u32 v224, v224, v2, v3
    s_lshl_b32 s34, s33, 8
    s_add_u32 s34, s34, 16384
    v_add_u32 v224, s34, v224
    v_mov_b32 v218, v223
    v_mov_b32 v222, v224
    s_mov_b32 s60, 0
    v_xor_b32 v219, 32, v218
    v_xor_b32 v220, 64, v218
    v_xor_b32 v221, 96, v218
    v_mov_b32 v8, 0
    v_mov_b32 v9, 0
    v_mov_b32 v10, 0
    v_mov_b32 v11, 0
    v_mov_b32 v12, 0
    v_mov_b32 v13, 0
    v_mov_b32 v14, 0
    v_mov_b32 v15, 0
    v_mov_b32 v16, 0
    v_mov_b32 v17, 0
    v_mov_b32 v18, 0
    v_mov_b32 v19, 0
    v_mov_b32 v20, 0
    v_mov_b32 v21, 0
    v_mov_b32 v22, 0
pad2_2:
    s_cbranch_execz pad2_3
    v_mov_b32 v23, 0
    v_mov_b32 v24, 0
    v_mov_b32 v25, 0
    v_mov_b32 v26, 0
    v_mov_b32 v27, 0
    v_mov_b32 v28, 0
    v_mov_b32 v29, 0
    v_mov_b32 v30, 0
    v_mov_b32 v31, 0
    v_mov_b32 v32, 0
    v_mov_b32 v33, 0
    v_mov_b32 v34, 0
    v_mov_b32 v35, 0
    v_mov_b32 v36, 0
    v_mov_b32 v37, 0
    v_mov_b32 v38, 0
    v_mov_b32 v39, 0
    v_mov_b32 v40, 0
    v_mov_b32 v41, 0
    v_mov_b32 v42, 0
    v_mov_b32 v43, 0
    v_mov_b32 v44, 0
    v_mov_b32 v45, 0
    v_mov_b32 v46, 0
    v_mov_b32 v47, 0
    v_mov_b32 v48, 0
    v_mov_b32 v49, 0
    v_mov_b32 v50, 0
    v_mov_b32 v51, 0
    v_mov_b32 v52, 0
    v_mov_b32 v53, 0
    v_mov_b32 v54, 0
    v_mov_b32 v55, 0
    v_mov_b32 v56, 0
    v_mov_b32 v57, 0
    v_mov_b32 v58, 0
    v_mov_b32 v59, 0
    v_mov_b32 v60, 0
    v_mov_b32 v61, 0
    v_mov_b32 v62, 0
    v_mov_b32 v63, 0
    v_mov_b32 v64, 0
    v_mov_b32 v65, 0
    v_mov_b32 v66, 0
    v_mov_b32 v67, 0
    v_mov_b32 v68, 0
    v_mov_b32 v69, 0
    v_mov_b32 v70, 0
    v_mov_b32 v71, 0
    v_mov_b32 v72, 0
    v_mov_b32 v73, 0
    v_mov_b32 v74, 0
    v_mov_b32 v75, 0
    v_mov_b32 v76, 0
    v_mov_b32 v77, 0
    v_mov_b32 v78, 0
    v_mov_b32 v79, 0
    v_mov_b32 v80, 0
    v_mov_b32 v81, 0
    v_mov_b32 v82, 0
    v_mov_b32 v83, 0
    v_mov_b32 v84, 0
    v_mov_b32 v85, 0
    v_mov_b32 v86, 0
    v_mov_b32 v87, 0
    v_mov_b32 v88, 0
    v_mov_b32 v89, 0
    v_mov_b32 v90, 0
    v_mov_b32 v91, 0
    v_mov_b32 v92, 0
    v_mov_b32 v93, 0
    v_mov_b32 v94, 0
    v_mov_b32 v95, 0
    v_mov_b32 v96, 0
    v_mov_b32 v97, 0
    v_mov_b32 v98, 0
    v_mov_b32 v99, 0
    v_mov_b32 v100, 0
    v_mov_b32 v101, 0
    v_mov_b32 v102, 0
    v_mov_b32 v103, 0
    v_mov_b32 v148, 0
    v_mov_b32 v149, 0
    v_mov_b32 v150, 0
    v_mov_b32 v151, 0
    v_mov_b32 v152, 0
    v_mov_b32 v153, 0
    v_mov_b32 v154, 0
    v_mov_b32 v155, 0
    v_mov_b32 v156, 0
    v_mov_b32 v157, 0
    v_mov_b32 v158, 0
    v_mov_b32 v159, 0
    s_lshl_b32 s34, s33, 17
    s_lshl_b32 s35, s30, 2
    s_lshl_b32 s36, s32, 1
    s_add_u32 s35, s35, s36
    s_lshl_b32 s35, s35, 11
    s_add_u32 s44, s34, s35
    s_lshl_b32 s34, s31, 18
    s_add_u32 s34, s34, s44
    s_lshl_b32 s35, s52, 18
    s_add_u32 s35, s35, s44
    s_add_u32 s35, s35, 4194304
    s_lshl_b32 s36, s53, 18
    s_add_u32 s36, s36, s44
    s_add_u32 s36, s36, 8388608
    s_waitcnt lgkmcnt(0)
    s_add_u32 s8, s6, 0x400000
    s_addc_u32 s9, s7, 0
    s_mov_b32 s10, 0xc00000
    s_mov_b32 s11, 0x00020000
    s_mov_b32 s16, s6
    s_mov_b32 s17, s7
    s_mov_b32 s18, 0x80000
    s_mov_b32 s19, 0x00020000
    s_mov_b32 s20, s26
    s_mov_b32 s21, s27
    s_mov_b32 s22, 0x100
pad2_3:
    s_cbranch_execz pad2_4
    s_mov_b32 s23, 0x00020000
    s_waitcnt vmcnt(0)
    s_mov_b64 exec, 0
    s_cmp_eq_u32 s3, 0
    s_cbranch_scc1 padc0
    s_cmp_eq_u32 s3, 1
    s_cbranch_scc1 padc1
    s_cmp_eq_u32 s3, 2
    s_cbranch_scc1 padc2
    s_cmp_eq_u32 s3, 3
    s_cbranch_scc1 padc3
qkv_warm_ret:
    s_mov_b64 exec, -1
    s_add_u32 s12, s6, 0x4400000
    s_addc_u32 s13, s7, 0
    s_mov_b32 s14, 0x8000
    s_mov_b32 s15, 0x00020000
    s_lshl_b32 s44, s2, 7
    s_cmp_eq_u32 s3, 0
    s_cselect_b32 s44, s44, 1073741824
    v_lshlrev_b32 v1, 4, v0
    s_mov_b64 exec, 0xff
    buffer_store_dwordx4 v[8:11], v1, s[12:15], s44 offen sc1
    s_mov_b64 exec, -1
    s_barrier
    ds_read_b128 v[104:107], v218 offset:0
    ds_read_b64_tr_b16 v[120:121], v222 offset:0
    ds_read_b64_tr_b16 v[122:123], v222 offset:512
    ds_read_b128 v[108:111], v218 offset:4096
    ds_read_b64_tr_b16 v[124:125], v222 offset:1024
    ds_read_b64_tr_b16 v[126:127], v222 offset:1536
    ds_read_b64_tr_b16 v[128:129], v222 offset:2048
    ds_read_b64_tr_b16 v[130:131], v222 offset:2560
    s_waitcnt lgkmcnt(5)
    v_mfma_f32_32x32x16_bf16 v[8:23], v[120:123], v[104:107], v[8:23]
    ds_read_b128 v[112:115], v219 offset:0
    ds_read_b64_tr_b16 v[132:133], v222 offset:6144
    s_waitcnt lgkmcnt(6)
    v_mfma_f32_32x32x16_bf16 v[56:71], v[120:123], v[108:111], v[56:71]
    ds_read_b64_tr_b16 v[134:135], v222 offset:6656
    ds_read_b128 v[116:119], v219 offset:4096
    v_mfma_f32_16x16x32_bf16 v[148:151], v[144:147], v[120:123], v[148:151]
    ds_read_b64_tr_b16 v[136:137], v222 offset:7168
    ds_read_b64_tr_b16 v[138:139], v222 offset:7680
    s_waitcnt lgkmcnt(8)
    v_mfma_f32_32x32x16_bf16 v[24:39], v[124:127], v[104:107], v[24:39]
    ds_read_b64_tr_b16 v[140:141], v222 offset:8192
    ds_read_b64_tr_b16 v[142:143], v222 offset:8704
    v_mfma_f32_32x32x16_bf16 v[72:87], v[124:127], v[108:111], v[72:87]
    v_mfma_f32_16x16x32_bf16 v[152:155], v[144:147], v[124:127], v[152:155]
    s_waitcnt lgkmcnt(8)
    v_mfma_f32_32x32x16_bf16 v[40:55], v[104:107], v[128:131], v[40:55]
    v_mfma_f32_32x32x16_bf16 v[88:103], v[108:111], v[128:131], v[88:103]
    v_mfma_f32_16x16x32_bf16 v[156:159], v[144:147], v[128:131], v[156:159]
    s_waitcnt lgkmcnt(5)
    v_mfma_f32_32x32x16_bf16 v[8:23], v[132:135], v[112:115], v[8:23]
    ds_read_b128 v[104:107], v220 offset:0
    ds_read_b64_tr_b16 v[120:121], v222 offset:12288
    s_waitcnt lgkmcnt(6)
    v_mfma_f32_32x32x16_bf16 v[56:71], v[132:135], v[116:119], v[56:71]
    ds_read_b64_tr_b16 v[122:123], v222 offset:12800
    ds_read_b128 v[108:111], v220 offset:4096
    v_mfma_f32_16x16x32_bf16 v[148:151], v[144:147], v[132:135], v[148:151]
    ds_read_b64_tr_b16 v[124:125], v222 offset:13312
    ds_read_b64_tr_b16 v[126:127], v222 offset:13824
    s_waitcnt lgkmcnt(8)
    v_mfma_f32_32x32x16_bf16 v[24:39], v[136:139], v[112:115], v[24:39]
    ds_read_b64_tr_b16 v[128:129], v222 offset:14336
    ds_read_b64_tr_b16 v[130:131], v222 offset:14848
    v_mfma_f32_32x32x16_bf16 v[72:87], v[136:139], v[116:119], v[72:87]
    v_mfma_f32_16x16x32_bf16 v[152:155], v[144:147], v[136:139], v[152:155]
    s_waitcnt lgkmcnt(8)
    v_mfma_f32_32x32x16_bf16 v[40:55], v[112:115], v[140:143], v[40:55]
    v_mfma_f32_32x32x16_bf16 v[88:103], v[116:119], v[140:143], v[88:103]
    v_mfma_f32_16x16x32_bf16 v[156:159], v[144:147], v[140:143], v[156:159]
    s_waitcnt lgkmcnt(5)
    v_mfma_f32_32x32x16_bf16 v[8:23], v[120:123], v[104:107], v[8:23]
    ds_read_b128 v[112:115], v221 offset:0
pad2_4:
    s_cbranch_execz qkv_warm_ret
    ds_read_b64_tr_b16 v[132:133], v222 offset:18432
    s_waitcnt lgkmcnt(6)
    v_mfma_f32_32x32x16_bf16 v[56:71], v[120:123], v[108:111], v[56:71]
    ds_read_b64_tr_b16 v[134:135], v222 offset:18944
    ds_read_b128 v[116:119], v221 offset:4096
    v_mfma_f32_16x16x32_bf16 v[148:151], v[144:147], v[120:123], v[148:151]
    ds_read_b64_tr_b16 v[136:137], v222 offset:19456
    ds_read_b64_tr_b16 v[138:139], v222 offset:19968
    s_waitcnt lgkmcnt(8)
    v_mfma_f32_32x32x16_bf16 v[24:39], v[124:127], v[104:107], v[24:39]
    ds_read_b64_tr_b16 v[140:141], v222 offset:20480
    ds_read_b64_tr_b16 v[142:143], v222 offset:20992
    v_mfma_f32_32x32x16_bf16 v[72:87], v[124:127], v[108:111], v[72:87]
    s_add_u32 s60, s60, 40960
    s_cmp_ge_u32 s60, 163840
    s_cselect_b32 s60, 0, s60
    v_add_u32 v218, s60, v223
    v_add_u32 v222, s60, v224
    v_xor_b32 v219, 32, v218
    v_xor_b32 v220, 64, v218
    v_xor_b32 v221, 96, v218
    v_mfma_f32_16x16x32_bf16 v[152:155], v[144:147], v[124:127], v[152:155]
    s_waitcnt lgkmcnt(8)
    v_mfma_f32_32x32x16_bf16 v[40:55], v[104:107], v[128:131], v[40:55]
    v_mfma_f32_32x32x16_bf16 v[88:103], v[108:111], v[128:131], v[88:103]
    v_mfma_f32_16x16x32_bf16 v[156:159], v[144:147], v[128:131], v[156:159]
    s_waitcnt lgkmcnt(5)
    v_mfma_f32_32x32x16_bf16 v[8:23], v[132:135], v[112:115], v[8:23]
    s_waitcnt lgkmcnt(4)
    v_mfma_f32_32x32x16_bf16 v[56:71], v[132:135], v[116:119], v[56:71]
    s_waitcnt lgkmcnt(0)
    s_barrier
    v_mfma_f32_16x16x32_bf16 v[148:151], v[144:147], v[132:135], v[148:151]
    ds_read_b128 v[104:107], v218 offset:0
    ds_read_b64_tr_b16 v[120:121], v222 offset:0
    v_mfma_f32_32x32x16_bf16 v[24:39], v[136:139], v[112:115], v[24:39]
    ds_read_b64_tr_b16 v[122:123], v222 offset:512
    ds_read_b128 v[108:111], v218 offset:4096
    v_mfma_f32_32x32x16_bf16 v[72:87], v[136:139], v[116:119], v[72:87]
    ds_read_b64_tr_b16 v[124:125], v222 offset:1024
    ds_read_b64_tr_b16 v[126:127], v222 offset:1536
    v_mfma_f32_16x16x32_bf16 v[152:155], v[144:147], v[136:139], v[152:155]
    ds_read_b64_tr_b16 v[128:129], v222 offset:2048
    ds_read_b64_tr_b16 v[130:131], v222 offset:2560
    v_mfma_f32_32x32x16_bf16 v[40:55], v[112:115], v[140:143], v[40:55]
    v_mfma_f32_32x32x16_bf16 v[88:103], v[116:119], v[140:143], v[88:103]
    v_mfma_f32_16x16x32_bf16 v[156:159], v[144:147], v[140:143], v[156:159]
    s_waitcnt lgkmcnt(5)
    v_mfma_f32_32x32x16_bf16 v[8:23], v[120:123], v[104:107], v[8:23]
    ds_read_b128 v[112:115], v219 offset:0
    ds_read_b64_tr_b16 v[132:133], v222 offset:6144
    s_waitcnt lgkmcnt(6)
    v_mfma_f32_32x32x16_bf16 v[56:71], v[120:123], v[108:111], v[56:71]
    ds_read_b64_tr_b16 v[134:135], v222 offset:6656
    ds_read_b128 v[116:119], v219 offset:4096
    s_waitcnt lgkmcnt(6)
    v_mfma_f32_32x32x16_bf16 v[24:39], v[124:127], v[104:107], v[24:39]
    ds_read_b64_tr_b16 v[136:137], v222 offset:7168
    ds_read_b64_tr_b16 v[138:139], v222 offset:7680
    v_mfma_f32_32x32x16_bf16 v[72:87], v[124:127], v[108:111], v[72:87]
    ds_read_b64_tr_b16 v[140:141], v222 offset:8192
    ds_read_b64_tr_b16 v[142:143], v222 offset:8704
    s_waitcnt lgkmcnt(8)
    v_mfma_f32_32x32x16_bf16 v[40:55], v[104:107], v[128:131], v[40:55]
    buffer_store_dword v148, v226, s[16:19], s46 offen sc1
    v_mfma_f32_32x32x16_bf16 v[88:103], v[108:111], v[128:131], v[88:103]
    buffer_store_dword v152, v226, s[16:19], s47 offen sc1
    buffer_store_dword v156, v226, s[16:19], s48 offen sc1
    s_waitcnt lgkmcnt(5)
    v_mfma_f32_32x32x16_bf16 v[8:23], v[132:135], v[112:115], v[8:23]
    ds_read_b128 v[104:107], v220 offset:0
    ds_read_b64_tr_b16 v[120:121], v222 offset:12288
padc3:
    s_cbranch_execz pad3_1
    s_waitcnt lgkmcnt(6)
    v_mfma_f32_32x32x16_bf16 v[56:71], v[132:135], v[116:119], v[56:71]
    ds_read_b64_tr_b16 v[122:123], v222 offset:12800
    ds_read_b128 v[108:111], v220 offset:4096
    s_waitcnt lgkmcnt(6)
    v_mfma_f32_32x32x16_bf16 v[24:39], v[136:139], v[112:115], v[24:39]
    ds_read_b64_tr_b16 v[124:125], v222 offset:13312
    ds_read_b64_tr_b16 v[126:127], v222 offset:13824
    v_mfma_f32_32x32x16_bf16 v[72:87], v[136:139], v[116:119], v[72:87]
    ds_read_b64_tr_b16 v[128:129], v222 offset:14336
    ds_read_b64_tr_b16 v[130:131], v222 offset:14848
    s_waitcnt lgkmcnt(8)
    v_mfma_f32_32x32x16_bf16 v[40:55], v[112:115], v[140:143], v[40:55]
    v_mfma_f32_32x32x16_bf16 v[88:103], v[116:119], v[140:143], v[88:103]
    s_waitcnt lgkmcnt(5)
    v_mfma_f32_32x32x16_bf16 v[8:23], v[120:123], v[104:107], v[8:23]
    ds_read_b128 v[112:115], v221 offset:0
    ds_read_b64_tr_b16 v[132:133], v222 offset:18432
    s_waitcnt lgkmcnt(6)
    v_mfma_f32_32x32x16_bf16 v[56:71], v[120:123], v[108:111], v[56:71]
    ds_read_b64_tr_b16 v[134:135], v222 offset:18944
    ds_read_b128 v[116:119], v221 offset:4096
    s_waitcnt lgkmcnt(6)
    v_mfma_f32_32x32x16_bf16 v[24:39], v[124:127], v[104:107], v[24:39]
    ds_read_b64_tr_b16 v[136:137], v222 offset:19456
    ds_read_b64_tr_b16 v[138:139], v222 offset:19968
    v_mfma_f32_32x32x16_bf16 v[72:87], v[124:127], v[108:111], v[72:87]
    ds_read_b64_tr_b16 v[140:141], v222 offset:20480
    ds_read_b64_tr_b16 v[142:143], v222 offset:20992
    s_waitcnt lgkmcnt(8)
    v_mfma_f32_32x32x16_bf16 v[40:55], v[104:107], v[128:131], v[40:55]
    s_add_u32 s60, s60, 40960
    s_cmp_ge_u32 s60, 163840
    s_cselect_b32 s60, 0, s60
    v_add_u32 v218, s60, v223
    v_add_u32 v222, s60, v224
    v_xor_b32 v219, 32, v218
    v_xor_b32 v220, 64, v218
    v_xor_b32 v221, 96, v218
    v_mfma_f32_32x32x16_bf16 v[88:103], v[108:111], v[128:131], v[88:103]
    s_waitcnt lgkmcnt(5)
    v_mfma_f32_32x32x16_bf16 v[8:23], v[132:135], v[112:115], v[8:23]
    s_waitcnt lgkmcnt(4)
    v_mfma_f32_32x32x16_bf16 v[56:71], v[132:135], v[116:119], v[56:71]
    s_waitcnt lgkmcnt(0)
    s_barrier
    v_mfma_f32_32x32x16_bf16 v[24:39], v[136:139], v[112:115], v[24:39]
    ds_read_b128 v[104:107], v218 offset:0
    ds_read_b64_tr_b16 v[120:121], v222 offset:0
    v_mfma_f32_32x32x16_bf16 v[72:87], v[136:139], v[116:119], v[72:87]
    ds_read_b64_tr_b16 v[122:123], v222 offset:512
    ds_read_b128 v[108:111], v218 offset:4096
    v_mfma_f32_32x32x16_bf16 v[40:55], v[112:115], v[140:143], v[40:55]
    ds_read_b64_tr_b16 v[124:125], v222 offset:1024
    ds_read_b64_tr_b16 v[126:127], v222 offset:1536
    v_mfma_f32_32x32x16_bf16 v[88:103], v[116:119], v[140:143], v[88:103]
    ds_read_b64_tr_b16 v[128:129], v222 offset:2048
    ds_read_b64_tr_b16 v[130:131], v222 offset:2560
    s_mov_b32 s61, 13
    .p2align 4
qkv_loop4:
    s_waitcnt lgkmcnt(5)
    v_mfma_f32_32x32x16_bf16 v[8:23], v[120:123], v[104:107], v[8:23]
    ds_read_b128 v[112:115], v219 offset:0
    ds_read_b64_tr_b16 v[132:133], v222 offset:6144
    s_waitcnt lgkmcnt(6)
    v_mfma_f32_32x32x16_bf16 v[56:71], v[120:123], v[108:111], v[56:71]
    ds_read_b64_tr_b16 v[134:135], v222 offset:6656
    ds_read_b128 v[116:119], v219 offset:4096
    s_waitcnt lgkmcnt(6)
    v_mfma_f32_32x32x16_bf16 v[24:39], v[124:127], v[104:107], v[24:39]
    ds_read_b64_tr_b16 v[136:137], v222 offset:7168
    ds_read_b64_tr_b16 v[138:139], v222 offset:7680
    v_mfma_f32_32x32x16_bf16 v[72:87], v[124:127], v[108:111], v[72:87]
    ds_read_b64_tr_b16 v[140:141], v222 offset:8192
    ds_read_b64_tr_b16 v[142:143], v222 offset:8704
    s_waitcnt lgkmcnt(8)
    v_mfma_f32_32x32x16_bf16 v[40:55], v[104:107], v[128:131], v[40:55]
    v_mfma_f32_32x32x16_bf16 v[88:103], v[108:111], v[128:131], v[88:103]
    s_waitcnt lgkmcnt(5)
    v_mfma_f32_32x32x16_bf16 v[8:23], v[132:135], v[112:115], v[8:23]
    ds_read_b128 v[104:107], v220 offset:0
    ds_read_b64_tr_b16 v[120:121], v222 offset:12288
    s_waitcnt lgkmcnt(6)
    v_mfma_f32_32x32x16_bf16 v[56:71], v[132:135], v[116:119], v[56:71]
    ds_read_b64_tr_b16 v[122:123], v222 offset:12800
    ds_read_b128 v[108:111], v220 offset:4096
    s_waitcnt lgkmcnt(6)
    v_mfma_f32_32x32x16_bf16 v[24:39], v[136:139], v[112:115], v[24:39]
    ds_read_b64_tr_b16 v[124:125], v222 offset:13312
    ds_read_b64_tr_b16 v[126:127], v222 offset:13824
    v_mfma_f32_32x32x16_bf16 v[72:87], v[136:139], v[116:119], v[72:87]
    ds_read_b64_tr_b16 v[128:129], v222 offset:14336
    ds_read_b64_tr_b16 v[130:131], v222 offset:14848
    s_waitcnt lgkmcnt(8)
    v_mfma_f32_32x32x16_bf16 v[40:55], v[112:115], v[140:143], v[40:55]
    v_mfma_f32_32x32x16_bf16 v[88:103], v[116:119], v[140:143], v[88:103]
    s_waitcnt lgkmcnt(5)
    v_mfma_f32_32x32x16_bf16 v[8:23], v[120:123], v[104:107], v[8:23]
    ds_read_b128 v[112:115], v221 offset:0
    ds_read_b64_tr_b16 v[132:133], v222 offset:18432
    s_waitcnt lgkmcnt(6)
    v_mfma_f32_32x32x16_bf16 v[56:71], v[120:123], v[108:111], v[56:71]
    ds_read_b64_tr_b16 v[134:135], v222 offset:18944
    ds_read_b128 v[116:119], v221 offset:4096
    s_waitcnt lgkmcnt(6)
    v_mfma_f32_32x32x16_bf16 v[24:39], v[124:127], v[104:107], v[24:39]
    ds_read_b64_tr_b16 v[136:137], v222 offset:19456
    ds_read_b64_tr_b16 v[138:139], v222 offset:19968
    v_mfma_f32_32x32x16_bf16 v[72:87], v[124:127], v[108:111], v[72:87]
    ds_read_b64_tr_b16 v[140:141], v222 offset:20480
    ds_read_b64_tr_b16 v[142:143], v222 offset:20992
    s_waitcnt lgkmcnt(8)
    v_mfma_f32_32x32x16_bf16 v[40:55], v[104:107], v[128:131], v[40:55]
    s_add_u32 s60, s60, 40960
    s_cmp_ge_u32 s60, 163840
    s_cselect_b32 s60, 0, s60
    v_add_u32 v218, s60, v223
    v_add_u32 v222, s60, v224
    v_xor_b32 v219, 32, v218
    v_xor_b32 v220, 64, v218
    v_xor_b32 v221, 96, v218
    v_mfma_f32_32x32x16_bf16 v[88:103], v[108:111], v[128:131], v[88:103]
    s_waitcnt lgkmcnt(5)
    v_mfma_f32_32x32x16_bf16 v[8:23], v[132:135], v[112:115], v[8:23]
    s_waitcnt lgkmcnt(4)
    v_mfma_f32_32x32x16_bf16 v[56:71], v[132:135], v[116:119], v[56:71]
    s_waitcnt lgkmcnt(0)
    s_cmp_eq_u32 s61, 12
    s_cbranch_scc1 qkv_sig
    s_barrier
qkv_sigdone:
    v_mfma_f32_32x32x16_bf16 v[24:39], v[136:139], v[112:115], v[24:39]
    ds_read_b128 v[104:107], v218 offset:0
    ds_read_b64_tr_b16 v[120:121], v222 offset:0
    v_mfma_f32_32x32x16_bf16 v[72:87], v[136:139], v[116:119], v[72:87]
    ds_read_b64_tr_b16 v[122:123], v222 offset:512
    ds_read_b128 v[108:111], v218 offset:4096
    v_mfma_f32_32x32x16_bf16 v[40:55], v[112:115], v[140:143], v[40:55]
    ds_read_b64_tr_b16 v[124:125], v222 offset:1024
    ds_read_b64_tr_b16 v[126:127], v222 offset:1536
    v_mfma_f32_32x32x16_bf16 v[88:103], v[116:119], v[140:143], v[88:103]
    ds_read_b64_tr_b16 v[128:129], v222 offset:2048
    ds_read_b64_tr_b16 v[130:131], v222 offset:2560
    s_sub_u32 s61, s61, 1
    s_cmp_lg_u32 s61, 0
    s_cbranch_scc1 qkv_loop4
pad3_1:
    s_cbranch_execz pad3_2
    s_waitcnt lgkmcnt(5)
    v_mfma_f32_32x32x16_bf16 v[8:23], v[120:123], v[104:107], v[8:23]
    ds_read_b128 v[112:115], v219 offset:0
    ds_read_b64_tr_b16 v[132:133], v222 offset:6144
    s_waitcnt lgkmcnt(6)
    v_mfma_f32_32x32x16_bf16 v[56:71], v[120:123], v[108:111], v[56:71]
    ds_read_b64_tr_b16 v[134:135], v222 offset:6656
    ds_read_b128 v[116:119], v219 offset:4096
    s_waitcnt lgkmcnt(6)
    v_mfma_f32_32x32x16_bf16 v[24:39], v[124:127], v[104:107], v[24:39]
    ds_read_b64_tr_b16 v[136:137], v222 offset:7168
    ds_read_b64_tr_b16 v[138:139], v222 offset:7680
    v_mfma_f32_32x32x16_bf16 v[72:87], v[124:127], v[108:111], v[72:87]
    ds_read_b64_tr_b16 v[140:141], v222 offset:8192
    ds_read_b64_tr_b16 v[142:143], v222 offset:8704
    s_waitcnt lgkmcnt(8)
    v_mfma_f32_32x32x16_bf16 v[40:55], v[104:107], v[128:131], v[40:55]
    v_mfma_f32_32x32x16_bf16 v[88:103], v[108:111], v[128:131], v[88:103]
    s_waitcnt lgkmcnt(5)
    v_mfma_f32_32x32x16_bf16 v[8:23], v[132:135], v[112:115], v[8:23]
    ds_read_b128 v[104:107], v220 offset:0
    ds_read_b64_tr_b16 v[120:121], v222 offset:12288
    s_waitcnt lgkmcnt(6)
    v_mfma_f32_32x32x16_bf16 v[56:71], v[132:135], v[116:119], v[56:71]
    ds_read_b64_tr_b16 v[122:123], v222 offset:12800
    ds_read_b128 v[108:111], v220 offset:4096
    s_waitcnt lgkmcnt(6)
    v_mfma_f32_32x32x16_bf16 v[24:39], v[136:139], v[112:115], v[24:39]
    ds_read_b64_tr_b16 v[124:125], v222 offset:13312
    ds_read_b64_tr_b16 v[126:127], v222 offset:13824
    v_mfma_f32_32x32x16_bf16 v[72:87], v[136:139], v[116:119], v[72:87]
    ds_read_b64_tr_b16 v[128:129], v222 offset:14336
    ds_read_b64_tr_b16 v[130:131], v222 offset:14848
    s_waitcnt lgkmcnt(8)
    v_mfma_f32_32x32x16_bf16 v[40:55], v[112:115], v[140:143], v[40:55]
    v_mfma_f32_32x32x16_bf16 v[88:103], v[116:119], v[140:143], v[88:103]
    s_waitcnt lgkmcnt(5)
    v_mfma_f32_32x32x16_bf16 v[8:23], v[120:123], v[104:107], v[8:23]
    ds_read_b128 v[112:115], v221 offset:0
    ds_read_b64_tr_b16 v[132:133], v222 offset:18432
    s_waitcnt lgkmcnt(6)
    v_mfma_f32_32x32x16_bf16 v[56:71], v[120:123], v[108:111], v[56:71]
    ds_read_b64_tr_b16 v[134:135], v222 offset:18944
    ds_read_b128 v[116:119], v221 offset:4096
    s_waitcnt lgkmcnt(6)
    v_mfma_f32_32x32x16_bf16 v[24:39], v[124:127], v[104:107], v[24:39]
    ds_read_b64_tr_b16 v[136:137], v222 offset:19456
    ds_read_b64_tr_b16 v[138:139], v222 offset:19968
    v_mfma_f32_32x32x16_bf16 v[72:87], v[124:127], v[108:111], v[72:87]
    ds_read_b64_tr_b16 v[140:141], v222 offset:20480
    ds_read_b64_tr_b16 v[142:143], v222 offset:20992
    s_waitcnt lgkmcnt(8)
    v_mfma_f32_32x32x16_bf16 v[40:55], v[104:107], v[128:131], v[40:55]
    v_mfma_f32_32x32x16_bf16 v[88:103], v[108:111], v[128:131], v[88:103]
    s_waitcnt lgkmcnt(5)
    v_mfma_f32_32x32x16_bf16 v[8:23], v[132:135], v[112:115], v[8:23]
    ds_read_b32 v208, v6 offset:0
    ds_read_b32 v209, v6 offset:512
    s_waitcnt lgkmcnt(6)
    v_mfma_f32_32x32x16_bf16 v[56:71], v[132:135], v[116:119], v[56:71]
    ds_read_b32 v210, v6 offset:128
    ds_read_b32 v211, v6 offset:640
    s_waitcnt lgkmcnt(6)
    v_mfma_f32_32x32x16_bf16 v[24:39], v[136:139], v[112:115], v[24:39]
    ds_read_b128 v[160:163], v5 offset:1280
    ds_read_b128 v[164:167], v5 offset:1312
    v_mfma_f32_32x32x16_bf16 v[72:87], v[136:139], v[116:119], v[72:87]
pad3_2:
    s_cbranch_execz pad3_3
    ds_read_b128 v[168:171], v5 offset:1344
    ds_read_b128 v[172:175], v5 offset:1376
    s_waitcnt lgkmcnt(8)
    v_mfma_f32_32x32x16_bf16 v[40:55], v[112:115], v[140:143], v[40:55]
    ds_read_b128 v[144:147], v5 offset:1024
    ds_read_b128 v[148:151], v5 offset:1056
    v_mfma_f32_32x32x16_bf16 v[88:103], v[116:119], v[140:143], v[88:103]
    ds_read_b128 v[152:155], v5 offset:1088
    ds_read_b128 v[156:159], v5 offset:1120
    ds_read_b32 v216, v7 offset:1536
    ds_read_b128 v[176:179], v4 offset:0
    ds_read_b128 v[192:195], v4 offset:512
    ds_read_b128 v[180:183], v4 offset:32
    ds_read_b128 v[196:199], v4 offset:544
    ds_read_b128 v[184:187], v4 offset:64
    ds_read_b128 v[200:203], v4 offset:576
    ds_read_b128 v[188:191], v4 offset:96
    ds_read_b128 v[204:207], v4 offset:608
    s_mov_b32 s37, 0x3e8293ee
    ds_read_b128 v[104:107], v4 offset:128
    ds_read_b128 v[120:123], v4 offset:640
    ds_read_b128 v[108:111], v4 offset:160
    ds_read_b128 v[124:127], v4 offset:672
    ds_read_b128 v[112:115], v4 offset:192
    ds_read_b128 v[128:131], v4 offset:704
    ds_read_b128 v[116:119], v4 offset:224
    ds_read_b128 v[132:135], v4 offset:736
    s_waitcnt lgkmcnt(15)
    v_mul_f32 v212, s37, v208
    v_mul_f32 v213, s37, v209
    v_mul_f32 v214, s37, v210
    v_mul_f32 v215, s37, v211
    v_pk_mul_f32 v[24:25], v[24:25], v[208:209] op_sel_hi:[1,0]
    v_pk_mul_f32 v[26:27], v[26:27], v[208:209] op_sel_hi:[1,0]
    v_pk_mul_f32 v[28:29], v[28:29], v[208:209] op_sel_hi:[1,0]
    v_pk_mul_f32 v[30:31], v[30:31], v[208:209] op_sel_hi:[1,0]
    v_pk_mul_f32 v[32:33], v[32:33], v[208:209] op_sel_hi:[1,0]
    v_pk_mul_f32 v[34:35], v[34:35], v[208:209] op_sel_hi:[1,0]
    v_pk_mul_f32 v[36:37], v[36:37], v[208:209] op_sel_hi:[1,0]
    v_pk_mul_f32 v[38:39], v[38:39], v[208:209] op_sel_hi:[1,0]
    v_pk_fma_f32 v[24:25], v[160:161], v[208:209], v[24:25] op_sel:[0,1,0] op_sel_hi:[1,1,1]
    v_pk_fma_f32 v[26:27], v[162:163], v[208:209], v[26:27] op_sel:[0,1,0] op_sel_hi:[1,1,1]
    v_pk_fma_f32 v[28:29], v[164:165], v[208:209], v[28:29] op_sel:[0,1,0] op_sel_hi:[1,1,1]
    v_pk_fma_f32 v[30:31], v[166:167], v[208:209], v[30:31] op_sel:[0,1,0] op_sel_hi:[1,1,1]
    v_pk_fma_f32 v[32:33], v[168:169], v[208:209], v[32:33] op_sel:[0,1,0] op_sel_hi:[1,1,1]
    v_pk_fma_f32 v[34:35], v[170:171], v[208:209], v[34:35] op_sel:[0,1,0] op_sel_hi:[1,1,1]
    v_pk_fma_f32 v[36:37], v[172:173], v[208:209], v[36:37] op_sel:[0,1,0] op_sel_hi:[1,1,1]
    v_pk_fma_f32 v[38:39], v[174:175], v[208:209], v[38:39] op_sel:[0,1,0] op_sel_hi:[1,1,1]
    v_cvt_pk_bf16_f32 v24, v24, v25
    v_cvt_pk_bf16_f32 v25, v26, v27
    v_cvt_pk_bf16_f32 v26, v28, v29
    v_cvt_pk_bf16_f32 v27, v30, v31
    v_cvt_pk_bf16_f32 v28, v32, v33
    v_cvt_pk_bf16_f32 v29, v34, v35
    v_cvt_pk_bf16_f32 v30, v36, v37
    v_cvt_pk_bf16_f32 v31, v38, v39
    buffer_store_dwordx4 v[24:27], v225, s[8:11], s35 offen offset:0 sc1
    buffer_store_dwordx4 v[28:31], v225, s[8:11], s35 offen offset:1024 sc1
    v_pk_mul_f32 v[72:73], v[72:73], v[210:211] op_sel_hi:[1,0]
    v_pk_mul_f32 v[74:75], v[74:75], v[210:211] op_sel_hi:[1,0]
    v_pk_mul_f32 v[76:77], v[76:77], v[210:211] op_sel_hi:[1,0]
    v_pk_mul_f32 v[78:79], v[78:79], v[210:211] op_sel_hi:[1,0]
    v_pk_mul_f32 v[80:81], v[80:81], v[210:211] op_sel_hi:[1,0]
    v_pk_mul_f32 v[82:83], v[82:83], v[210:211] op_sel_hi:[1,0]
    v_pk_mul_f32 v[84:85], v[84:85], v[210:211] op_sel_hi:[1,0]
    v_pk_mul_f32 v[86:87], v[86:87], v[210:211] op_sel_hi:[1,0]
    v_pk_fma_f32 v[72:73], v[160:161], v[210:211], v[72:73] op_sel:[0,1,0] op_sel_hi:[1,1,1]
pad3_3:
    s_cbranch_execz pad3_4
    v_pk_fma_f32 v[74:75], v[162:163], v[210:211], v[74:75] op_sel:[0,1,0] op_sel_hi:[1,1,1]
    v_pk_fma_f32 v[76:77], v[164:165], v[210:211], v[76:77] op_sel:[0,1,0] op_sel_hi:[1,1,1]
    v_pk_fma_f32 v[78:79], v[166:167], v[210:211], v[78:79] op_sel:[0,1,0] op_sel_hi:[1,1,1]
    v_pk_fma_f32 v[80:81], v[168:169], v[210:211], v[80:81] op_sel:[0,1,0] op_sel_hi:[1,1,1]
    v_pk_fma_f32 v[82:83], v[170:171], v[210:211], v[82:83] op_sel:[0,1,0] op_sel_hi:[1,1,1]
    v_pk_fma_f32 v[84:85], v[172:173], v[210:211], v[84:85] op_sel:[0,1,0] op_sel_hi:[1,1,1]
    v_pk_fma_f32 v[86:87], v[174:175], v[210:211], v[86:87] op_sel:[0,1,0] op_sel_hi:[1,1,1]
    v_cvt_pk_bf16_f32 v72, v72, v73
    v_cvt_pk_bf16_f32 v73, v74, v75
    v_cvt_pk_bf16_f32 v74, v76, v77
    v_cvt_pk_bf16_f32 v75, v78, v79
    v_cvt_pk_bf16_f32 v76, v80, v81
    v_cvt_pk_bf16_f32 v77, v82, v83
    v_cvt_pk_bf16_f32 v78, v84, v85
    v_cvt_pk_bf16_f32 v79, v86, v87
    buffer_store_dwordx4 v[72:75], v225, s[8:11], s35 offen offset:2048 sc1
    buffer_store_dwordx4 v[76:79], v225, s[8:11], s35 offen offset:3072 sc1
    v_pk_mul_f32 v[8:9], v[8:9], v[212:213] op_sel_hi:[1,0]
    v_pk_mul_f32 v[10:11], v[10:11], v[212:213] op_sel_hi:[1,0]
    v_pk_mul_f32 v[12:13], v[12:13], v[212:213] op_sel_hi:[1,0]
    v_pk_mul_f32 v[14:15], v[14:15], v[212:213] op_sel_hi:[1,0]
    v_pk_mul_f32 v[16:17], v[16:17], v[212:213] op_sel_hi:[1,0]
    v_pk_mul_f32 v[18:19], v[18:19], v[212:213] op_sel_hi:[1,0]
    v_pk_mul_f32 v[20:21], v[20:21], v[212:213] op_sel_hi:[1,0]
    v_pk_mul_f32 v[22:23], v[22:23], v[212:213] op_sel_hi:[1,0]
    v_pk_fma_f32 v[8:9], v[144:145], v[212:213], v[8:9] op_sel:[0,1,0] op_sel_hi:[1,1,1]
    v_pk_fma_f32 v[10:11], v[146:147], v[212:213], v[10:11] op_sel:[0,1,0] op_sel_hi:[1,1,1]
    v_pk_fma_f32 v[12:13], v[148:149], v[212:213], v[12:13] op_sel:[0,1,0] op_sel_hi:[1,1,1]
    v_pk_fma_f32 v[14:15], v[150:151], v[212:213], v[14:15] op_sel:[0,1,0] op_sel_hi:[1,1,1]
    v_pk_fma_f32 v[16:17], v[152:153], v[212:213], v[16:17] op_sel:[0,1,0] op_sel_hi:[1,1,1]
    v_pk_fma_f32 v[18:19], v[154:155], v[212:213], v[18:19] op_sel:[0,1,0] op_sel_hi:[1,1,1]
    v_pk_fma_f32 v[20:21], v[156:157], v[212:213], v[20:21] op_sel:[0,1,0] op_sel_hi:[1,1,1]
    v_pk_fma_f32 v[22:23], v[158:159], v[212:213], v[22:23] op_sel:[0,1,0] op_sel_hi:[1,1,1]
    v_cvt_pk_bf16_f32 v8, v8, v9
    v_cvt_pk_bf16_f32 v9, v10, v11
    v_cvt_pk_bf16_f32 v10, v12, v13
    v_cvt_pk_bf16_f32 v11, v14, v15
    v_cvt_pk_bf16_f32 v12, v16, v17
    v_cvt_pk_bf16_f32 v13, v18, v19
    v_cvt_pk_bf16_f32 v14, v20, v21
    v_cvt_pk_bf16_f32 v15, v22, v23
    buffer_store_dwordx4 v[8:11], v225, s[8:11], s34 offen offset:0 sc1
    buffer_store_dwordx4 v[12:15], v225, s[8:11], s34 offen offset:1024 sc1
    v_pk_mul_f32 v[56:57], v[56:57], v[214:215] op_sel_hi:[1,0]
    v_pk_mul_f32 v[58:59], v[58:59], v[214:215] op_sel_hi:[1,0]
    v_pk_mul_f32 v[60:61], v[60:61], v[214:215] op_sel_hi:[1,0]
    v_pk_mul_f32 v[62:63], v[62:63], v[214:215] op_sel_hi:[1,0]
    v_pk_mul_f32 v[64:65], v[64:65], v[214:215] op_sel_hi:[1,0]
    v_pk_mul_f32 v[66:67], v[66:67], v[214:215] op_sel_hi:[1,0]
    v_pk_mul_f32 v[68:69], v[68:69], v[214:215] op_sel_hi:[1,0]
    v_pk_mul_f32 v[70:71], v[70:71], v[214:215] op_sel_hi:[1,0]
    v_pk_fma_f32 v[56:57], v[144:145], v[214:215], v[56:57] op_sel:[0,1,0] op_sel_hi:[1,1,1]
    v_pk_fma_f32 v[58:59], v[146:147], v[214:215], v[58:59] op_sel:[0,1,0] op_sel_hi:[1,1,1]
    v_pk_fma_f32 v[60:61], v[148:149], v[214:215], v[60:61] op_sel:[0,1,0] op_sel_hi:[1,1,1]
    v_pk_fma_f32 v[62:63], v[150:151], v[214:215], v[62:63] op_sel:[0,1,0] op_sel_hi:[1,1,1]
    v_pk_fma_f32 v[64:65], v[152:153], v[214:215], v[64:65] op_sel:[0,1,0] op_sel_hi:[1,1,1]
    v_pk_fma_f32 v[66:67], v[154:155], v[214:215], v[66:67] op_sel:[0,1,0] op_sel_hi:[1,1,1]
    v_pk_fma_f32 v[68:69], v[156:157], v[214:215], v[68:69] op_sel:[0,1,0] op_sel_hi:[1,1,1]
    v_pk_fma_f32 v[70:71], v[158:159], v[214:215], v[70:71] op_sel:[0,1,0] op_sel_hi:[1,1,1]
    v_cvt_pk_bf16_f32 v56, v56, v57
    v_cvt_pk_bf16_f32 v57, v58, v59
    v_cvt_pk_bf16_f32 v58, v60, v61
    v_cvt_pk_bf16_f32 v59, v62, v63
pad3_4:
    s_cbranch_execz pad3_5
    v_cvt_pk_bf16_f32 v60, v64, v65
    v_cvt_pk_bf16_f32 v61, v66, v67
    v_cvt_pk_bf16_f32 v62, v68, v69
    v_cvt_pk_bf16_f32 v63, v70, v71
    buffer_store_dwordx4 v[56:59], v225, s[8:11], s34 offen offset:2048 sc1
    buffer_store_dwordx4 v[60:63], v225, s[8:11], s34 offen offset:3072 sc1
    s_waitcnt lgkmcnt(8)
    v_pk_mul_f32 v[40:41], v[40:41], v[176:177]
    v_pk_mul_f32 v[42:43], v[42:43], v[178:179]
    v_pk_mul_f32 v[44:45], v[44:45], v[180:181]
    v_pk_mul_f32 v[46:47], v[46:47], v[182:183]
    v_pk_mul_f32 v[48:49], v[48:49], v[184:185]
    v_pk_mul_f32 v[50:51], v[50:51], v[186:187]
    v_pk_mul_f32 v[52:53], v[52:53], v[188:189]
    v_pk_mul_f32 v[54:55], v[54:55], v[190:191]
    v_pk_fma_f32 v[40:41], v[192:193], v[216:217], v[40:41] op_sel_hi:[1,0,1]
    v_pk_fma_f32 v[42:43], v[194:195], v[216:217], v[42:43] op_sel_hi:[1,0,1]
    v_pk_fma_f32 v[44:45], v[196:197], v[216:217], v[44:45] op_sel_hi:[1,0,1]
    v_pk_fma_f32 v[46:47], v[198:199], v[216:217], v[46:47] op_sel_hi:[1,0,1]
    v_pk_fma_f32 v[48:49], v[200:201], v[216:217], v[48:49] op_sel_hi:[1,0,1]
    v_pk_fma_f32 v[50:51], v[202:203], v[216:217], v[50:51] op_sel_hi:[1,0,1]
    v_pk_fma_f32 v[52:53], v[204:205], v[216:217], v[52:53] op_sel_hi:[1,0,1]
    v_pk_fma_f32 v[54:55], v[206:207], v[216:217], v[54:55] op_sel_hi:[1,0,1]
    v_cvt_pk_bf16_f32 v40, v40, v41
    v_cvt_pk_bf16_f32 v41, v42, v43
    v_cvt_pk_bf16_f32 v42, v44, v45
    v_cvt_pk_bf16_f32 v43, v46, v47
    v_cvt_pk_bf16_f32 v44, v48, v49
    v_cvt_pk_bf16_f32 v45, v50, v51
    v_cvt_pk_bf16_f32 v46, v52, v53
    v_cvt_pk_bf16_f32 v47, v54, v55
    buffer_store_dwordx4 v[40:43], v225, s[8:11], s36 offen offset:0 sc1
    buffer_store_dwordx4 v[44:47], v225, s[8:11], s36 offen offset:1024 sc1
    s_waitcnt lgkmcnt(0)
    v_pk_mul_f32 v[88:89], v[88:89], v[104:105]
    v_pk_mul_f32 v[90:91], v[90:91], v[106:107]
    v_pk_mul_f32 v[92:93], v[92:93], v[108:109]
    v_pk_mul_f32 v[94:95], v[94:95], v[110:111]
    v_pk_mul_f32 v[96:97], v[96:97], v[112:113]
    v_pk_mul_f32 v[98:99], v[98:99], v[114:115]
    v_pk_mul_f32 v[100:101], v[100:101], v[116:117]
    v_pk_mul_f32 v[102:103], v[102:103], v[118:119]
    v_pk_fma_f32 v[88:89], v[120:121], v[216:217], v[88:89] op_sel_hi:[1,0,1]
    v_pk_fma_f32 v[90:91], v[122:123], v[216:217], v[90:91] op_sel_hi:[1,0,1]
    v_pk_fma_f32 v[92:93], v[124:125], v[216:217], v[92:93] op_sel_hi:[1,0,1]
    v_pk_fma_f32 v[94:95], v[126:127], v[216:217], v[94:95] op_sel_hi:[1,0,1]
    v_pk_fma_f32 v[96:97], v[128:129], v[216:217], v[96:97] op_sel_hi:[1,0,1]
    v_pk_fma_f32 v[98:99], v[130:131], v[216:217], v[98:99] op_sel_hi:[1,0,1]
    v_pk_fma_f32 v[100:101], v[132:133], v[216:217], v[100:101] op_sel_hi:[1,0,1]
    v_pk_fma_f32 v[102:103], v[134:135], v[216:217], v[102:103] op_sel_hi:[1,0,1]
    v_cvt_pk_bf16_f32 v88, v88, v89
    v_cvt_pk_bf16_f32 v89, v90, v91
    v_cvt_pk_bf16_f32 v90, v92, v93
    v_cvt_pk_bf16_f32 v91, v94, v95
    v_cvt_pk_bf16_f32 v92, v96, v97
    v_cvt_pk_bf16_f32 v93, v98, v99
    v_cvt_pk_bf16_f32 v94, v100, v101
    v_cvt_pk_bf16_f32 v95, v102, v103
    buffer_store_dwordx4 v[88:91], v225, s[8:11], s36 offen offset:2048 sc1
    buffer_store_dwordx4 v[92:95], v225, s[8:11], s36 offen offset:3072 sc1
    s_mov_b64 exec, -1
    s_add_u32 s96, s86, 0x4400000
    s_addc_u32 s97, s87, 0
    s_mov_b32 s98, 0x8000
    s_mov_b32 s99, 0x00020000
    v_mov_b32 v218, 2048
pad3_5:
    s_cbranch_execz qkv_warm_ret
    v_mov_b32 v219, 1
    s_lshl_b32 s38, s52, 11
    s_add_u32 s38, s38, 96
    s_lshl_b32 s39, s53, 11
    s_add_u32 s39, s39, -1936
    v_mov_b32 v220, s38
    v_mov_b32 v221, s39
    v_cmp_lt_u32 vcc, 15, v0
    s_nop 1
    v_cndmask_b32 v220, v220, v221, vcc
    v_lshl_add_u32 v220, v0, 7, v220
    v_add_u32 v220, s30, v220
    s_lshl_b32 s38, s31, 4
    s_lshr_b32 s39, s30, 1
    s_add_u32 s38, s38, s39
    s_lshl_b32 s38, s38, 7
    s_and_b32 s39, s30, 1
    s_add_u32 s38, s38, s39
    s_add_u32 s38, s38, -32676
    v_lshlrev_b32 v221, 10, v0
    v_add_u32 v221, s38, v221
    v_cmp_lt_u32 vcc, 31, v0
    s_nop 1
    v_cndmask_b32 v220, v220, v221, vcc
    s_mov_b64 exec, 1
    s_waitcnt vmcnt(0)
    ds_add_rtn_u32 v218, v218, v219
    s_waitcnt lgkmcnt(0)
    v_readfirstlane_b32 s89, v218
    s_nop 0
    s_cmp_eq_u32 s89, 7
    s_cbranch_scc0 qkv_sg5
    s_bfm_b64 exec, 34, 0
    buffer_store_byte v219, v220, s[96:99], 0 offen sc1
qkv_sg5:
    s_mov_b64 exec, -1
    s_branch attn_begin
qkv_sig:
    s_cmp_ge_u32 s3, 2
    s_cbranch_scc1 qkv_sigb
    s_waitcnt vmcnt(0)
qkv_sigb:
    s_barrier
    buffer_atomic_or v228, v227, s[20:23], s45 offen sc1
    s_branch qkv_sigdone
attn_begin:
padc4:
    s_cbranch_execz pad4_1
    s_mov_b64 exec, -1
    s_mov_b32 s3, s93
    s_mov_b64 s[6:7], s[86:87]
    s_mov_b64 s[44:45], s[76:77]
    s_mov_b64 s[46:47], s[78:79]
    s_mov_b64 s[48:49], s[80:81]
    s_mov_b64 s[50:51], s[72:73]
    s_lshl_b32 s30, s90, 2
    s_lshr_b32 s31, s91, 3
    s_add_u32 s30, s30, s31
    s_and_b32 s31, s91, 7
    s_lshl_b32 s32, s30, 17
    s_lshl_b32 s33, s31, 3
    s_add_u32 s33, s33, s3
    v_lshlrev_b32 v132, 4, v0
    s_lshl_b32 s34, s3, 10
    v_add_u32 v133, s34, v132
    s_lshl_b32 s35, s33, 11
    s_waitcnt lgkmcnt(0)
    s_add_u32 s8, s6, 0x400000
    s_addc_u32 s9, s7, 0
    s_add_u32 s8, s8, s32
    s_addc_u32 s9, s9, 0
    s_mov_b32 s10, 0x20000
    s_mov_b32 s11, 0x00020000
    s_add_u32 s12, s6, 0x800000
    s_addc_u32 s13, s7, 0
    s_add_u32 s12, s12, s32
    s_addc_u32 s13, s13, 0
    s_mov_b32 s14, 0x20000
    s_mov_b32 s15, 0x00020000
    s_add_u32 s16, s6, 0xc00000
    s_addc_u32 s17, s7, 0
    s_add_u32 s16, s16, s32
    s_addc_u32 s17, s17, 0
    s_mov_b32 s18, 0x20000
    s_mov_b32 s19, 0x00020000
    s_mov_b32 s56, s50
    s_mov_b32 s57, s51
    s_mov_b32 s58, 0x200000
    s_mov_b32 s59, 0x00020000
    s_lshl_b32 s38, s91, 3
    s_add_u32 s38, s38, s3
    s_lshl_b32 s38, s38, 13
    s_and_b32 s39, s90, 1
    s_lshl_b32 s39, s39, 10
    s_add_u32 s43, s38, s39
    v_lshrrev_b32 v1, 4, v0
    v_and_b32 v2, 15, v0
    v_lshlrev_b32 v2, 6, v2
    v_lshl_add_u32 v134, v1, 11, v2
    s_lshl_b32 s94, s31, 5
    s_lshl_b32 s94, s94, 7
    s_add_u32 s94, s94, s30
    v_lshrrev_b32 v1, 5, v0
    v_lshlrev_b32 v1, 2, v1
    v_bfe_u32 v2, v0, 2, 2
    v_add_u32 v1, v1, v2
    s_mov_b32 s92, 2048
    v_mul_lo_u32 v135, v1, s92
    v_bfe_u32 v1, v0, 4, 1
    v_lshlrev_b32 v1, 6, v1
    v_and_b32 v2, 3, v0
    v_lshlrev_b32 v2, 4, v2
    v_add3_u32 v135, v135, v1, v2
    s_lshl_b32 s38, s31, 7
    s_add_u32 s38, s38, s39
    s_lshl_b32 s39, s3, 14
    s_add_u32 s38, s38, s39
    v_add_u32 v135, s38, v135
    s_lshr_b32 s38, s3, 1
    s_movk_i32 s62, 14336
    s_cmp_eq_u32 s38, 1
    s_cselect_b32 s44, s46, s44
    s_cselect_b32 s45, s47, s45
    s_cmp_eq_u32 s38, 2
    s_cselect_b32 s44, s48, s44
    s_cselect_b32 s45, s49, s45
    s_cmp_eq_u32 s38, 3
    s_cselect_b32 s44, s50, s44
    s_cselect_b32 s45, s51, s45
    s_cselect_b32 s62, 4096, s62
    s_lshl_b32 s38, s2, 1
    s_and_b32 s39, s3, 1
    s_add_u32 s38, s38, s39
    s_lshr_b32 s39, s38, 5
    s_lshl_b32 s39, s39, 7
    s_and_b32 s40, s38, 31
    s_mul_i32 s40, s40, 229376
    s_add_u32 s39, s39, s40
    s_mul_i32 s38, s38, s62
    s_lshr_b32 s40, s3, 1
    s_cmp_eq_u32 s40, 99
    s_cselect_b32 s38, s39, s38
    s_cselect_b32 s62, 227456, s62
    s_add_u32 s60, s44, s38
    s_addc_u32 s61, s45, 0
    s_mov_b32 s63, 0x00020000
    s_mov_b32 s41, 0
    s_mov_b32 s44, 0
    s_add_u32 s45, s34, 81920
pad4_1:
    s_cbranch_execz pad4_2
    s_getpc_b64 s[24:25]
qkv_here6:
    s_add_u32 s24, s24, gu_begin-qkv_here6
    s_addc_u32 s25, s25, 0
    s_mov_b32 s26, code_end-gu_begin
    s_mov_b32 s27, 0x00020000
    v_lshlrev_b32 v136, 7, v0
    s_mul_i32 s28, s3, (code_end-gu_begin)/8
    s_add_u32 s20, s6, 0x2900000
    s_addc_u32 s21, s7, 0
    s_mov_b32 s22, 0x50000
    s_mov_b32 s23, 0x00020000
    s_lshl_b32 s38, s31, 5
    s_add_u32 s38, s38, s30
    s_lshl_b32 s38, s38, 3
    s_add_u32 s38, s38, s3
    s_lshl_b32 s38, s38, 11
    s_mov_b32 s42, 0
    s_add_u32 s96, s6, 0x4000000
    s_addc_u32 s97, s7, 0
    s_add_u32 s96, s96, s38
    s_addc_u32 s97, s97, 0
    s_mov_b32 s98, 0x800
    s_mov_b32 s99, 0x00020000
    v_mov_b32 v128, -1
    v_mov_b32 v129, -1
    v_mov_b32 v130, -1
    v_mov_b32 v131, -1
    v_bfe_u32 v1, v0, 2, 1
    v_bfe_u32 v2, v0, 4, 1
    v_cmp_eq_u32 vcc, v1, v2
    v_mov_b32 v1, 0x3f803f80
    s_nop 0
    v_cndmask_b32 v88, 0, v1, vcc
    v_mov_b32 v89, v88
    v_mov_b32 v90, v88
    v_mov_b32 v91, v88
    s_cmp_eq_u32 s3, 7
    s_cbranch_scc0 attn_polled
    s_lshl_b32 s38, s30, 3
    s_add_u32 s38, s38, s31
    s_lshl_b32 s38, s38, 7
    s_add_u32 s46, s86, s38
    s_addc_u32 s47, s87, 0
    s_add_u32 s46, s46, 0x4400000
    s_addc_u32 s47, s47, 0
    s_mov_b32 s38, 0x40000
attn_poll:
    s_load_dwordx8 s[48:55], s[46:47], 96 glc
    s_load_dword s39, s[46:47], 92 glc
    s_waitcnt lgkmcnt(0)
    s_cmp_eq_u32 s39, 0x0101
    s_cbranch_scc1 attn_polled
    s_sub_u32 s38, s38, 1
    s_cbranch_scc0 attn_poll
attn_polled:
    s_barrier
    buffer_load_dwordx4 v[4:7], v132, s[8:11], s35 offen sc1
    buffer_load_dwordx4 v[8:11], v132, s[8:11], s35 offen offset:1024 sc1
    s_mov_b32 s36, 1
    s_mov_b32 s37, 0
    s_cmp_eq_u32 s3, 7
    s_cbranch_scc0 attn_polled2
attn_poll2:
    s_and_b32 s48, s48, s49
    s_and_b32 s50, s50, s51
    s_and_b32 s52, s52, s53
    s_and_b32 s54, s54, s55
    s_and_b32 s48, s48, s50
    s_and_b32 s52, s52, s54
    s_and_b32 s48, s48, s52
    s_cmp_eq_u32 s48, 0x01010101
    s_cbranch_scc1 attn_polled2
    s_load_dwordx8 s[48:55], s[46:47], 96 glc
    s_waitcnt lgkmcnt(0)
    s_sub_u32 s38, s38, 1
    s_cbranch_scc0 attn_poll2
attn_polled2:
    s_barrier
    s_add_u32 m0, s34, 0
    s_nop 0
    buffer_load_dwordx4 v133, s[12:15], s37 offen sc1 lds
    s_add_u32 m0, s34, 8192
    s_nop 0
    buffer_load_dwordx4 v133, s[16:19], s37 offen sc1 lds
    s_add_u32 s37, s37, 8192
    v_lshlrev_b32 v1, 2, v0
    v_add_u32 v1, 163584, v1
    v_mov_b32 v2, 0
    ds_write_b32 v1, v2
    s_branch attn_go
attn_restart:
    s_mov_b32 s38, 0
    v_mov_b32 v12, 0xff800000
attn_scan:
    buffer_load_dwordx4 v[92:95], v132, s[12:15], s38 offen sc1
    buffer_load_dwordx4 v[96:99], v132, s[12:15], s38 offen offset:1024 sc1
    s_waitcnt vmcnt(0)
    v_mfma_f32_32x32x16_bf16 v[28:43], v[92:95], v[4:7], 0
    v_mfma_f32_32x32x16_bf16 v[28:43], v[96:99], v[8:11], v[28:43]
    s_add_u32 s38, s38, 2048
pad4_2:
    s_cbranch_execz pad4_3
    s_nop 10
    v_max3_f32 v12, v28, v29, v12
    v_max3_f32 v12, v30, v31, v12
    v_max3_f32 v12, v32, v33, v12
    v_max3_f32 v12, v34, v35, v12
    v_max3_f32 v12, v36, v37, v12
    v_max3_f32 v12, v38, v39, v12
    v_max3_f32 v12, v40, v41, v12
    v_max3_f32 v12, v42, v43, v12
    s_cmp_lg_u32 s38, 131072
    s_cbranch_scc1 attn_scan
    s_mov_b32 s37, 0
    s_add_u32 m0, s34, 0
    s_nop 0
    buffer_load_dwordx4 v133, s[12:15], s37 offen sc1 lds
    s_add_u32 m0, s34, 8192
    s_nop 0
    buffer_load_dwordx4 v133, s[16:19], s37 offen sc1 lds
    s_add_u32 s37, s37, 8192
attn_go:
    s_add_u32 m0, s34, 16384
    s_nop 0
    buffer_load_dwordx4 v133, s[12:15], s37 offen sc1 lds
    s_add_u32 m0, s34, 24576
    s_nop 0
    buffer_load_dwordx4 v133, s[16:19], s37 offen sc1 lds
    s_add_u32 s37, s37, 8192
    v_mov_b32 v68, 0
    v_mov_b32 v69, 0
    v_mov_b32 v70, 0
    v_mov_b32 v71, 0
    v_mov_b32 v72, 0
    v_mov_b32 v73, 0
    v_mov_b32 v74, 0
    v_mov_b32 v75, 0
    v_mov_b32 v76, 0
    v_mov_b32 v77, 0
    v_mov_b32 v78, 0
    v_mov_b32 v79, 0
    v_mov_b32 v80, 0
    v_mov_b32 v81, 0
    v_mov_b32 v82, 0
    v_mov_b32 v83, 0
    v_mov_b32 v84, 0
    v_mov_b32 v85, 0
    v_mov_b32 v86, 0
    v_mov_b32 v87, 0
    v_mov_b32 v64, 0
    v_mov_b32 v65, 0
    v_mov_b32 v66, 0
    v_mov_b32 v67, 0
    v_mov_b32 v104, 0
    v_mov_b32 v105, 0
    v_mov_b32 v106, 0
    v_mov_b32 v107, 0
    s_waitcnt vmcnt(2) lgkmcnt(0)
    s_barrier
    ds_read_b128 v[92:95], v132
    ds_read_b128 v[96:99], v132 offset:1024
    ds_read_b128 v[100:103], v132 offset:8192
    s_add_u32 m0, s34, 32768
    s_nop 0
    buffer_load_dwordx4 v133, s[12:15], s37 offen sc1 lds
    s_add_u32 m0, s34, 40960
    s_nop 0
    buffer_load_dwordx4 v133, s[16:19], s37 offen sc1 lds
    s_add_u32 s37, s37, 8192
    s_lshl_b32 s40, s30, 7
    s_add_u32 s40, s40, 16384
    v_lshrrev_b32 v3, 5, v0
    v_lshlrev_b32 v3, 5, v3
    buffer_load_dwordx4 v[108:111], v3, s[20:23], s40 offen offset:0 sc1
    buffer_load_dwordx4 v[112:115], v3, s[20:23], s40 offen offset:16 sc1
    buffer_load_dwordx4 v[116:119], v3, s[20:23], s40 offen offset:64 sc1
    buffer_load_dwordx4 v[120:123], v3, s[20:23], s40 offen offset:80 sc1
    s_waitcnt lgkmcnt(2)
    v_mfma_f32_32x32x16_bf16 v[28:43], v[92:95], v[4:7], 0
    s_waitcnt lgkmcnt(1)
    v_mfma_f32_32x32x16_bf16 v[28:43], v[96:99], v[8:11], v[28:43]
    ds_read_b128 v[92:95], v132 offset:2048
    ds_read_b128 v[96:99], v132 offset:3072
    s_mov_b32 s39, 4
    s_cmp_lg_u32 s36, 1
    s_cbranch_scc1 attn_havemax
    s_nop 6
    v_max_f32 v12, v28, v29
    v_max3_f32 v12, v30, v31, v12
    v_max3_f32 v12, v32, v33, v12
    v_max3_f32 v12, v34, v35, v12
pad4_3:
    s_cbranch_execz qkv_ld_ret
    v_max3_f32 v12, v36, v37, v12
    v_max3_f32 v12, v38, v39, v12
    v_max3_f32 v12, v40, v41, v12
    v_max3_f32 v12, v42, v43, v12
attn_havemax:
    v_mov_b32 v1, v12
    s_nop 1
    v_permlane32_swap_b32 v12, v1
    v_max_f32 v1, v12, v1
    v_sub_f32 v12, 0, v1
    v_sub_f32 v13, 0, v1
    v_sub_f32 v14, 0, v1
    v_sub_f32 v15, 0, v1
    v_sub_f32 v16, 0, v1
    v_sub_f32 v17, 0, v1
    v_sub_f32 v18, 0, v1
    v_sub_f32 v19, 0, v1
    v_sub_f32 v20, 0, v1
    v_sub_f32 v21, 0, v1
    v_sub_f32 v22, 0, v1
    v_sub_f32 v23, 0, v1
    v_sub_f32 v24, 0, v1
    v_sub_f32 v25, 0, v1
    v_sub_f32 v26, 0, v1
    v_sub_f32 v27, 0, v1
    v_sub_f32 v28, v28, v1
    v_sub_f32 v29, v29, v1
    v_sub_f32 v30, v30, v1
    v_sub_f32 v31, v31, v1
    v_sub_f32 v32, v32, v1
    v_sub_f32 v33, v33, v1
    v_sub_f32 v34, v34, v1
    v_sub_f32 v35, v35, v1
    v_sub_f32 v36, v36, v1
    v_sub_f32 v37, v37, v1
    v_sub_f32 v38, v38, v1
    v_sub_f32 v39, v39, v1
    v_sub_f32 v40, v40, v1
    v_sub_f32 v41, v41, v1
    v_sub_f32 v42, v42, v1
    v_sub_f32 v43, v43, v1
    s_waitcnt lgkmcnt(0)
    .p2align 4
attn_loop:
    s_waitcnt lgkmcnt(3)
    v_mfma_f32_32x32x16_bf16 v[44:59], v[92:95], v[4:7], v[12:27]
    ds_read_b128 v[92:95], v132 offset:4096
    v_exp_f32 v28, v28
    v_exp_f32 v29, v29
    v_exp_f32 v30, v30
    v_exp_f32 v31, v31
    s_waitcnt lgkmcnt(3)
    v_mfma_f32_32x32x16_bf16 v[68:83], v[104:107], v[64:67], v[68:83]
    ds_read_b128 v[104:107], v132 offset:9216
    v_exp_f32 v32, v32
    v_exp_f32 v33, v33
    v_exp_f32 v34, v34
    v_exp_f32 v35, v35
    v_mfma_f32_16x16x32_bf16 v[84:87], v[88:91], v[64:67], v[84:87]
    v_cvt_pk_bf16_f32 v60, v28, v29
    v_cvt_pk_bf16_f32 v61, v30, v31
    v_cvt_pk_bf16_f32 v62, v32, v33
    v_cvt_pk_bf16_f32 v63, v34, v35
    s_waitcnt lgkmcnt(3)
    v_mfma_f32_32x32x16_bf16 v[44:59], v[96:99], v[8:11], v[44:59]
    ds_read_b128 v[96:99], v132 offset:5120
    v_exp_f32 v36, v36
    v_exp_f32 v37, v37
    v_exp_f32 v38, v38
    v_exp_f32 v39, v39
    s_waitcnt lgkmcnt(3)
    v_mfma_f32_32x32x16_bf16 v[68:83], v[100:103], v[60:63], v[68:83]
    ds_read_b128 v[100:103], v132 offset:10240
    v_exp_f32 v40, v40
    v_exp_f32 v41, v41
    v_exp_f32 v42, v42
    v_exp_f32 v43, v43
    v_mfma_f32_16x16x32_bf16 v[84:87], v[88:91], v[60:63], v[84:87]
    v_cvt_pk_bf16_f32 v64, v36, v37
    v_cvt_pk_bf16_f32 v65, v38, v39
    v_cvt_pk_bf16_f32 v66, v40, v41
    v_cvt_pk_bf16_f32 v67, v42, v43
    s_waitcnt lgkmcnt(3)
    v_mfma_f32_32x32x16_bf16 v[28:43], v[92:95], v[4:7], v[12:27]
    ds_read_b128 v[92:95], v132 offset:6144
    v_exp_f32 v44, v44
    v_exp_f32 v45, v45
    v_exp_f32 v46, v46
    v_exp_f32 v47, v47
    s_waitcnt lgkmcnt(3)
    v_mfma_f32_32x32x16_bf16 v[68:83], v[104:107], v[64:67], v[68:83]
    ds_read_b128 v[104:107], v132 offset:11264
    v_exp_f32 v48, v48
    v_exp_f32 v49, v49
    v_exp_f32 v50, v50
    v_exp_f32 v51, v51
    v_mfma_f32_16x16x32_bf16 v[84:87], v[88:91], v[64:67], v[84:87]
    v_cvt_pk_bf16_f32 v60, v44, v45
    v_cvt_pk_bf16_f32 v61, v46, v47
    v_cvt_pk_bf16_f32 v62, v48, v49
    v_cvt_pk_bf16_f32 v63, v50, v51
    s_waitcnt lgkmcnt(3)
    v_mfma_f32_32x32x16_bf16 v[28:43], v[96:99], v[8:11], v[28:43]
    ds_read_b128 v[96:99], v132 offset:7168
    v_exp_f32 v52, v52
    v_exp_f32 v53, v53
    v_exp_f32 v54, v54
    v_exp_f32 v55, v55
    s_waitcnt lgkmcnt(3)
    v_mfma_f32_32x32x16_bf16 v[68:83], v[100:103], v[60:63], v[68:83]
    ds_read_b128 v[100:103], v132 offset:12288
    v_exp_f32 v56, v56
    v_exp_f32 v57, v57
    v_exp_f32 v58, v58
    v_exp_f32 v59, v59
    v_mfma_f32_16x16x32_bf16 v[84:87], v[88:91], v[60:63], v[84:87]
    v_cvt_pk_bf16_f32 v64, v52, v53
    v_cvt_pk_bf16_f32 v65, v54, v55
    v_cvt_pk_bf16_f32 v66, v56, v57
    v_cvt_pk_bf16_f32 v67, v58, v59
    s_waitcnt vmcnt(4)
    s_barrier
    s_waitcnt lgkmcnt(3)
    v_mfma_f32_32x32x16_bf16 v[44:59], v[92:95], v[4:7], v[12:27]
    ds_read_b128 v[92:95], v132 offset:16384
    v_exp_f32 v28, v28
    v_exp_f32 v29, v29
    v_exp_f32 v30, v30
    v_exp_f32 v31, v31
    s_add_u32 m0, s34, 49152
    s_nop 0
    buffer_load_dwordx4 v133, s[12:15], s37 offen sc1 lds
    s_waitcnt lgkmcnt(3)
    v_mfma_f32_32x32x16_bf16 v[68:83], v[104:107], v[64:67], v[68:83]
    ds_read_b128 v[104:107], v132 offset:13312
    v_exp_f32 v32, v32
    v_exp_f32 v33, v33
    v_exp_f32 v34, v34
    v_exp_f32 v35, v35
    v_mfma_f32_16x16x32_bf16 v[84:87], v[88:91], v[64:67], v[84:87]
    v_cvt_pk_bf16_f32 v60, v28, v29
    v_cvt_pk_bf16_f32 v61, v30, v31
    v_cvt_pk_bf16_f32 v62, v32, v33
    v_cvt_pk_bf16_f32 v63, v34, v35
    s_add_u32 m0, s34, 57344
    s_nop 0
    buffer_load_dwordx4 v133, s[16:19], s37 offen sc1 lds
    s_add_u32 s37, s37, 8192
    s_waitcnt lgkmcnt(3)
    v_mfma_f32_32x32x16_bf16 v[44:59], v[96:99], v[8:11], v[44:59]
    ds_read_b128 v[96:99], v132 offset:17408
    v_exp_f32 v36, v36
    v_exp_f32 v37, v37
    v_exp_f32 v38, v38
    v_exp_f32 v39, v39
    buffer_load_dwordx4 v[124:127], v132, s[60:63], s41 offen
    s_add_u32 s41, s41, 1024
    s_cmp_lt_u32 s42, 2048
    s_cbranch_scc0 qkv_ex7
    buffer_store_dwordx4 v[128:131], v132, s[96:99], s42 offen sc1
    s_add_u32 s42, s42, 1024
qkv_ex7:
    s_cmp_lt_u32 s44, 1179648
    s_cbranch_scc0 qkv_wl8
    s_mov_b32 m0, s45
    s_add_u32 s45, s45, 8192
    buffer_load_dwordx4 v135, s[56:59], s44 offen lds
    s_add_u32 s44, s44, 131072
qkv_wl8:
    s_waitcnt lgkmcnt(3)
    v_mfma_f32_32x32x16_bf16 v[68:83], v[100:103], v[60:63], v[68:83]
    ds_read_b128 v[100:103], v132 offset:14336
    v_exp_f32 v40, v40
    v_exp_f32 v41, v41
    v_exp_f32 v42, v42
    v_exp_f32 v43, v43
    v_mfma_f32_16x16x32_bf16 v[84:87], v[88:91], v[60:63], v[84:87]
    v_cvt_pk_bf16_f32 v64, v36, v37
    v_cvt_pk_bf16_f32 v65, v38, v39
    v_cvt_pk_bf16_f32 v66, v40, v41
    v_cvt_pk_bf16_f32 v67, v42, v43
    s_waitcnt lgkmcnt(3)
    v_mfma_f32_32x32x16_bf16 v[28:43], v[92:95], v[4:7], v[12:27]
    ds_read_b128 v[92:95], v132 offset:18432
    v_exp_f32 v44, v44
    v_exp_f32 v45, v45
    v_exp_f32 v46, v46
    v_exp_f32 v47, v47
    s_waitcnt lgkmcnt(3)
    v_mfma_f32_32x32x16_bf16 v[68:83], v[104:107], v[64:67], v[68:83]
    ds_read_b128 v[104:107], v132 offset:15360
    v_exp_f32 v48, v48
    v_exp_f32 v49, v49
    v_exp_f32 v50, v50
    v_exp_f32 v51, v51
    v_mfma_f32_16x16x32_bf16 v[84:87], v[88:91], v[64:67], v[84:87]
    v_cvt_pk_bf16_f32 v60, v44, v45
    v_cvt_pk_bf16_f32 v61, v46, v47
    v_cvt_pk_bf16_f32 v62, v48, v49
    v_cvt_pk_bf16_f32 v63, v50, v51
    s_waitcnt lgkmcnt(3)
    v_mfma_f32_32x32x16_bf16 v[28:43], v[96:99], v[8:11], v[28:43]
    ds_read_b128 v[96:99], v132 offset:19456
    v_exp_f32 v52, v52
    v_exp_f32 v53, v53
    v_exp_f32 v54, v54
    v_exp_f32 v55, v55
    s_waitcnt lgkmcnt(3)
    v_mfma_f32_32x32x16_bf16 v[68:83], v[100:103], v[60:63], v[68:83]
    ds_read_b128 v[100:103], v132 offset:24576
    v_exp_f32 v56, v56
    v_exp_f32 v57, v57
    v_exp_f32 v58, v58
    v_exp_f32 v59, v59
    v_mfma_f32_16x16x32_bf16 v[84:87], v[88:91], v[60:63], v[84:87]
    v_cvt_pk_bf16_f32 v64, v52, v53
    v_cvt_pk_bf16_f32 v65, v54, v55
    v_cvt_pk_bf16_f32 v66, v56, v57
    v_cvt_pk_bf16_f32 v67, v58, v59
    s_waitcnt lgkmcnt(3)
    v_mfma_f32_32x32x16_bf16 v[44:59], v[92:95], v[4:7], v[12:27]
    ds_read_b128 v[92:95], v132 offset:20480
    v_exp_f32 v28, v28
    v_exp_f32 v29, v29
    v_exp_f32 v30, v30
    v_exp_f32 v31, v31
    s_waitcnt lgkmcnt(3)
    v_mfma_f32_32x32x16_bf16 v[68:83], v[104:107], v[64:67], v[68:83]
    ds_read_b128 v[104:107], v132 offset:25600
    v_exp_f32 v32, v32
    v_exp_f32 v33, v33
    v_exp_f32 v34, v34
    v_exp_f32 v35, v35
    v_mfma_f32_16x16x32_bf16 v[84:87], v[88:91], v[64:67], v[84:87]
    v_cvt_pk_bf16_f32 v60, v28, v29
    v_cvt_pk_bf16_f32 v61, v30, v31
    v_cvt_pk_bf16_f32 v62, v32, v33
    v_cvt_pk_bf16_f32 v63, v34, v35
    s_waitcnt lgkmcnt(3)
    v_mfma_f32_32x32x16_bf16 v[44:59], v[96:99], v[8:11], v[44:59]
    ds_read_b128 v[96:99], v132 offset:21504
    v_exp_f32 v36, v36
    v_exp_f32 v37, v37
    v_exp_f32 v38, v38
    v_exp_f32 v39, v39
    s_waitcnt lgkmcnt(3)
    v_mfma_f32_32x32x16_bf16 v[68:83], v[100:103], v[60:63], v[68:83]
    ds_read_b128 v[100:103], v132 offset:26624
    v_exp_f32 v40, v40
    v_exp_f32 v41, v41
    v_exp_f32 v42, v42
    v_exp_f32 v43, v43
    v_mfma_f32_16x16x32_bf16 v[84:87], v[88:91], v[60:63], v[84:87]
    v_cvt_pk_bf16_f32 v64, v36, v37
    v_cvt_pk_bf16_f32 v65, v38, v39
    v_cvt_pk_bf16_f32 v66, v40, v41
    v_cvt_pk_bf16_f32 v67, v42, v43
    s_waitcnt lgkmcnt(3)
    v_mfma_f32_32x32x16_bf16 v[28:43], v[92:95], v[4:7], v[12:27]
    ds_read_b128 v[92:95], v132 offset:22528
    v_exp_f32 v44, v44
    v_exp_f32 v45, v45
    v_exp_f32 v46, v46
    v_exp_f32 v47, v47
    s_waitcnt lgkmcnt(3)
    v_mfma_f32_32x32x16_bf16 v[68:83], v[104:107], v[64:67], v[68:83]
    ds_read_b128 v[104:107], v132 offset:27648
    v_exp_f32 v48, v48
    v_exp_f32 v49, v49
    v_exp_f32 v50, v50
    v_exp_f32 v51, v51
    v_mfma_f32_16x16x32_bf16 v[84:87], v[88:91], v[64:67], v[84:87]
    v_cvt_pk_bf16_f32 v60, v44, v45
    v_cvt_pk_bf16_f32 v61, v46, v47
    v_cvt_pk_bf16_f32 v62, v48, v49
    v_cvt_pk_bf16_f32 v63, v50, v51
    s_waitcnt lgkmcnt(3)
    v_mfma_f32_32x32x16_bf16 v[28:43], v[96:99], v[8:11], v[28:43]
    ds_read_b128 v[96:99], v132 offset:23552
    v_exp_f32 v52, v52
    v_exp_f32 v53, v53
    v_exp_f32 v54, v54
    v_exp_f32 v55, v55
    s_waitcnt lgkmcnt(3)
    v_mfma_f32_32x32x16_bf16 v[68:83], v[100:103], v[60:63], v[68:83]
    ds_read_b128 v[100:103], v132 offset:28672
    v_exp_f32 v56, v56
    v_exp_f32 v57, v57
    v_exp_f32 v58, v58
    v_exp_f32 v59, v59
    v_mfma_f32_16x16x32_bf16 v[84:87], v[88:91], v[60:63], v[84:87]
    v_cvt_pk_bf16_f32 v64, v52, v53
    v_cvt_pk_bf16_f32 v65, v54, v55
    v_cvt_pk_bf16_f32 v66, v56, v57
    v_cvt_pk_bf16_f32 v67, v58, v59
    s_waitcnt vmcnt(4)
    s_barrier
    s_waitcnt lgkmcnt(3)
    v_mfma_f32_32x32x16_bf16 v[44:59], v[92:95], v[4:7], v[12:27]
    ds_read_b128 v[92:95], v132 offset:32768
    v_exp_f32 v28, v28
    v_exp_f32 v29, v29
    v_exp_f32 v30, v30
    v_exp_f32 v31, v31
    s_add_u32 m0, s34, 0
    s_nop 0
    buffer_load_dwordx4 v133, s[12:15], s37 offen sc1 lds
    s_waitcnt lgkmcnt(3)
    v_mfma_f32_32x32x16_bf16 v[68:83], v[104:107], v[64:67], v[68:83]
    ds_read_b128 v[104:107], v132 offset:29696
    v_exp_f32 v32, v32
    v_exp_f32 v33, v33
    v_exp_f32 v34, v34
    v_exp_f32 v35, v35
    v_mfma_f32_16x16x32_bf16 v[84:87], v[88:91], v[64:67], v[84:87]
    v_cvt_pk_bf16_f32 v60, v28, v29
    v_cvt_pk_bf16_f32 v61, v30, v31
    v_cvt_pk_bf16_f32 v62, v32, v33
    v_cvt_pk_bf16_f32 v63, v34, v35
    s_add_u32 m0, s34, 8192
    s_nop 0
    buffer_load_dwordx4 v133, s[16:19], s37 offen sc1 lds
    s_add_u32 s37, s37, 8192
    s_waitcnt lgkmcnt(3)
    v_mfma_f32_32x32x16_bf16 v[44:59], v[96:99], v[8:11], v[44:59]
    ds_read_b128 v[96:99], v132 offset:33792
    v_exp_f32 v36, v36
    v_exp_f32 v37, v37
    v_exp_f32 v38, v38
    v_exp_f32 v39, v39
    buffer_load_dwordx4 v[124:127], v132, s[60:63], s41 offen
    s_add_u32 s41, s41, 1024
    s_cmp_lt_u32 s42, 2048
    s_cbranch_scc0 qkv_ex9
    buffer_store_dwordx4 v[128:131], v132, s[96:99], s42 offen sc1
    s_add_u32 s42, s42, 1024
qkv_ex9:
    s_cmp_lt_u32 s44, 1179648
    s_cbranch_scc0 qkv_wl10
    s_mov_b32 m0, s45
    s_add_u32 s45, s45, 8192
    buffer_load_dwordx4 v135, s[56:59], s44 offen lds
    s_add_u32 s44, s44, 131072
qkv_wl10:
    s_waitcnt lgkmcnt(3)
    v_mfma_f32_32x32x16_bf16 v[68:83], v[100:103], v[60:63], v[68:83]
    ds_read_b128 v[100:103], v132 offset:30720
    v_exp_f32 v40, v40
    v_exp_f32 v41, v41
    v_exp_f32 v42, v42
    v_exp_f32 v43, v43
    v_mfma_f32_16x16x32_bf16 v[84:87], v[88:91], v[60:63], v[84:87]
    v_cvt_pk_bf16_f32 v64, v36, v37
    v_cvt_pk_bf16_f32 v65, v38, v39
    v_cvt_pk_bf16_f32 v66, v40, v41
    v_cvt_pk_bf16_f32 v67, v42, v43
    s_waitcnt lgkmcnt(3)
    v_mfma_f32_32x32x16_bf16 v[28:43], v[92:95], v[4:7], v[12:27]
    ds_read_b128 v[92:95], v132 offset:34816
    v_exp_f32 v44, v44
    v_exp_f32 v45, v45
    v_exp_f32 v46, v46
    v_exp_f32 v47, v47
    s_waitcnt lgkmcnt(3)
    v_mfma_f32_32x32x16_bf16 v[68:83], v[104:107], v[64:67], v[68:83]
    ds_read_b128 v[104:107], v132 offset:31744
    v_exp_f32 v48, v48
    v_exp_f32 v49, v49
    v_exp_f32 v50, v50
    v_exp_f32 v51, v51
    v_mfma_f32_16x16x32_bf16 v[84:87], v[88:91], v[64:67], v[84:87]
    v_cvt_pk_bf16_f32 v60, v44, v45
    v_cvt_pk_bf16_f32 v61, v46, v47
    v_cvt_pk_bf16_f32 v62, v48, v49
    v_cvt_pk_bf16_f32 v63, v50, v51
    s_waitcnt lgkmcnt(3)
    v_mfma_f32_32x32x16_bf16 v[28:43], v[96:99], v[8:11], v[28:43]
    ds_read_b128 v[96:99], v132 offset:35840
    v_exp_f32 v52, v52
    v_exp_f32 v53, v53
    v_exp_f32 v54, v54
    v_exp_f32 v55, v55
    s_waitcnt lgkmcnt(3)
    v_mfma_f32_32x32x16_bf16 v[68:83], v[100:103], v[60:63], v[68:83]
    ds_read_b128 v[100:103], v132 offset:40960
    v_exp_f32 v56, v56
    v_exp_f32 v57, v57
    v_exp_f32 v58, v58
    v_exp_f32 v59, v59
    v_mfma_f32_16x16x32_bf16 v[84:87], v[88:91], v[60:63], v[84:87]
    v_cvt_pk_bf16_f32 v64, v52, v53
    v_cvt_pk_bf16_f32 v65, v54, v55
    v_cvt_pk_bf16_f32 v66, v56, v57
    v_cvt_pk_bf16_f32 v67, v58, v59
    s_waitcnt lgkmcnt(3)
    v_mfma_f32_32x32x16_bf16 v[44:59], v[92:95], v[4:7], v[12:27]
    ds_read_b128 v[92:95], v132 offset:36864
    v_exp_f32 v28, v28
    v_exp_f32 v29, v29
    v_exp_f32 v30, v30
    v_exp_f32 v31, v31
    s_waitcnt lgkmcnt(3)
    v_mfma_f32_32x32x16_bf16 v[68:83], v[104:107], v[64:67], v[68:83]
    ds_read_b128 v[104:107], v132 offset:41984
    v_exp_f32 v32, v32
    v_exp_f32 v33, v33
    v_exp_f32 v34, v34
    v_exp_f32 v35, v35
    v_mfma_f32_16x16x32_bf16 v[84:87], v[88:91], v[64:67], v[84:87]
    v_cvt_pk_bf16_f32 v60, v28, v29
    v_cvt_pk_bf16_f32 v61, v30, v31
    v_cvt_pk_bf16_f32 v62, v32, v33
    v_cvt_pk_bf16_f32 v63, v34, v35
    s_waitcnt lgkmcnt(3)
    v_mfma_f32_32x32x16_bf16 v[44:59], v[96:99], v[8:11], v[44:59]
    ds_read_b128 v[96:99], v132 offset:37888
    v_exp_f32 v36, v36
    v_exp_f32 v37, v37
    v_exp_f32 v38, v38
    v_exp_f32 v39, v39
    s_waitcnt lgkmcnt(3)
    v_mfma_f32_32x32x16_bf16 v[68:83], v[100:103], v[60:63], v[68:83]
    ds_read_b128 v[100:103], v132 offset:43008
    v_exp_f32 v40, v40
    v_exp_f32 v41, v41
    v_exp_f32 v42, v42
    v_exp_f32 v43, v43
    v_mfma_f32_16x16x32_bf16 v[84:87], v[88:91], v[60:63], v[84:87]
    v_cvt_pk_bf16_f32 v64, v36, v37
    v_cvt_pk_bf16_f32 v65, v38, v39
    v_cvt_pk_bf16_f32 v66, v40, v41
    v_cvt_pk_bf16_f32 v67, v42, v43
    s_waitcnt lgkmcnt(3)
    v_mfma_f32_32x32x16_bf16 v[28:43], v[92:95], v[4:7], v[12:27]
    ds_read_b128 v[92:95], v132 offset:38912
    v_exp_f32 v44, v44
    v_exp_f32 v45, v45
    v_exp_f32 v46, v46
    v_exp_f32 v47, v47
    s_waitcnt lgkmcnt(3)
    v_mfma_f32_32x32x16_bf16 v[68:83], v[104:107], v[64:67], v[68:83]
    ds_read_b128 v[104:107], v132 offset:44032
    v_exp_f32 v48, v48
    v_exp_f32 v49, v49
    v_exp_f32 v50, v50
    v_exp_f32 v51, v51
    v_mfma_f32_16x16x32_bf16 v[84:87], v[88:91], v[64:67], v[84:87]
    v_cvt_pk_bf16_f32 v60, v44, v45
    v_cvt_pk_bf16_f32 v61, v46, v47
    v_cvt_pk_bf16_f32 v62, v48, v49
    v_cvt_pk_bf16_f32 v63, v50, v51
    s_waitcnt lgkmcnt(3)
    v_mfma_f32_32x32x16_bf16 v[28:43], v[96:99], v[8:11], v[28:43]
    ds_read_b128 v[96:99], v132 offset:39936
    v_exp_f32 v52, v52
    v_exp_f32 v53, v53
    v_exp_f32 v54, v54
    v_exp_f32 v55, v55
    s_waitcnt lgkmcnt(3)
    v_mfma_f32_32x32x16_bf16 v[68:83], v[100:103], v[60:63], v[68:83]
    ds_read_b128 v[100:103], v132 offset:45056
    v_exp_f32 v56, v56
    v_exp_f32 v57, v57
    v_exp_f32 v58, v58
    v_exp_f32 v59, v59
    v_mfma_f32_16x16x32_bf16 v[84:87], v[88:91], v[60:63], v[84:87]
    v_cvt_pk_bf16_f32 v64, v52, v53
    v_cvt_pk_bf16_f32 v65, v54, v55
    v_cvt_pk_bf16_f32 v66, v56, v57
    v_cvt_pk_bf16_f32 v67, v58, v59
    s_waitcnt vmcnt(4)
    s_barrier
    s_waitcnt lgkmcnt(3)
    v_mfma_f32_32x32x16_bf16 v[44:59], v[92:95], v[4:7], v[12:27]
    ds_read_b128 v[92:95], v132 offset:49152
    v_exp_f32 v28, v28
    v_exp_f32 v29, v29
    v_exp_f32 v30, v30
    v_exp_f32 v31, v31
    s_add_u32 m0, s34, 16384
    s_nop 0
    buffer_load_dwordx4 v133, s[12:15], s37 offen sc1 lds
    s_waitcnt lgkmcnt(3)
    v_mfma_f32_32x32x16_bf16 v[68:83], v[104:107], v[64:67], v[68:83]
    ds_read_b128 v[104:107], v132 offset:46080
    v_exp_f32 v32, v32
    v_exp_f32 v33, v33
    v_exp_f32 v34, v34
    v_exp_f32 v35, v35
    v_mfma_f32_16x16x32_bf16 v[84:87], v[88:91], v[64:67], v[84:87]
    v_cvt_pk_bf16_f32 v60, v28, v29
    v_cvt_pk_bf16_f32 v61, v30, v31
    v_cvt_pk_bf16_f32 v62, v32, v33
    v_cvt_pk_bf16_f32 v63, v34, v35
    s_add_u32 m0, s34, 24576
    s_nop 0
    buffer_load_dwordx4 v133, s[16:19], s37 offen sc1 lds
    s_add_u32 s37, s37, 8192
    s_waitcnt lgkmcnt(3)
    v_mfma_f32_32x32x16_bf16 v[44:59], v[96:99], v[8:11], v[44:59]
    ds_read_b128 v[96:99], v132 offset:50176
    v_exp_f32 v36, v36
    v_exp_f32 v37, v37
    v_exp_f32 v38, v38
    v_exp_f32 v39, v39
    buffer_load_dwordx4 v[124:127], v132, s[60:63], s41 offen
    s_add_u32 s41, s41, 1024
    s_cmp_lt_u32 s42, 2048
    s_cbranch_scc0 qkv_ex11
    buffer_store_dwordx4 v[128:131], v132, s[96:99], s42 offen sc1
    s_add_u32 s42, s42, 1024
qkv_ex11:
    s_cmp_lt_u32 s44, 1179648
    s_cbranch_scc0 qkv_wl12
    s_mov_b32 m0, s45
    s_add_u32 s45, s45, 8192
    buffer_load_dwordx4 v135, s[56:59], s44 offen lds
    s_add_u32 s44, s44, 131072
qkv_wl12:
    s_waitcnt lgkmcnt(3)
    v_mfma_f32_32x32x16_bf16 v[68:83], v[100:103], v[60:63], v[68:83]
    ds_read_b128 v[100:103], v132 offset:47104
    v_exp_f32 v40, v40
    v_exp_f32 v41, v41
    v_exp_f32 v42, v42
    v_exp_f32 v43, v43
    v_mfma_f32_16x16x32_bf16 v[84:87], v[88:91], v[60:63], v[84:87]
    v_cvt_pk_bf16_f32 v64, v36, v37
    v_cvt_pk_bf16_f32 v65, v38, v39
    v_cvt_pk_bf16_f32 v66, v40, v41
    v_cvt_pk_bf16_f32 v67, v42, v43
    s_waitcnt lgkmcnt(3)
    v_mfma_f32_32x32x16_bf16 v[28:43], v[92:95], v[4:7], v[12:27]
    ds_read_b128 v[92:95], v132 offset:51200
    v_exp_f32 v44, v44
    v_exp_f32 v45, v45
    v_exp_f32 v46, v46
    v_exp_f32 v47, v47
    s_waitcnt lgkmcnt(3)
    v_mfma_f32_32x32x16_bf16 v[68:83], v[104:107], v[64:67], v[68:83]
    ds_read_b128 v[104:107], v132 offset:48128
    v_exp_f32 v48, v48
    v_exp_f32 v49, v49
    v_exp_f32 v50, v50
    v_exp_f32 v51, v51
    v_mfma_f32_16x16x32_bf16 v[84:87], v[88:91], v[64:67], v[84:87]
    v_cvt_pk_bf16_f32 v60, v44, v45
    v_cvt_pk_bf16_f32 v61, v46, v47
    v_cvt_pk_bf16_f32 v62, v48, v49
    v_cvt_pk_bf16_f32 v63, v50, v51
    s_waitcnt lgkmcnt(3)
    v_mfma_f32_32x32x16_bf16 v[28:43], v[96:99], v[8:11], v[28:43]
    ds_read_b128 v[96:99], v132 offset:52224
    v_exp_f32 v52, v52
    v_exp_f32 v53, v53
    v_exp_f32 v54, v54
    v_exp_f32 v55, v55
    s_waitcnt lgkmcnt(3)
    v_mfma_f32_32x32x16_bf16 v[68:83], v[100:103], v[60:63], v[68:83]
    ds_read_b128 v[100:103], v132 offset:57344
    v_exp_f32 v56, v56
    v_exp_f32 v57, v57
    v_exp_f32 v58, v58
    v_exp_f32 v59, v59
    v_mfma_f32_16x16x32_bf16 v[84:87], v[88:91], v[60:63], v[84:87]
    v_cvt_pk_bf16_f32 v64, v52, v53
    v_cvt_pk_bf16_f32 v65, v54, v55
    v_cvt_pk_bf16_f32 v66, v56, v57
    v_cvt_pk_bf16_f32 v67, v58, v59
    s_waitcnt lgkmcnt(3)
    v_mfma_f32_32x32x16_bf16 v[44:59], v[92:95], v[4:7], v[12:27]
    ds_read_b128 v[92:95], v132 offset:53248
    v_exp_f32 v28, v28
    v_exp_f32 v29, v29
    v_exp_f32 v30, v30
    v_exp_f32 v31, v31
    s_waitcnt lgkmcnt(3)
    v_mfma_f32_32x32x16_bf16 v[68:83], v[104:107], v[64:67], v[68:83]
    ds_read_b128 v[104:107], v132 offset:58368
    v_exp_f32 v32, v32
    v_exp_f32 v33, v33
    v_exp_f32 v34, v34
    v_exp_f32 v35, v35
    v_mfma_f32_16x16x32_bf16 v[84:87], v[88:91], v[64:67], v[84:87]
    v_cvt_pk_bf16_f32 v60, v28, v29
    v_cvt_pk_bf16_f32 v61, v30, v31
    v_cvt_pk_bf16_f32 v62, v32, v33
    v_cvt_pk_bf16_f32 v63, v34, v35
    s_waitcnt lgkmcnt(3)
    v_mfma_f32_32x32x16_bf16 v[44:59], v[96:99], v[8:11], v[44:59]
    ds_read_b128 v[96:99], v132 offset:54272
    v_exp_f32 v36, v36
    v_exp_f32 v37, v37
    v_exp_f32 v38, v38
    v_exp_f32 v39, v39
    s_waitcnt lgkmcnt(3)
    v_mfma_f32_32x32x16_bf16 v[68:83], v[100:103], v[60:63], v[68:83]
    ds_read_b128 v[100:103], v132 offset:59392
    v_exp_f32 v40, v40
    v_exp_f32 v41, v41
    v_exp_f32 v42, v42
    v_exp_f32 v43, v43
    v_mfma_f32_16x16x32_bf16 v[84:87], v[88:91], v[60:63], v[84:87]
    v_cvt_pk_bf16_f32 v64, v36, v37
    v_cvt_pk_bf16_f32 v65, v38, v39
    v_cvt_pk_bf16_f32 v66, v40, v41
    v_cvt_pk_bf16_f32 v67, v42, v43
    s_waitcnt lgkmcnt(3)
    v_mfma_f32_32x32x16_bf16 v[28:43], v[92:95], v[4:7], v[12:27]
    ds_read_b128 v[92:95], v132 offset:55296
    v_exp_f32 v44, v44
    v_exp_f32 v45, v45
    v_exp_f32 v46, v46
    v_exp_f32 v47, v47
    s_waitcnt lgkmcnt(3)
    v_mfma_f32_32x32x16_bf16 v[68:83], v[104:107], v[64:67], v[68:83]
    ds_read_b128 v[104:107], v132 offset:60416
    v_exp_f32 v48, v48
    v_exp_f32 v49, v49
    v_exp_f32 v50, v50
    v_exp_f32 v51, v51
    v_mfma_f32_16x16x32_bf16 v[84:87], v[88:91], v[64:67], v[84:87]
    v_cvt_pk_bf16_f32 v60, v44, v45
    v_cvt_pk_bf16_f32 v61, v46, v47
    v_cvt_pk_bf16_f32 v62, v48, v49
    v_cvt_pk_bf16_f32 v63, v50, v51
    s_waitcnt lgkmcnt(3)
    v_mfma_f32_32x32x16_bf16 v[28:43], v[96:99], v[8:11], v[28:43]
    ds_read_b128 v[96:99], v132 offset:56320
    v_exp_f32 v52, v52
    v_exp_f32 v53, v53
    v_exp_f32 v54, v54
    v_exp_f32 v55, v55
    s_waitcnt lgkmcnt(3)
    v_mfma_f32_32x32x16_bf16 v[68:83], v[100:103], v[60:63], v[68:83]
    ds_read_b128 v[100:103], v132 offset:61440
    v_exp_f32 v56, v56
    v_exp_f32 v57, v57
    v_exp_f32 v58, v58
    v_exp_f32 v59, v59
    v_mfma_f32_16x16x32_bf16 v[84:87], v[88:91], v[60:63], v[84:87]
    v_cvt_pk_bf16_f32 v64, v52, v53
    v_cvt_pk_bf16_f32 v65, v54, v55
    v_cvt_pk_bf16_f32 v66, v56, v57
    v_cvt_pk_bf16_f32 v67, v58, v59
    s_waitcnt vmcnt(4)
    s_barrier
    s_waitcnt lgkmcnt(3)
    v_mfma_f32_32x32x16_bf16 v[44:59], v[92:95], v[4:7], v[12:27]
    ds_read_b128 v[92:95], v132 offset:0
    v_exp_f32 v28, v28
    v_exp_f32 v29, v29
    v_exp_f32 v30, v30
    v_exp_f32 v31, v31
    s_add_u32 m0, s34, 32768
    s_nop 0
    buffer_load_dwordx4 v133, s[12:15], s37 offen sc1 lds
    s_waitcnt lgkmcnt(3)
    v_mfma_f32_32x32x16_bf16 v[68:83], v[104:107], v[64:67], v[68:83]
    ds_read_b128 v[104:107], v132 offset:62464
    v_exp_f32 v32, v32
    v_exp_f32 v33, v33
    v_exp_f32 v34, v34
    v_exp_f32 v35, v35
    v_mfma_f32_16x16x32_bf16 v[84:87], v[88:91], v[64:67], v[84:87]
    v_cvt_pk_bf16_f32 v60, v28, v29
    v_cvt_pk_bf16_f32 v61, v30, v31
    v_cvt_pk_bf16_f32 v62, v32, v33
    v_cvt_pk_bf16_f32 v63, v34, v35
    s_add_u32 m0, s34, 40960
    s_nop 0
    buffer_load_dwordx4 v133, s[16:19], s37 offen sc1 lds
    s_add_u32 s37, s37, 8192
    s_waitcnt lgkmcnt(3)
    v_mfma_f32_32x32x16_bf16 v[44:59], v[96:99], v[8:11], v[44:59]
    ds_read_b128 v[96:99], v132 offset:1024
    v_exp_f32 v36, v36
    v_exp_f32 v37, v37
    v_exp_f32 v38, v38
    v_exp_f32 v39, v39
    buffer_load_dwordx4 v[124:127], v132, s[60:63], s41 offen
    s_add_u32 s41, s41, 1024
    s_cmp_lt_u32 s42, 2048
    s_cbranch_scc0 qkv_ex13
    buffer_store_dwordx4 v[128:131], v132, s[96:99], s42 offen sc1
    s_add_u32 s42, s42, 1024
qkv_ex13:
    s_cmp_lt_u32 s44, 1179648
    s_cbranch_scc0 qkv_wl14
    s_mov_b32 m0, s45
    s_add_u32 s45, s45, 8192
    buffer_load_dwordx4 v135, s[56:59], s44 offen lds
    s_add_u32 s44, s44, 131072
qkv_wl14:
    s_cmp_eq_u32 s41, 12288
    s_cbranch_scc0 qkv_po15
    buffer_load_dword v124, v134, s[56:59], s43 offen
    s_mov_b32 s27, 0x00020000
    buffer_load_dword v125, v136, s[24:27], s28 offen
qkv_po15:
    s_waitcnt lgkmcnt(3)
    v_mfma_f32_32x32x16_bf16 v[68:83], v[100:103], v[60:63], v[68:83]
    ds_read_b128 v[100:103], v132 offset:63488
    v_exp_f32 v40, v40
    v_exp_f32 v41, v41
    v_exp_f32 v42, v42
    v_exp_f32 v43, v43
    v_mfma_f32_16x16x32_bf16 v[84:87], v[88:91], v[60:63], v[84:87]
    v_cvt_pk_bf16_f32 v64, v36, v37
    v_cvt_pk_bf16_f32 v65, v38, v39
    v_cvt_pk_bf16_f32 v66, v40, v41
    v_cvt_pk_bf16_f32 v67, v42, v43
    s_waitcnt lgkmcnt(3)
    v_mfma_f32_32x32x16_bf16 v[28:43], v[92:95], v[4:7], v[12:27]
    ds_read_b128 v[92:95], v132 offset:2048
    v_exp_f32 v44, v44
    v_exp_f32 v45, v45
    v_exp_f32 v46, v46
    v_exp_f32 v47, v47
    s_waitcnt lgkmcnt(3)
    v_mfma_f32_32x32x16_bf16 v[68:83], v[104:107], v[64:67], v[68:83]
    ds_read_b128 v[104:107], v132 offset:64512
    v_exp_f32 v48, v48
    v_exp_f32 v49, v49
    v_exp_f32 v50, v50
    v_exp_f32 v51, v51
    v_mfma_f32_16x16x32_bf16 v[84:87], v[88:91], v[64:67], v[84:87]
    v_cvt_pk_bf16_f32 v60, v44, v45
    v_cvt_pk_bf16_f32 v61, v46, v47
    v_cvt_pk_bf16_f32 v62, v48, v49
    v_cvt_pk_bf16_f32 v63, v50, v51
    s_waitcnt lgkmcnt(3)
    v_mfma_f32_32x32x16_bf16 v[28:43], v[96:99], v[8:11], v[28:43]
    ds_read_b128 v[96:99], v132 offset:3072
    v_exp_f32 v52, v52
    v_exp_f32 v53, v53
    v_exp_f32 v54, v54
    v_exp_f32 v55, v55
    s_waitcnt lgkmcnt(3)
    v_mfma_f32_32x32x16_bf16 v[68:83], v[100:103], v[60:63], v[68:83]
    ds_read_b128 v[100:103], v132 offset:8192
    v_exp_f32 v56, v56
    v_exp_f32 v57, v57
    v_exp_f32 v58, v58
    v_exp_f32 v59, v59
    v_mfma_f32_16x16x32_bf16 v[84:87], v[88:91], v[60:63], v[84:87]
    v_cvt_pk_bf16_f32 v64, v52, v53
    v_cvt_pk_bf16_f32 v65, v54, v55
    v_cvt_pk_bf16_f32 v66, v56, v57
    v_cvt_pk_bf16_f32 v67, v58, v59
    s_sub_u32 s39, s39, 1
    s_cmp_lg_u32 s39, 0
    s_cbranch_scc1 attn_loop
padc5:
    s_cbranch_execz pad5_1
    s_waitcnt lgkmcnt(0)
    v_mfma_f32_32x32x16_bf16 v[68:83], v[104:107], v[64:67], v[68:83]
    v_mfma_f32_16x16x32_bf16 v[84:87], v[88:91], v[64:67], v[84:87]
    s_waitcnt vmcnt(0)
    s_nop 7
    v_rcp_f32 v1, v84
    s_nop 0
    v_mul_f32 v68, v68, v1
    v_mul_f32 v69, v69, v1
    v_mul_f32 v70, v70, v1
    v_mul_f32 v71, v71, v1
    v_mul_f32 v72, v72, v1
    v_mul_f32 v73, v73, v1
    v_mul_f32 v74, v74, v1
    v_mul_f32 v75, v75, v1
    v_mul_f32 v76, v76, v1
    v_mul_f32 v77, v77, v1
    v_mul_f32 v78, v78, v1
    v_mul_f32 v79, v79, v1
    v_mul_f32 v80, v80, v1
    v_mul_f32 v81, v81, v1
    v_mul_f32 v82, v82, v1
    v_mul_f32 v83, v83, v1
    s_lshl_b32 s35, s33, 6
    s_lshl_b32 s40, s30, 1
    s_add_u32 s35, s35, s40
    s_lshl_b32 s35, s35, 10
    s_add_u32 s8, s6, 0x1000000
    s_addc_u32 s9, s7, 0
    s_mov_b32 s10, 0x400000
    s_mov_b32 s11, 0x00020000
    v_mul_f32 v1, v68, v108
    v_mul_f32 v2, v69, v109
    v_fmac_f32 v1, v70, v110
    v_fmac_f32 v2, v71, v111
    v_fmac_f32 v1, v72, v112
    v_fmac_f32 v2, v73, v113
    v_fmac_f32 v1, v74, v114
    v_fmac_f32 v2, v75, v115
    v_fmac_f32 v1, v76, v116
    v_fmac_f32 v2, v77, v117
    v_fmac_f32 v1, v78, v118
    v_fmac_f32 v2, v79, v119
    v_fmac_f32 v1, v80, v120
    v_fmac_f32 v2, v81, v121
    v_fmac_f32 v1, v82, v122
    v_fmac_f32 v2, v83, v123
    v_cvt_pk_bf16_f32 v28, v68, v69
    v_cvt_pk_bf16_f32 v29, v70, v71
    v_cvt_pk_bf16_f32 v30, v72, v73
    v_cvt_pk_bf16_f32 v31, v74, v75
    v_cvt_pk_bf16_f32 v32, v76, v77
    v_cvt_pk_bf16_f32 v33, v78, v79
    v_cvt_pk_bf16_f32 v34, v80, v81
    v_cvt_pk_bf16_f32 v35, v82, v83
    buffer_store_dwordx4 v[28:31], v132, s[8:11], s35 offen sc1
    buffer_store_dwordx4 v[32:35], v132, s[8:11], s35 offen offset:1024 sc1
    v_add_f32 v1, v1, v2
    v_mov_b32 v2, v1
    s_nop 1
    v_permlane32_swap_b32 v1, v2
    v_add_f32 v1, v1, v2
    s_lshl_b32 s35, s33, 12
    s_lshl_b32 s40, s30, 7
    s_add_u32 s35, s35, s40
    s_add_u32 s35, s35, 65536
    v_lshlrev_b32 v2, 2, v0
    s_mov_b32 exec_hi, 0
    buffer_store_dword v1, v2, s[20:23], s35 offen sc1
    s_mov_b64 exec, -1
    s_cmp_lg_u32 s36, 1
    s_cbranch_scc1 attn_fin
    v_max3_f32 v2, |v68|, |v69|, |v84|
    v_mul_f32 v2, 0, v2
    v_fma_f32 v2, 0, v70, v2
    v_fma_f32 v2, 0, v71, v2
    v_fma_f32 v2, 0, v72, v2
    v_fma_f32 v2, 0, v73, v2
    v_fma_f32 v2, 0, v74, v2
    v_fma_f32 v2, 0, v75, v2
    v_fma_f32 v2, 0, v76, v2
    v_fma_f32 v2, 0, v77, v2
    v_fma_f32 v2, 0, v78, v2
    v_fma_f32 v2, 0, v79, v2
    v_fma_f32 v2, 0, v80, v2
    v_fma_f32 v2, 0, v81, v2
    v_fma_f32 v2, 0, v82, v2
    v_fma_f32 v2, 0, v83, v2
pad5_1:
    s_cbranch_execz pad5_2
    v_fma_f32 v2, 0, v68, v2
    v_fma_f32 v2, 0, v69, v2
    v_add_f32 v2, v2, v84
    s_mov_b32 s40, 0x5d800000
    v_cmp_nlt_f32 vcc, v2, s40
    s_nop 1
    s_cbranch_vccz attn_vote
    v_mov_b32 v1, 1
    v_mov_b32 v2, 163600
    ds_write_b32 v2, v1
attn_vote:
    v_mov_b32 v2, 163600
    s_waitcnt lgkmcnt(0)
    s_barrier
    ds_read_b32 v1, v2
    s_waitcnt lgkmcnt(0)
    v_readfirstlane_b32 s40, v1
    s_nop 0
    s_cmp_eq_u32 s40, 0
    s_cbranch_scc1 attn_fin
    s_mov_b32 s36, 64
    s_branch attn_restart
attn_fin:
    s_add_u32 s96, s86, 0x4400000
    s_addc_u32 s97, s87, 0
    s_mov_b32 s98, 0x8000
    s_mov_b32 s99, 0x00020000
    v_mov_b32 v4, 163584
    v_mov_b32 v5, 1
    v_mul_u32_u24 v6, 128, v0
    s_mov_b64 exec, 1
    s_waitcnt vmcnt(0)
    ds_add_rtn_u32 v4, v4, v5
    s_waitcnt lgkmcnt(0)
    v_readfirstlane_b32 s89, v4
    s_nop 0
    s_cmp_eq_u32 s89, 7
    s_cbranch_scc0 qkv_sg16
    s_mov_b32 exec_lo, -1
    buffer_store_byte v5, v6, s[96:99], s94 offen sc1
qkv_sg16:
    s_mov_b64 exec, -1
    s_branch wo_begin
wo_begin:
    s_mov_b64 exec, -1
    s_mov_b32 s3, s93
    s_mov_b64 s[4:5], s[72:73]
    s_mov_b64 s[6:7], s[86:87]
    s_mov_b64 s[24:25], s[68:69]
    s_lshr_b32 s30, s90, 1
    s_lshl_b32 s30, s30, 2
    s_lshr_b32 s92, s91, 3
    s_add_u32 s30, s30, s92
    s_and_b32 s31, s90, 1
    s_lshl_b32 s31, s31, 3
    s_and_b32 s92, s91, 7
    s_add_u32 s31, s31, s92
    s_lshr_b32 s32, s30, 1
    s_and_b32 s33, s30, 1
    s_lshl_b32 s33, s33, 4
    s_add_u32 s33, s33, s31
    s_lshl_b32 s95, s32, 5
    s_lshl_b32 s95, s95, 7
    s_add_u32 s95, s95, s33
    s_add_u32 s95, s95, 32
    s_waitcnt lgkmcnt(0)
    s_cmp_ge_u32 s3, 4
    s_cbranch_scc0 wo_comp
    s_add_u32 s8, s6, 0x1000000
    s_addc_u32 s9, s7, 0
    s_mov_b32 s10, 0x400000
    s_mov_b32 s11, 0x00020000
    s_mov_b32 s12, s4
    s_mov_b32 s13, s5
    s_mov_b32 s14, 0x200000
    s_mov_b32 s15, 0x00020000
    s_sub_u32 s3, s3, 4
    s_lshl_b32 s32, s30, 2
    s_add_u32 s32, s32, s3
    s_mul_i32 s32, s32, 65536
    v_lshlrev_b32 v1, 4, v0
    v_add_u32 v1, s32, v1
    v_add_u32 v8, 0, v1
    v_add_u32 v9, 1024, v1
    v_add_u32 v10, 2048, v1
    v_add_u32 v11, 3072, v1
    v_lshrrev_b32 v3, 5, v0
    v_lshlrev_b32 v3, 2, v3
    v_bfe_u32 v4, v0, 2, 2
    v_add_u32 v3, v3, v4
    s_mov_b32 s92, 2048
    v_mul_lo_u32 v2, v3, s92
    v_bfe_u32 v3, v0, 4, 1
    v_lshlrev_b32 v3, 6, v3
    v_and_b32 v4, 3, v0
    v_lshlrev_b32 v4, 4, v4
    v_add3_u32 v2, v2, v3, v4
    s_lshl_b32 s33, s3, 15
    s_lshl_b32 s34, s31, 7
    s_add_u32 s33, s33, s34
    v_add_u32 v12, s33, v2
    v_add_u32 v13, 8*2048, v12
pad5_2:
    s_cbranch_execz pad5_3
    s_mov_b32 s40, 0
    s_mov_b32 s41, 0
    s_lshl_b32 s42, s3, 12
    s_lshl_b32 s43, s3, 11
    s_add_u32 s43, s43, 81920
    s_mov_b32 s62, 0
    s_mov_b32 s64, 16384
    s_mov_b32 s65, -65536
    s_lshr_b32 s36, s90, 1
    s_lshl_b32 s36, s36, 3
    s_and_b32 s92, s91, 7
    s_add_u32 s36, s36, s92
    s_mul_i32 s39, s36, 112
    s_and_b32 s92, s36, 1
    s_lshl_b32 s37, s92, 4
    s_add_u32 s37, s37, s39
    s_cmp_eq_u32 s92, 0
    s_cselect_b32 s38, 96, 0
    s_add_u32 s38, s38, s39
    s_and_b32 s39, s3, 1
    v_lshrrev_b32 v1, 4, v0
    s_lshr_b32 s55, s3, 1
    s_mul_i32 s55, s55, 7168
    s_lshl_b32 s44, s39, 12
    s_add_u32 s55, s55, s44
    s_add_u32 s55, s55, 16384
    v_lshlrev_b32 v2, 3, v1
    v_bfe_u32 v3, v0, 2, 2
    v_add_u32 v2, v2, v3
    v_mul_u32_u24 v2, 7168, v2
    v_lshlrev_b32 v3, 1, v1
    v_xor_b32 v3, v3, v0
    v_and_b32 v3, 3, v3
    v_lshl_add_u32 v2, v3, 4, v2
    v_lshrrev_b32 v3, 1, v3
    s_lshl_b32 s44, s37, 1
    s_lshl_b32 s45, s39, 7
    s_add_u32 s44, s44, s45
    v_add_u32 v20, s44, v2
    v_add_u32 v21, 28672, v20
    s_lshl_b32 s45, s38, 1
    s_add_u32 s44, s44, 64
    s_cmp_eq_u32 s39, 0
    s_cselect_b32 s44, s44, s45
    s_cselect_b32 s45, 0, 28640
    s_cselect_b32 s48, 28672, 0x40000000
    s_cselect_b32 s53, s55, 150528
    v_add_u32 v22, s44, v2
    v_add_u32 v23, s48, v22
    v_mad_u32_u24 v22, v3, s45, v22
    s_cmp_ge_u32 s3, 2
    s_cselect_b32 s44, s78, s76
    s_cselect_b32 s45, s79, s77
    s_mov_b32 s54, 0
    s_cmp_eq_u32 s39, 0
    s_cselect_b32 s52, -1, 0
    s_mov_b32 s20, s44
    s_mov_b32 s21, s45
    s_mov_b32 s22, 0x700000
    s_mov_b32 s23, 0x00020000
    s_mov_b64 exec, 0
    s_cmp_eq_u32 s3, 0
    s_cbranch_scc1 padc8
    s_cmp_eq_u32 s3, 1
    s_cbranch_scc1 padc9
    s_cmp_eq_u32 s3, 2
    s_cbranch_scc1 padc10
    s_cmp_eq_u32 s3, 3
    s_cbranch_scc1 padc11
wo_warm_ret:
    s_mov_b64 exec, -1
    s_barrier
    s_add_u32 m0, s42, 0
    s_nop 0
    buffer_load_dwordx4 v8, s[8:11], s40 offen sc1 lds
    s_add_u32 m0, s42, 1024
    s_nop 0
    buffer_load_dwordx4 v9, s[8:11], s40 offen sc1 lds
    s_add_u32 m0, s42, 2048
    s_nop 0
    buffer_load_dwordx4 v10, s[8:11], s40 offen sc1 lds
    s_add_u32 m0, s42, 3072
    s_nop 0
    buffer_load_dwordx4 v11, s[8:11], s40 offen sc1 lds
    s_add_u32 s40, s40, 4096
    s_add_u32 m0, s42, 16384
    s_nop 0
    buffer_load_dwordx4 v8, s[8:11], s40 offen sc1 lds
    s_add_u32 m0, s42, 17408
    s_nop 0
    buffer_load_dwordx4 v9, s[8:11], s40 offen sc1 lds
    s_add_u32 m0, s42, 18432
    s_nop 0
    buffer_load_dwordx4 v10, s[8:11], s40 offen sc1 lds
    s_add_u32 m0, s42, 19456
pad5_3:
    s_cbranch_execz pad5_4
    s_nop 0
    buffer_load_dwordx4 v11, s[8:11], s40 offen sc1 lds
    s_add_u32 s40, s40, 4096
    s_add_u32 m0, s42, 32768
    s_nop 0
    buffer_load_dwordx4 v8, s[8:11], s40 offen sc1 lds
    s_add_u32 m0, s42, 33792
    s_nop 0
    buffer_load_dwordx4 v9, s[8:11], s40 offen sc1 lds
    s_add_u32 m0, s42, 34816
    s_nop 0
    buffer_load_dwordx4 v10, s[8:11], s40 offen sc1 lds
    s_add_u32 m0, s42, 35840
    s_nop 0
    buffer_load_dwordx4 v11, s[8:11], s40 offen sc1 lds
    s_add_u32 s40, s40, 4096
    s_add_u32 m0, s42, 49152
    s_nop 0
    buffer_load_dwordx4 v8, s[8:11], s40 offen sc1 lds
    s_add_u32 m0, s42, 50176
    s_nop 0
    buffer_load_dwordx4 v9, s[8:11], s40 offen sc1 lds
    s_add_u32 m0, s42, 51200
    s_nop 0
    buffer_load_dwordx4 v10, s[8:11], s40 offen sc1 lds
    s_add_u32 m0, s42, 52224
    s_nop 0
    buffer_load_dwordx4 v11, s[8:11], s40 offen sc1 lds
    s_add_u32 s40, s40, 4096
    s_add_u32 m0, s42, 65536
    s_nop 0
    buffer_load_dwordx4 v8, s[8:11], s40 offen sc1 lds
    s_add_u32 m0, s42, 66560
    s_nop 0
    buffer_load_dwordx4 v9, s[8:11], s40 offen sc1 lds
    s_add_u32 m0, s42, 67584
    s_nop 0
    buffer_load_dwordx4 v10, s[8:11], s40 offen sc1 lds
    s_add_u32 m0, s42, 68608
    s_nop 0
    buffer_load_dwordx4 v11, s[8:11], s40 offen sc1 lds
    s_add_u32 s40, s40, 4096
    s_waitcnt vmcnt(16)
    s_barrier
    s_waitcnt vmcnt(12)
    s_barrier
    s_add_u32 m0, s42, 0
    s_nop 0
    buffer_load_dwordx4 v8, s[8:11], s40 offen sc1 lds
    s_add_u32 m0, s42, 1024
    s_nop 0
    buffer_load_dwordx4 v9, s[8:11], s40 offen sc1 lds
    s_add_u32 m0, s42, 2048
    s_nop 0
    buffer_load_dwordx4 v10, s[8:11], s40 offen sc1 lds
    s_add_u32 m0, s42, 3072
    s_nop 0
    buffer_load_dwordx4 v11, s[8:11], s40 offen sc1 lds
    s_add_u32 s40, s40, 4096
    s_mov_b32 s41, 1179648
    s_add_u32 m0, s43, 0
    s_nop 0
    buffer_load_dwordx4 v12, s[12:15], s41 offen lds
    s_add_u32 m0, s43, 1024
    s_nop 0
    buffer_load_dwordx4 v13, s[12:15], s41 offen lds
    s_waitcnt vmcnt(14)
    s_barrier
    s_add_u32 m0, s42, 16384
    s_nop 0
    buffer_load_dwordx4 v8, s[8:11], s40 offen sc1 lds
    s_add_u32 m0, s42, 17408
    s_nop 0
    buffer_load_dwordx4 v9, s[8:11], s40 offen sc1 lds
    s_add_u32 m0, s42, 18432
    s_nop 0
    buffer_load_dwordx4 v10, s[8:11], s40 offen sc1 lds
    s_add_u32 m0, s42, 19456
    s_nop 0
pad5_4:
    s_cbranch_execz qkv_ld_ret
    buffer_load_dwordx4 v11, s[8:11], s40 offen sc1 lds
    s_add_u32 s40, s40, 4096
    s_mov_b32 s41, 1310720
    s_add_u32 m0, s43, 8192
    s_nop 0
    buffer_load_dwordx4 v12, s[12:15], s41 offen lds
    s_add_u32 m0, s43, 9216
    s_nop 0
    buffer_load_dwordx4 v13, s[12:15], s41 offen lds
    s_waitcnt vmcnt(16)
    s_barrier
    s_add_u32 m0, s42, 32768
    s_nop 0
    buffer_load_dwordx4 v8, s[8:11], s40 offen sc1 lds
    s_add_u32 m0, s42, 33792
    s_nop 0
    buffer_load_dwordx4 v9, s[8:11], s40 offen sc1 lds
    s_add_u32 m0, s42, 34816
    s_nop 0
    buffer_load_dwordx4 v10, s[8:11], s40 offen sc1 lds
    s_add_u32 m0, s42, 35840
    s_nop 0
    buffer_load_dwordx4 v11, s[8:11], s40 offen sc1 lds
    s_add_u32 s40, s40, 4096
    s_mov_b32 s41, 1441792
    s_add_u32 m0, s43, 16384
    s_nop 0
    buffer_load_dwordx4 v12, s[12:15], s41 offen lds
    s_add_u32 m0, s43, 17408
    s_nop 0
    buffer_load_dwordx4 v13, s[12:15], s41 offen lds
    s_waitcnt vmcnt(18)
    s_barrier
    s_add_u32 m0, s42, 49152
    s_nop 0
    buffer_load_dwordx4 v8, s[8:11], s40 offen sc1 lds
    s_add_u32 m0, s42, 50176
    s_nop 0
    buffer_load_dwordx4 v9, s[8:11], s40 offen sc1 lds
    s_add_u32 m0, s42, 51200
    s_nop 0
    buffer_load_dwordx4 v10, s[8:11], s40 offen sc1 lds
    s_add_u32 m0, s42, 52224
    s_nop 0
    buffer_load_dwordx4 v11, s[8:11], s40 offen sc1 lds
    s_add_u32 s40, s40, 4096
    s_mov_b32 s41, 1572864
    s_add_u32 m0, s43, 24576
    s_nop 0
    buffer_load_dwordx4 v12, s[12:15], s41 offen lds
    s_add_u32 m0, s43, 25600
    s_nop 0
    buffer_load_dwordx4 v13, s[12:15], s41 offen lds
    s_waitcnt vmcnt(20)
    s_barrier
    s_add_u32 m0, s42, 65536
    s_nop 0
    buffer_load_dwordx4 v8, s[8:11], s40 offen sc1 lds
    s_add_u32 m0, s42, 66560
    s_nop 0
    buffer_load_dwordx4 v9, s[8:11], s40 offen sc1 lds
    s_add_u32 m0, s42, 67584
    s_nop 0
    buffer_load_dwordx4 v10, s[8:11], s40 offen sc1 lds
    s_add_u32 m0, s42, 68608
    s_nop 0
    buffer_load_dwordx4 v11, s[8:11], s40 offen sc1 lds
    s_add_u32 s40, s40, 4096
    s_mov_b32 s41, 1703936
    s_add_u32 m0, s43, 32768
    s_nop 0
    buffer_load_dwordx4 v12, s[12:15], s41 offen lds
    s_add_u32 m0, s43, 33792
    s_nop 0
    buffer_load_dwordx4 v13, s[12:15], s41 offen lds
    s_waitcnt vmcnt(20)
    s_barrier
    s_add_u32 m0, s42, 0
padc6:
    s_cbranch_execz pad6_1
    s_nop 0
    buffer_load_dwordx4 v8, s[8:11], s40 offen sc1 lds
    s_add_u32 m0, s42, 1024
    s_nop 0
    buffer_load_dwordx4 v9, s[8:11], s40 offen sc1 lds
    s_add_u32 m0, s42, 2048
    s_nop 0
    buffer_load_dwordx4 v10, s[8:11], s40 offen sc1 lds
    s_add_u32 m0, s42, 3072
    s_nop 0
    buffer_load_dwordx4 v11, s[8:11], s40 offen sc1 lds
    s_add_u32 s40, s40, 4096
    s_mov_b32 s41, 1835008
    s_add_u32 m0, s43, 40960
    s_nop 0
    buffer_load_dwordx4 v12, s[12:15], s41 offen lds
    s_add_u32 m0, s43, 41984
    s_nop 0
    buffer_load_dwordx4 v13, s[12:15], s41 offen lds
    s_waitcnt vmcnt(20)
    s_barrier
    s_add_u32 m0, s42, 16384
    s_nop 0
    buffer_load_dwordx4 v8, s[8:11], s40 offen sc1 lds
    s_add_u32 m0, s42, 17408
    s_nop 0
    buffer_load_dwordx4 v9, s[8:11], s40 offen sc1 lds
    s_add_u32 m0, s42, 18432
    s_nop 0
    buffer_load_dwordx4 v10, s[8:11], s40 offen sc1 lds
    s_add_u32 m0, s42, 19456
    s_nop 0
    buffer_load_dwordx4 v11, s[8:11], s40 offen sc1 lds
    s_add_u32 s40, s40, 4096
    s_mov_b32 s41, 1966080
    s_add_u32 m0, s43, 49152
    s_nop 0
    buffer_load_dwordx4 v12, s[12:15], s41 offen lds
    s_add_u32 m0, s43, 50176
    s_nop 0
    buffer_load_dwordx4 v13, s[12:15], s41 offen lds
    s_waitcnt vmcnt(20)
    s_barrier
    s_add_u32 m0, s42, 32768
    s_nop 0
    buffer_load_dwordx4 v8, s[8:11], s40 offen sc1 lds
    s_add_u32 m0, s42, 33792
    s_nop 0
    buffer_load_dwordx4 v9, s[8:11], s40 offen sc1 lds
    s_add_u32 m0, s42, 34816
    s_nop 0
    buffer_load_dwordx4 v10, s[8:11], s40 offen sc1 lds
    s_add_u32 m0, s42, 35840
    s_nop 0
    buffer_load_dwordx4 v11, s[8:11], s40 offen sc1 lds
    s_add_u32 s40, s40, 4096
    s_waitcnt vmcnt(18)
    s_barrier
    s_add_u32 m0, s42, 49152
    s_nop 0
    buffer_load_dwordx4 v8, s[8:11], s40 offen sc1 lds
    s_add_u32 m0, s42, 50176
    s_nop 0
    buffer_load_dwordx4 v9, s[8:11], s40 offen sc1 lds
    s_add_u32 m0, s42, 51200
    s_nop 0
    buffer_load_dwordx4 v10, s[8:11], s40 offen sc1 lds
    s_add_u32 m0, s42, 52224
    s_nop 0
    buffer_load_dwordx4 v11, s[8:11], s40 offen sc1 lds
    s_add_u32 s40, s40, 4096
    s_mov_b32 s54, 229376
    s_add_u32 m0, s55, 122880
    s_nop 0
    buffer_load_dwordx4 v20, s[20:23], s54 offen lds
    s_add_u32 m0, s55, 123904
    s_nop 0
    buffer_load_dwordx4 v21, s[20:23], s54 offen lds
pad6_1:
    s_cbranch_execz pad6_2
    s_add_u32 m0, s55, 124928
    s_nop 0
    buffer_load_dwordx4 v22, s[20:23], s54 offen lds
    s_and_b32 s44, s52, 122880
    s_add_u32 s44, s44, s53
    s_add_u32 m0, s44, 3072
    s_nop 0
    buffer_load_dwordx4 v23, s[20:23], s54 offen lds
    s_waitcnt vmcnt(20)
    s_barrier
    s_add_u32 m0, s42, 65536
    s_nop 0
    buffer_load_dwordx4 v8, s[8:11], s40 offen sc1 lds
    s_add_u32 m0, s42, 66560
    s_nop 0
    buffer_load_dwordx4 v9, s[8:11], s40 offen sc1 lds
    s_add_u32 m0, s42, 67584
    s_nop 0
    buffer_load_dwordx4 v10, s[8:11], s40 offen sc1 lds
    s_add_u32 m0, s42, 68608
    s_nop 0
    buffer_load_dwordx4 v11, s[8:11], s40 offen sc1 lds
    s_add_u32 s40, s40, 4096
    s_waitcnt vmcnt(18)
    s_barrier
    s_add_u32 m0, s42, 0
    s_nop 0
    buffer_load_dwordx4 v8, s[8:11], s40 offen sc1 lds
    s_add_u32 m0, s42, 1024
    s_nop 0
    buffer_load_dwordx4 v9, s[8:11], s40 offen sc1 lds
    s_add_u32 m0, s42, 2048
    s_nop 0
    buffer_load_dwordx4 v10, s[8:11], s40 offen sc1 lds
    s_add_u32 m0, s42, 3072
    s_nop 0
    buffer_load_dwordx4 v11, s[8:11], s40 offen sc1 lds
    s_add_u32 s40, s40, 4096
    s_waitcnt vmcnt(16)
    s_barrier
    s_mov_b32 s54, 458752
    s_add_u32 m0, s55, 0
    s_nop 0
    buffer_load_dwordx4 v20, s[20:23], s54 offen lds
    s_add_u32 m0, s55, 1024
    s_nop 0
    buffer_load_dwordx4 v21, s[20:23], s54 offen lds
    s_add_u32 m0, s55, 2048
    s_nop 0
    buffer_load_dwordx4 v22, s[20:23], s54 offen lds
    s_and_b32 s44, s52, 0
    s_add_u32 s44, s44, s53
    s_add_u32 m0, s44, 3072
    s_nop 0
    buffer_load_dwordx4 v23, s[20:23], s54 offen lds
    s_waitcnt vmcnt(16)
    s_barrier
    s_waitcnt vmcnt(8)
    s_barrier
    s_mov_b32 s54, 0
    s_add_u32 m0, s55, 92160
    s_nop 0
    buffer_load_dwordx4 v20, s[20:23], s54 offen lds
    s_add_u32 m0, s55, 93184
    s_nop 0
    buffer_load_dwordx4 v21, s[20:23], s54 offen lds
    s_add_u32 m0, s55, 94208
    s_nop 0
    buffer_load_dwordx4 v22, s[20:23], s54 offen lds
    s_and_b32 s44, s52, 92160
    s_add_u32 s44, s44, s53
    s_add_u32 m0, s44, 3072
    s_nop 0
    buffer_load_dwordx4 v23, s[20:23], s54 offen lds
    s_waitcnt vmcnt(8)
    s_barrier
    s_branch gu_begin
wo_comp:
    s_lshl_b32 s32, s30, 2
    s_add_u32 s32, s32, s3
    v_lshlrev_b32 v177, 4, v0
    v_and_b32 v2, 31, v0
    v_lshlrev_b32 v2, 11, v2
    v_lshrrev_b32 v3, 5, v0
    v_lshlrev_b32 v3, 4, v3
    v_add_u32 v178, v2, v3
    s_lshl_b32 s33, s32, 16
    s_lshl_b32 s34, s31, 7
pad6_2:
    s_cbranch_execz pad6_3
    s_add_u32 s33, s33, s34
    s_lshl_b32 s34, s32, 6
    s_lshl_b32 s35, s31, 2
    s_add_u32 s34, s34, s35
    s_lshl_b32 s34, s34, 10
    s_mov_b32 s8, s24
    s_mov_b32 s9, s25
    s_mov_b32 s10, 0x400000
    s_mov_b32 s11, 0x00020000
    buffer_load_dwordx4 v[136:139], v178, s[8:11], s33 offen offset:0
    buffer_load_dwordx4 v[140:143], v178, s[8:11], s33 offen offset:32
    buffer_load_dwordx4 v[144:147], v178, s[8:11], s33 offen offset:64
    buffer_load_dwordx4 v[148:151], v178, s[8:11], s33 offen offset:96
    s_add_u32 s16, s6, 0x2900000
    s_addc_u32 s17, s7, 0
    s_mov_b32 s18, 0x50000
    s_mov_b32 s19, 0x00020000
    s_lshl_b32 s35, s32, 12
    s_add_u32 s35, s35, 65536
    s_lshl_b32 s36, s32, 7
    v_and_b32 v2, 31, v0
    v_lshlrev_b32 v2, 2, v2
    v_lshlrev_b32 v5, 2, v0
    s_lshl_b32 s39, s3, 12
    v_add_u32 v175, s39, v177
    v_lshrrev_b32 v4, 5, v0
    v_mul_u32_u24 v176, 1024, v4
    v_bfe_u32 v4, v0, 2, 2
    v_lshlrev_b32 v4, 6, v4
    v_add_u32 v176, v176, v4
    v_bfe_u32 v4, v0, 4, 1
    v_mul_u32_u24 v4, 32, v4
    v_add_u32 v176, v176, v4
    v_and_b32 v4, 1, v0
    v_lshlrev_b32 v4, 4, v4
    v_bfe_u32 v3, v0, 1, 1
    v_lshlrev_b32 v3, 3, v3
    v_add3_u32 v176, v176, v4, v3
    v_add_u32 v176, 81920, v176
    v_mov_b32 v173, v175
    v_mov_b32 v174, v176
    s_mov_b32 s60, 0
    v_mov_b32 v8, 0
    v_mov_b32 v9, 0
    v_mov_b32 v10, 0
    v_mov_b32 v11, 0
    v_mov_b32 v12, 0
    v_mov_b32 v13, 0
    v_mov_b32 v14, 0
    v_mov_b32 v15, 0
    v_mov_b32 v16, 0
    v_mov_b32 v17, 0
    v_mov_b32 v18, 0
    v_mov_b32 v19, 0
    v_mov_b32 v20, 0
    v_mov_b32 v21, 0
    v_mov_b32 v22, 0
    v_mov_b32 v23, 0
    v_mov_b32 v24, 0
    v_mov_b32 v25, 0
    v_mov_b32 v26, 0
    v_mov_b32 v27, 0
    v_mov_b32 v28, 0
    v_mov_b32 v29, 0
    v_mov_b32 v30, 0
    v_mov_b32 v31, 0
    v_mov_b32 v32, 0
    v_mov_b32 v33, 0
    v_mov_b32 v34, 0
    v_mov_b32 v35, 0
    v_mov_b32 v36, 0
    v_mov_b32 v37, 0
    v_mov_b32 v38, 0
    v_mov_b32 v39, 0
    s_add_u32 s44, s6, 0x1000000
    s_addc_u32 s45, s7, 0
    s_mov_b32 s46, 0x400000
    s_mov_b32 s47, 0x00020000
    s_mov_b32 s58, 0
    s_lshl_b32 s37, s30, 4
    s_add_u32 s37, s37, s31
    s_and_b32 s38, s31, 7
    s_lshl_b32 s38, s38, 13
    s_lshl_b32 s39, s32, 16
    s_add_u32 s38, s38, s39
    v_lshlrev_b32 v6, 7, v0
    s_mov_b64 exec, 0
    s_cmp_eq_u32 s3, 1
    s_cbranch_scc1 padc12
    s_cmp_eq_u32 s3, 2
    s_cbranch_scc1 padc13
    s_cmp_eq_u32 s3, 3
    s_cbranch_scc1 padc14
wo_warm_ret2:
    s_mov_b64 exec, -1
    s_cmp_eq_u32 s3, 0
    s_cbranch_scc0 qkv_pl17
    s_lshl_b32 s58, s37, 7
    s_add_u32 s56, s86, s58
    s_addc_u32 s57, s87, 0
    s_add_u32 s56, s56, 0x4400000
    s_addc_u32 s57, s57, 0
    s_mov_b32 s58, 0x40000
qkv_pll18:
    s_load_dwordx8 s[48:55], s[56:57], 0 glc
    s_waitcnt lgkmcnt(0)
    s_and_b32 s48, s48, s49
pad6_3:
    s_cbranch_execz qkv_ld_ret
    s_and_b32 s50, s50, s51
    s_and_b32 s52, s52, s53
    s_and_b32 s54, s54, s55
    s_and_b32 s48, s48, s50
    s_and_b32 s52, s52, s54
    s_and_b32 s48, s48, s52
    s_cmp_eq_u32 s48, 0x01010101
    s_cbranch_scc1 qkv_pl17x
    s_sub_u32 s58, s58, 1
    s_cbranch_scc0 qkv_pll18
qkv_pl17x:
qkv_pl17:
    s_mov_b32 s58, 0
    s_barrier
    buffer_load_dword v152, v5, s[16:19], s35 offen offset:0 sc1
    buffer_load_dword v153, v5, s[16:19], s35 offen offset:256 sc1
    buffer_load_dword v154, v5, s[16:19], s35 offen offset:512 sc1
    buffer_load_dword v155, v5, s[16:19], s35 offen offset:768 sc1
    buffer_load_dword v156, v5, s[16:19], s35 offen offset:1024 sc1
    buffer_load_dword v157, v5, s[16:19], s35 offen offset:1280 sc1
    buffer_load_dword v158, v5, s[16:19], s35 offen offset:1536 sc1
    buffer_load_dword v159, v5, s[16:19], s35 offen offset:1792 sc1
    buffer_load_dword v160, v5, s[16:19], s35 offen offset:2048 sc1
    buffer_load_dword v161, v5, s[16:19], s35 offen offset:2304 sc1
    buffer_load_dword v162, v5, s[16:19], s35 offen offset:2560 sc1
    buffer_load_dword v163, v5, s[16:19], s35 offen offset:2816 sc1
    buffer_load_dword v164, v5, s[16:19], s35 offen offset:3072 sc1
    buffer_load_dword v165, v5, s[16:19], s35 offen offset:3328 sc1
    buffer_load_dword v166, v5, s[16:19], s35 offen offset:3584 sc1
    buffer_load_dword v167, v5, s[16:19], s35 offen offset:3840 sc1
    buffer_load_dword v168, v2, s[16:19], s36 offen sc1
    s_barrier
    s_add_u32 s8, s6, 0x2a00000
    s_addc_u32 s9, s7, 0
    s_mov_b32 s10, 0x400000
    s_mov_b32 s11, 0x00020000
    s_add_u32 s16, s6, 0x2800000
    s_addc_u32 s17, s7, 0
    s_mov_b32 s18, 0x22000
    s_mov_b32 s19, 0x00020000
    ds_read_b128 v[40:43], v173 offset:0
    ds_read_b64_tr_b16 v[72:73], v174 offset:0
    ds_read_b64_tr_b16 v[74:75], v174 offset:512
    ds_read_b64_tr_b16 v[76:77], v174 offset:256
    ds_read_b64_tr_b16 v[78:79], v174 offset:768
    ds_read_b128 v[44:47], v173 offset:1024
    ds_read_b64_tr_b16 v[80:81], v174 offset:2048
    ds_read_b64_tr_b16 v[82:83], v174 offset:2560
    ds_read_b64_tr_b16 v[84:85], v174 offset:2304
    ds_read_b64_tr_b16 v[86:87], v174 offset:2816
    ds_read_b128 v[48:51], v173 offset:2048
    ds_read_b64_tr_b16 v[88:89], v174 offset:4096
    ds_read_b64_tr_b16 v[90:91], v174 offset:4608
    ds_read_b64_tr_b16 v[92:93], v174 offset:4352
    ds_read_b64_tr_b16 v[94:95], v174 offset:4864
    ds_read_b128 v[52:55], v173 offset:3072
    ds_read_b64_tr_b16 v[96:97], v174 offset:6144
    ds_read_b64_tr_b16 v[98:99], v174 offset:6656
    ds_read_b64_tr_b16 v[100:101], v174 offset:6400
    ds_read_b64_tr_b16 v[102:103], v174 offset:6912
    s_add_u32 s60, s60, 16384
    s_cmp_ge_u32 s60, 81920
    s_cselect_b32 s60, 0, s60
    s_add_u32 s58, s58, 8192
    s_cmp_ge_u32 s58, 73728
    s_cselect_b32 s58, 0, s58
    v_add_u32 v173, s60, v175
    v_add_u32 v174, s58, v176
    s_waitcnt lgkmcnt(0)
    s_barrier
    v_mfma_f32_32x32x16_bf16 v[8:23], v[72:75], v[40:43], v[8:23]
    ds_read_b128 v[56:59], v173 offset:0
    ds_read_b64_tr_b16 v[104:105], v174 offset:0
    ds_read_b64_tr_b16 v[106:107], v174 offset:512
    v_mfma_f32_32x32x16_bf16 v[24:39], v[76:79], v[40:43], v[24:39]
    ds_read_b64_tr_b16 v[108:109], v174 offset:256
padc7:
    s_cbranch_execz pad7_1
    ds_read_b64_tr_b16 v[110:111], v174 offset:768
    ds_read_b128 v[60:63], v173 offset:1024
    v_mfma_f32_32x32x16_bf16 v[8:23], v[80:83], v[44:47], v[8:23]
    ds_read_b64_tr_b16 v[112:113], v174 offset:2048
    ds_read_b64_tr_b16 v[114:115], v174 offset:2560
    ds_read_b64_tr_b16 v[116:117], v174 offset:2304
    v_mfma_f32_32x32x16_bf16 v[24:39], v[84:87], v[44:47], v[24:39]
    ds_read_b64_tr_b16 v[118:119], v174 offset:2816
    ds_read_b128 v[64:67], v173 offset:2048
    ds_read_b64_tr_b16 v[120:121], v174 offset:4096
    v_mfma_f32_32x32x16_bf16 v[8:23], v[88:91], v[48:51], v[8:23]
    ds_read_b64_tr_b16 v[122:123], v174 offset:4608
    ds_read_b64_tr_b16 v[124:125], v174 offset:4352
    ds_read_b64_tr_b16 v[126:127], v174 offset:4864
    v_mfma_f32_32x32x16_bf16 v[24:39], v[92:95], v[48:51], v[24:39]
    ds_read_b128 v[68:71], v173 offset:3072
    ds_read_b64_tr_b16 v[128:129], v174 offset:6144
    ds_read_b64_tr_b16 v[130:131], v174 offset:6656
    v_mfma_f32_32x32x16_bf16 v[8:23], v[96:99], v[52:55], v[8:23]
    ds_read_b64_tr_b16 v[132:133], v174 offset:6400
    ds_read_b64_tr_b16 v[134:135], v174 offset:6912
    v_mfma_f32_32x32x16_bf16 v[24:39], v[100:103], v[52:55], v[24:39]
    s_add_u32 s60, s60, 16384
    s_cmp_ge_u32 s60, 81920
    s_cselect_b32 s60, 0, s60
    s_add_u32 s58, s58, 8192
    s_cmp_ge_u32 s58, 73728
    s_cselect_b32 s58, 0, s58
    v_add_u32 v173, s60, v175
    v_add_u32 v174, s58, v176
    s_waitcnt lgkmcnt(0)
    s_barrier
    v_mfma_f32_32x32x16_bf16 v[8:23], v[104:107], v[56:59], v[8:23]
    ds_read_b128 v[40:43], v173 offset:0
    ds_read_b64_tr_b16 v[72:73], v174 offset:0
    ds_read_b64_tr_b16 v[74:75], v174 offset:512
    v_mfma_f32_32x32x16_bf16 v[24:39], v[108:111], v[56:59], v[24:39]
    ds_read_b64_tr_b16 v[76:77], v174 offset:256
    ds_read_b64_tr_b16 v[78:79], v174 offset:768
    ds_read_b128 v[44:47], v173 offset:1024
    v_mfma_f32_32x32x16_bf16 v[8:23], v[112:115], v[60:63], v[8:23]
    ds_read_b64_tr_b16 v[80:81], v174 offset:2048
    ds_read_b64_tr_b16 v[82:83], v174 offset:2560
    ds_read_b64_tr_b16 v[84:85], v174 offset:2304
    v_mfma_f32_32x32x16_bf16 v[24:39], v[116:119], v[60:63], v[24:39]
    ds_read_b64_tr_b16 v[86:87], v174 offset:2816
    ds_read_b128 v[48:51], v173 offset:2048
    ds_read_b64_tr_b16 v[88:89], v174 offset:4096
    v_mfma_f32_32x32x16_bf16 v[8:23], v[120:123], v[64:67], v[8:23]
    ds_read_b64_tr_b16 v[90:91], v174 offset:4608
    ds_read_b64_tr_b16 v[92:93], v174 offset:4352
    ds_read_b64_tr_b16 v[94:95], v174 offset:4864
    v_mfma_f32_32x32x16_bf16 v[24:39], v[124:127], v[64:67], v[24:39]
    ds_read_b128 v[52:55], v173 offset:3072
    ds_read_b64_tr_b16 v[96:97], v174 offset:6144
    ds_read_b64_tr_b16 v[98:99], v174 offset:6656
    v_mfma_f32_32x32x16_bf16 v[8:23], v[128:131], v[68:71], v[8:23]
    ds_read_b64_tr_b16 v[100:101], v174 offset:6400
    ds_read_b64_tr_b16 v[102:103], v174 offset:6912
    v_mfma_f32_32x32x16_bf16 v[24:39], v[132:135], v[68:71], v[24:39]
    s_add_u32 s60, s60, 16384
    s_cmp_ge_u32 s60, 81920
    s_cselect_b32 s60, 0, s60
    s_add_u32 s58, s58, 8192
    s_cmp_ge_u32 s58, 73728
    s_cselect_b32 s58, 0, s58
    v_add_u32 v173, s60, v175
    v_add_u32 v174, s58, v176
pad7_1:
    s_cbranch_execz pad7_2
    s_waitcnt vmcnt(0)
    v_pk_add_f32 v[152:153], v[152:153], v[154:155]
    v_pk_add_f32 v[152:153], v[152:153], v[156:157]
    v_pk_add_f32 v[152:153], v[152:153], v[158:159]
    v_pk_add_f32 v[152:153], v[152:153], v[160:161]
    v_pk_add_f32 v[152:153], v[152:153], v[162:163]
    v_pk_add_f32 v[152:153], v[152:153], v[164:165]
    v_pk_add_f32 v[152:153], v[152:153], v[166:167]
    v_add_f32 v152, v152, v153
    v_mov_b32 v4, v152
    s_nop 1
    v_permlane32_swap_b32 v152, v4
    v_add_f32 v152, v152, v4
    v_add_f32 v152, v152, v168
    v_sub_f32 v154, 0, v152
    v_lshlrev_b32 v156, 16, v136
    v_and_b32 v157, 0xffff0000, v136
    v_pk_add_f32 v[156:157], v[156:157], v[154:155] op_sel_hi:[1,0]
    v_pk_add_f32 v[8:9], v[8:9], v[156:157]
    v_lshlrev_b32 v158, 16, v137
    v_and_b32 v159, 0xffff0000, v137
    v_pk_add_f32 v[158:159], v[158:159], v[154:155] op_sel_hi:[1,0]
    v_pk_add_f32 v[10:11], v[10:11], v[158:159]
    v_lshlrev_b32 v160, 16, v138
    v_and_b32 v161, 0xffff0000, v138
    v_pk_add_f32 v[160:161], v[160:161], v[154:155] op_sel_hi:[1,0]
    v_pk_add_f32 v[12:13], v[12:13], v[160:161]
    v_lshlrev_b32 v162, 16, v139
    v_and_b32 v163, 0xffff0000, v139
    v_pk_add_f32 v[162:163], v[162:163], v[154:155] op_sel_hi:[1,0]
    v_pk_add_f32 v[14:15], v[14:15], v[162:163]
    v_lshlrev_b32 v156, 16, v140
    v_and_b32 v157, 0xffff0000, v140
    v_pk_add_f32 v[156:157], v[156:157], v[154:155] op_sel_hi:[1,0]
    v_pk_add_f32 v[16:17], v[16:17], v[156:157]
    v_lshlrev_b32 v158, 16, v141
    v_and_b32 v159, 0xffff0000, v141
    v_pk_add_f32 v[158:159], v[158:159], v[154:155] op_sel_hi:[1,0]
    v_pk_add_f32 v[18:19], v[18:19], v[158:159]
    v_lshlrev_b32 v160, 16, v142
    v_and_b32 v161, 0xffff0000, v142
    v_pk_add_f32 v[160:161], v[160:161], v[154:155] op_sel_hi:[1,0]
    v_pk_add_f32 v[20:21], v[20:21], v[160:161]
    v_lshlrev_b32 v162, 16, v143
    v_and_b32 v163, 0xffff0000, v143
    v_pk_add_f32 v[162:163], v[162:163], v[154:155] op_sel_hi:[1,0]
    v_pk_add_f32 v[22:23], v[22:23], v[162:163]
    v_lshlrev_b32 v156, 16, v144
    v_and_b32 v157, 0xffff0000, v144
    v_pk_add_f32 v[156:157], v[156:157], v[154:155] op_sel_hi:[1,0]
    v_pk_add_f32 v[24:25], v[24:25], v[156:157]
    v_lshlrev_b32 v158, 16, v145
    v_and_b32 v159, 0xffff0000, v145
    v_pk_add_f32 v[158:159], v[158:159], v[154:155] op_sel_hi:[1,0]
    v_pk_add_f32 v[26:27], v[26:27], v[158:159]
    v_lshlrev_b32 v160, 16, v146
    v_and_b32 v161, 0xffff0000, v146
    v_pk_add_f32 v[160:161], v[160:161], v[154:155] op_sel_hi:[1,0]
    v_pk_add_f32 v[28:29], v[28:29], v[160:161]
    v_lshlrev_b32 v162, 16, v147
    v_and_b32 v163, 0xffff0000, v147
    v_pk_add_f32 v[162:163], v[162:163], v[154:155] op_sel_hi:[1,0]
    v_pk_add_f32 v[30:31], v[30:31], v[162:163]
    v_lshlrev_b32 v156, 16, v148
    v_and_b32 v157, 0xffff0000, v148
    v_pk_add_f32 v[156:157], v[156:157], v[154:155] op_sel_hi:[1,0]
    v_pk_add_f32 v[32:33], v[32:33], v[156:157]
    v_lshlrev_b32 v158, 16, v149
    v_and_b32 v159, 0xffff0000, v149
    v_pk_add_f32 v[158:159], v[158:159], v[154:155] op_sel_hi:[1,0]
    v_pk_add_f32 v[34:35], v[34:35], v[158:159]
    v_lshlrev_b32 v160, 16, v150
    v_and_b32 v161, 0xffff0000, v150
    v_pk_add_f32 v[160:161], v[160:161], v[154:155] op_sel_hi:[1,0]
    v_pk_add_f32 v[36:37], v[36:37], v[160:161]
pad7_2:
    s_cbranch_execz pad7_3
    v_lshlrev_b32 v162, 16, v151
    v_and_b32 v163, 0xffff0000, v151
    v_pk_add_f32 v[162:163], v[162:163], v[154:155] op_sel_hi:[1,0]
    v_pk_add_f32 v[38:39], v[38:39], v[162:163]
    s_waitcnt lgkmcnt(0)
    s_barrier
    v_mfma_f32_32x32x16_bf16 v[8:23], v[72:75], v[40:43], v[8:23]
    ds_read_b128 v[56:59], v173 offset:0
    ds_read_b64_tr_b16 v[104:105], v174 offset:0
    ds_read_b64_tr_b16 v[106:107], v174 offset:512
    v_mfma_f32_32x32x16_bf16 v[24:39], v[76:79], v[40:43], v[24:39]
    ds_read_b64_tr_b16 v[108:109], v174 offset:256
    ds_read_b64_tr_b16 v[110:111], v174 offset:768
    ds_read_b128 v[60:63], v173 offset:1024
    v_mfma_f32_32x32x16_bf16 v[8:23], v[80:83], v[44:47], v[8:23]
    ds_read_b64_tr_b16 v[112:113], v174 offset:2048
    ds_read_b64_tr_b16 v[114:115], v174 offset:2560
    ds_read_b64_tr_b16 v[116:117], v174 offset:2304
    v_mfma_f32_32x32x16_bf16 v[24:39], v[84:87], v[44:47], v[24:39]
    ds_read_b64_tr_b16 v[118:119], v174 offset:2816
    ds_read_b128 v[64:67], v173 offset:2048
    ds_read_b64_tr_b16 v[120:121], v174 offset:4096
    v_mfma_f32_32x32x16_bf16 v[8:23], v[88:91], v[48:51], v[8:23]
    ds_read_b64_tr_b16 v[122:123], v174 offset:4608
    ds_read_b64_tr_b16 v[124:125], v174 offset:4352
    ds_read_b64_tr_b16 v[126:127], v174 offset:4864
    v_mfma_f32_32x32x16_bf16 v[24:39], v[92:95], v[48:51], v[24:39]
    ds_read_b128 v[68:71], v173 offset:3072
    ds_read_b64_tr_b16 v[128:129], v174 offset:6144
    ds_read_b64_tr_b16 v[130:131], v174 offset:6656
    v_mfma_f32_32x32x16_bf16 v[8:23], v[96:99], v[52:55], v[8:23]
    ds_read_b64_tr_b16 v[132:133], v174 offset:6400
    ds_read_b64_tr_b16 v[134:135], v174 offset:6912
    v_mfma_f32_32x32x16_bf16 v[24:39], v[100:103], v[52:55], v[24:39]
    s_mov_b32 s61, 6
    .p2align 4
qkv_loop19:
    s_add_u32 s60, s60, 16384
    s_cmp_ge_u32 s60, 81920
    s_cselect_b32 s60, 0, s60
    s_add_u32 s58, s58, 8192
    s_cmp_ge_u32 s58, 73728
    s_cselect_b32 s58, 0, s58
    v_add_u32 v173, s60, v175
    v_add_u32 v174, s58, v176
    s_waitcnt lgkmcnt(0)
    s_barrier
    v_mfma_f32_32x32x16_bf16 v[8:23], v[104:107], v[56:59], v[8:23]
    ds_read_b128 v[40:43], v173 offset:0
    ds_read_b64_tr_b16 v[72:73], v174 offset:0
    ds_read_b64_tr_b16 v[74:75], v174 offset:512
    v_mfma_f32_32x32x16_bf16 v[24:39], v[108:111], v[56:59], v[24:39]
    ds_read_b64_tr_b16 v[76:77], v174 offset:256
    ds_read_b64_tr_b16 v[78:79], v174 offset:768
    ds_read_b128 v[44:47], v173 offset:1024
    v_mfma_f32_32x32x16_bf16 v[8:23], v[112:115], v[60:63], v[8:23]
    ds_read_b64_tr_b16 v[80:81], v174 offset:2048
    ds_read_b64_tr_b16 v[82:83], v174 offset:2560
    ds_read_b64_tr_b16 v[84:85], v174 offset:2304
    v_mfma_f32_32x32x16_bf16 v[24:39], v[116:119], v[60:63], v[24:39]
    ds_read_b64_tr_b16 v[86:87], v174 offset:2816
    ds_read_b128 v[48:51], v173 offset:2048
    ds_read_b64_tr_b16 v[88:89], v174 offset:4096
    v_mfma_f32_32x32x16_bf16 v[8:23], v[120:123], v[64:67], v[8:23]
    ds_read_b64_tr_b16 v[90:91], v174 offset:4608
    ds_read_b64_tr_b16 v[92:93], v174 offset:4352
    ds_read_b64_tr_b16 v[94:95], v174 offset:4864
    v_mfma_f32_32x32x16_bf16 v[24:39], v[124:127], v[64:67], v[24:39]
    ds_read_b128 v[52:55], v173 offset:3072
    ds_read_b64_tr_b16 v[96:97], v174 offset:6144
    ds_read_b64_tr_b16 v[98:99], v174 offset:6656
    v_mfma_f32_32x32x16_bf16 v[8:23], v[128:131], v[68:71], v[8:23]
    ds_read_b64_tr_b16 v[100:101], v174 offset:6400
    ds_read_b64_tr_b16 v[102:103], v174 offset:6912
    v_mfma_f32_32x32x16_bf16 v[24:39], v[132:135], v[68:71], v[24:39]
    s_add_u32 s60, s60, 16384
    s_cmp_ge_u32 s60, 81920
    s_cselect_b32 s60, 0, s60
    s_add_u32 s58, s58, 8192
    s_cmp_ge_u32 s58, 73728
    s_cselect_b32 s58, 0, s58
    v_add_u32 v173, s60, v175
    v_add_u32 v174, s58, v176
    s_waitcnt lgkmcnt(0)
    s_barrier
    v_mfma_f32_32x32x16_bf16 v[8:23], v[72:75], v[40:43], v[8:23]
    ds_read_b128 v[56:59], v173 offset:0
    ds_read_b64_tr_b16 v[104:105], v174 offset:0
    ds_read_b64_tr_b16 v[106:107], v174 offset:512
    v_mfma_f32_32x32x16_bf16 v[24:39], v[76:79], v[40:43], v[24:39]
    ds_read_b64_tr_b16 v[108:109], v174 offset:256
    ds_read_b64_tr_b16 v[110:111], v174 offset:768
    ds_read_b128 v[60:63], v173 offset:1024
    v_mfma_f32_32x32x16_bf16 v[8:23], v[80:83], v[44:47], v[8:23]
    ds_read_b64_tr_b16 v[112:113], v174 offset:2048
    ds_read_b64_tr_b16 v[114:115], v174 offset:2560
    ds_read_b64_tr_b16 v[116:117], v174 offset:2304
    v_mfma_f32_32x32x16_bf16 v[24:39], v[84:87], v[44:47], v[24:39]
    ds_read_b64_tr_b16 v[118:119], v174 offset:2816
    ds_read_b128 v[64:67], v173 offset:2048
    ds_read_b64_tr_b16 v[120:121], v174 offset:4096
    v_mfma_f32_32x32x16_bf16 v[8:23], v[88:91], v[48:51], v[8:23]
    ds_read_b64_tr_b16 v[122:123], v174 offset:4608
    ds_read_b64_tr_b16 v[124:125], v174 offset:4352
    ds_read_b64_tr_b16 v[126:127], v174 offset:4864
    v_mfma_f32_32x32x16_bf16 v[24:39], v[92:95], v[48:51], v[24:39]
    ds_read_b128 v[68:71], v173 offset:3072
    ds_read_b64_tr_b16 v[128:129], v174 offset:6144
    ds_read_b64_tr_b16 v[130:131], v174 offset:6656
    v_mfma_f32_32x32x16_bf16 v[8:23], v[96:99], v[52:55], v[8:23]
    ds_read_b64_tr_b16 v[132:133], v174 offset:6400
    ds_read_b64_tr_b16 v[134:135], v174 offset:6912
    v_mfma_f32_32x32x16_bf16 v[24:39], v[100:103], v[52:55], v[24:39]
    s_sub_u32 s61, s61, 1
    s_cmp_lg_u32 s61, 0
    s_cbranch_scc1 qkv_loop19
pad7_3:
    s_cbranch_execz pad7_4
    s_waitcnt lgkmcnt(15)
    v_mfma_f32_32x32x16_bf16 v[8:23], v[104:107], v[56:59], v[8:23]
    v_mfma_f32_32x32x16_bf16 v[24:39], v[108:111], v[56:59], v[24:39]
    s_waitcnt lgkmcnt(12)
    v_mfma_f32_32x32x16_bf16 v[8:23], v[112:115], v[60:63], v[8:23]
    s_waitcnt lgkmcnt(10)
    v_mfma_f32_32x32x16_bf16 v[24:39], v[116:119], v[60:63], v[24:39]
    s_waitcnt lgkmcnt(7)
    v_mfma_f32_32x32x16_bf16 v[8:23], v[120:123], v[64:67], v[8:23]
    s_waitcnt lgkmcnt(5)
    v_mfma_f32_32x32x16_bf16 v[24:39], v[124:127], v[64:67], v[24:39]
    s_waitcnt lgkmcnt(2)
    v_mfma_f32_32x32x16_bf16 v[8:23], v[128:131], v[68:71], v[8:23]
    s_waitcnt lgkmcnt(0)
    v_mfma_f32_32x32x16_bf16 v[24:39], v[132:135], v[68:71], v[24:39]
    s_nop 9
    v_cvt_pk_bf16_f32 v136, v8, v9
    v_cvt_pk_bf16_f32 v137, v10, v11
    v_cvt_pk_bf16_f32 v138, v12, v13
    v_cvt_pk_bf16_f32 v139, v14, v15
    buffer_store_dwordx4 v[136:139], v177, s[8:11], s34 offen offset:0 sc1
    v_cvt_pk_bf16_f32 v140, v16, v17
    v_cvt_pk_bf16_f32 v141, v18, v19
    v_cvt_pk_bf16_f32 v142, v20, v21
    v_cvt_pk_bf16_f32 v143, v22, v23
    buffer_store_dwordx4 v[140:143], v177, s[8:11], s34 offen offset:1024 sc1
    v_cvt_pk_bf16_f32 v144, v24, v25
    v_cvt_pk_bf16_f32 v145, v26, v27
    v_cvt_pk_bf16_f32 v146, v28, v29
    v_cvt_pk_bf16_f32 v147, v30, v31
    buffer_store_dwordx4 v[144:147], v177, s[8:11], s34 offen offset:2048 sc1
    v_cvt_pk_bf16_f32 v148, v32, v33
    v_cvt_pk_bf16_f32 v149, v34, v35
    v_cvt_pk_bf16_f32 v150, v36, v37
    v_cvt_pk_bf16_f32 v151, v38, v39
    buffer_store_dwordx4 v[148:151], v177, s[8:11], s34 offen offset:3072 sc1
    v_pk_mul_f32 v[2:3], v[8:9], v[8:9]
    v_pk_mul_f32 v[156:157], v[10:11], v[10:11]
    v_pk_fma_f32 v[2:3], v[12:13], v[12:13], v[2:3]
    v_pk_fma_f32 v[156:157], v[14:15], v[14:15], v[156:157]
    v_pk_fma_f32 v[2:3], v[16:17], v[16:17], v[2:3]
    v_pk_fma_f32 v[156:157], v[18:19], v[18:19], v[156:157]
    v_pk_fma_f32 v[2:3], v[20:21], v[20:21], v[2:3]
    v_pk_fma_f32 v[156:157], v[22:23], v[22:23], v[156:157]
    v_pk_fma_f32 v[2:3], v[24:25], v[24:25], v[2:3]
    v_pk_fma_f32 v[156:157], v[26:27], v[26:27], v[156:157]
    v_pk_fma_f32 v[2:3], v[28:29], v[28:29], v[2:3]
    v_pk_fma_f32 v[156:157], v[30:31], v[30:31], v[156:157]
    v_pk_fma_f32 v[2:3], v[32:33], v[32:33], v[2:3]
    v_pk_fma_f32 v[156:157], v[34:35], v[34:35], v[156:157]
    v_pk_fma_f32 v[2:3], v[36:37], v[36:37], v[2:3]
    v_pk_fma_f32 v[156:157], v[38:39], v[38:39], v[156:157]
    v_pk_add_f32 v[2:3], v[2:3], v[156:157]
    v_add_f32 v2, v2, v3
    v_mov_b32 v4, v2
    s_nop 1
    v_permlane32_swap_b32 v2, v4
    v_add_f32 v2, v2, v4
    s_lshl_b32 s35, s32, 11
    s_lshl_b32 s36, s31, 7
    s_add_u32 s35, s35, s36
    v_and_b32 v3, 15, v0
    v_lshlrev_b32 v3, 3, v3
    v_lshrrev_b32 v4, 4, v0
    v_lshl_add_u32 v3, v4, 2, v3
    s_lshl_b32 s36, s32, 7
    s_add_u32 s36, s36, 131072
    s_cmp_eq_u32 s31, 0
    s_cselect_b32 s36, s36, 0x40000000
    v_lshlrev_b32 v4, 2, v0
    s_mov_b32 exec_hi, 0
    buffer_store_dword v2, v3, s[16:19], s35 offen sc1
    buffer_store_dword v152, v4, s[16:19], s36 offen sc1
    s_add_u32 s96, s86, 0x4400000
    s_addc_u32 s97, s87, 0
    s_mov_b32 s98, 0x8000
    s_mov_b32 s99, 0x00020000
    v_mov_b32 v5, 163588
    v_mov_b32 v6, 1
    v_mul_u32_u24 v7, 128, v0
    s_mov_b64 exec, 1
    s_waitcnt vmcnt(0)
    ds_add_rtn_u32 v5, v5, v6
    s_waitcnt lgkmcnt(0)
    v_readfirstlane_b32 s89, v5
    s_nop 0
    s_cmp_eq_u32 s89, 3
    s_cbranch_scc0 qkv_sg20
    s_mov_b32 exec_lo, -1
    buffer_store_byte v6, v7, s[96:99], s95 offen sc1
qkv_sg20:
    s_mov_b64 exec, -1
pad7_4:
    s_cbranch_execz qkv_ld_ret
    s_branch gu_begin
gu_begin:
padc8:
    s_cbranch_execz pad8_1
    s_mov_b64 exec, -1
    s_mov_b32 s3, s93
    s_mov_b64 s[4:5], s[76:77]
    s_mov_b64 s[6:7], s[78:79]
    s_mov_b64 s[24:25], s[86:87]
    s_and_b32 s30, s90, 1
    s_lshl_b32 s30, s30, 2
    s_lshr_b32 s92, s91, 3
    s_add_u32 s30, s30, s92
    s_lshr_b32 s31, s90, 1
    s_lshl_b32 s31, s31, 3
    s_and_b32 s92, s91, 7
    s_add_u32 s31, s31, s92
    s_mul_i32 s33, s31, 112
    s_and_b32 s92, s31, 1
    s_lshl_b32 s35, s92, 4
    s_add_u32 s35, s35, s33
    s_cmp_eq_u32 s92, 0
    s_cselect_b32 s36, 96, 0
    s_add_u32 s36, s36, s33
    s_and_b32 s32, s3, 3
    s_lshl_b32 s46, s30, 3
    s_lshl_b32 s38, s32, 1
    s_add_u32 s37, s46, s38
    s_lshl_b32 s38, s37, 11
    s_lshl_b32 s46, s46, 16
    v_lshlrev_b32 v9, 4, v0
    v_lshrrev_b32 v1, 4, v0
    v_and_b32 v2, 15, v0
    v_lshlrev_b32 v2, 4, v2
    v_lshl_add_u32 v7, v1, 9, v2
    s_mov_b32 s40, 0
    s_mov_b32 s41, 0
    s_mov_b32 s62, 0
    s_mov_b32 s60, 0
    s_lshr_b32 s44, s31, 4
    s_and_b32 s45, s31, 15
    s_lshl_b32 s88, s30, 5
    s_add_u32 s88, s88, s44
    s_lshl_b32 s88, s88, 7
    s_add_u32 s88, s88, s45
    s_add_u32 s88, s88, 64
    s_cmp_ge_u32 s3, 4
    s_cbranch_scc1 gu_b
    s_mul_i32 s44, s3, 3
    s_lshl_b32 s42, s44, 10
    s_lshr_b32 s45, s44, 1
    s_lshl_b32 s45, s45, 16
    s_and_b32 s47, s44, 1
    s_lshl_b32 s47, s47, 10
    s_add_u32 s45, s45, s47
    s_add_u32 s45, s45, s46
    v_add_u32 v10, s45, v9
    s_add_u32 s44, s44, 1
    s_lshr_b32 s45, s44, 1
    s_lshl_b32 s45, s45, 16
    s_and_b32 s47, s44, 1
    s_lshl_b32 s47, s47, 10
    s_add_u32 s45, s45, s47
    s_add_u32 s45, s45, s46
    v_add_u32 v11, s45, v9
    s_add_u32 s44, s44, 1
    s_lshr_b32 s45, s44, 1
    s_lshl_b32 s45, s45, 16
    s_and_b32 s47, s44, 1
    s_lshl_b32 s47, s47, 10
    s_add_u32 s45, s45, s47
    s_add_u32 s45, s45, s46
    v_add_u32 v12, s45, v9
    s_waitcnt lgkmcnt(0)
    s_add_u32 s8, s24, 0x2a00000
    s_addc_u32 s9, s25, 0
    s_mov_b32 s10, 0x400000
    s_mov_b32 s11, 0x00020000
    s_add_u32 s16, s24, 0x2800000
    s_addc_u32 s17, s25, 0
    s_mov_b32 s18, 0x20000
    s_mov_b32 s19, 0x00020000
    s_mov_b32 s64, 30720
    s_mov_b32 s65, -122880
    s_add_u32 s42, s42, 92160
    s_mov_b32 s62, 3
    s_lshl_b32 s44, s32, 12
    v_add_u32 v7, s44, v7
    v_lshlrev_b32 v8, 8, v1
    v_bfe_u32 v2, v0, 2, 2
    v_lshl_add_u32 v8, v2, 6, v8
    v_and_b32 v2, 3, v0
    v_lshl_add_u32 v8, v2, 3, v8
    v_and_b32 v2, 1, v1
    v_lshl_add_u32 v8, v2, 5, v8
    v_add_u32 v8, 16384, v8
    s_mov_b32 s60, 92160
    v_add_u32 v4, s60, v7
    v_add_u32 v5, s60, v8
    v_xor_b32 v6, 32, v5
    v_mov_b32 v24, 0
    v_mov_b32 v25, 0
    v_mov_b32 v26, 0
    v_mov_b32 v27, 0
pad8_1:
    s_cbranch_execz pad8_2
    v_mov_b32 v28, 0
    v_mov_b32 v29, 0
    v_mov_b32 v30, 0
    v_mov_b32 v31, 0
    v_mov_b32 v32, 0
    v_mov_b32 v33, 0
    v_mov_b32 v34, 0
    v_mov_b32 v35, 0
    v_mov_b32 v36, 0
    v_mov_b32 v37, 0
    v_mov_b32 v38, 0
    v_mov_b32 v39, 0
    v_mov_b32 v40, 0
    v_mov_b32 v41, 0
    v_mov_b32 v42, 0
    v_mov_b32 v43, 0
    v_mov_b32 v44, 0
    v_mov_b32 v45, 0
    v_mov_b32 v46, 0
    v_mov_b32 v47, 0
    v_mov_b32 v48, 0
    v_mov_b32 v49, 0
    v_mov_b32 v50, 0
    v_mov_b32 v51, 0
    v_mov_b32 v52, 0
    v_mov_b32 v53, 0
    v_mov_b32 v54, 0
    v_mov_b32 v55, 0
    v_mov_b32 v56, 0
    v_mov_b32 v57, 0
    v_mov_b32 v58, 0
    v_mov_b32 v59, 0
    v_mov_b32 v60, 0
    v_mov_b32 v61, 0
    v_mov_b32 v62, 0
    v_mov_b32 v63, 0
    v_mov_b32 v64, 0
    v_mov_b32 v65, 0
    v_mov_b32 v66, 0
    v_mov_b32 v67, 0
    v_mov_b32 v68, 0
    v_mov_b32 v69, 0
    v_mov_b32 v70, 0
    v_mov_b32 v71, 0
    v_mov_b32 v72, 0
    v_mov_b32 v73, 0
    v_mov_b32 v74, 0
    v_mov_b32 v75, 0
    v_mov_b32 v76, 0
    v_mov_b32 v77, 0
    v_mov_b32 v78, 0
    v_mov_b32 v79, 0
    v_mov_b32 v80, 0
    v_mov_b32 v81, 0
    v_mov_b32 v82, 0
    v_mov_b32 v83, 0
    v_mov_b32 v84, 0
    v_mov_b32 v85, 0
    v_mov_b32 v86, 0
    v_mov_b32 v87, 0
    v_mov_b32 v88, 0
    v_mov_b32 v89, 0
    v_mov_b32 v90, 0
    v_mov_b32 v91, 0
    v_mov_b32 v92, 0
    v_mov_b32 v93, 0
    v_mov_b32 v94, 0
    v_mov_b32 v95, 0
    v_mov_b32 v96, 0
    v_mov_b32 v97, 0
    v_mov_b32 v98, 0
    v_mov_b32 v99, 0
    v_mov_b32 v100, 0
    v_mov_b32 v101, 0
    v_mov_b32 v102, 0
    v_mov_b32 v103, 0
    v_mov_b32 v104, 0
    v_mov_b32 v105, 0
    v_mov_b32 v106, 0
    v_mov_b32 v107, 0
    v_mov_b32 v108, 0
    v_mov_b32 v109, 0
    v_mov_b32 v110, 0
    v_mov_b32 v111, 0
    v_mov_b32 v112, 0
    v_mov_b32 v113, 0
    v_mov_b32 v114, 0
    v_mov_b32 v115, 0
    v_mov_b32 v116, 0
    v_mov_b32 v117, 0
    v_mov_b32 v118, 0
    v_mov_b32 v119, 0
    v_mov_b32 v120, 0
    v_mov_b32 v121, 0
    v_mov_b32 v122, 0
    v_mov_b32 v123, 0
    v_mov_b32 v124, 0
    v_mov_b32 v125, 0
    v_mov_b32 v126, 0
    v_mov_b32 v127, 0
    v_mov_b32 v128, 0
    v_mov_b32 v129, 0
    v_mov_b32 v130, 0
    v_mov_b32 v131, 0
    v_mov_b32 v132, 0
    v_mov_b32 v133, 0
    v_mov_b32 v134, 0
    v_mov_b32 v135, 0
    v_mov_b32 v136, 0
    v_mov_b32 v137, 0
    v_mov_b32 v138, 0
    v_mov_b32 v139, 0
    v_mov_b32 v140, 0
    v_mov_b32 v141, 0
    v_mov_b32 v142, 0
    v_mov_b32 v143, 0
    v_mov_b32 v144, 0
    v_mov_b32 v145, 0
    v_mov_b32 v146, 0
    v_mov_b32 v147, 0
    v_mov_b32 v148, 0
    v_mov_b32 v149, 0
    v_mov_b32 v150, 0
    v_mov_b32 v151, 0
    s_lshl_b32 s44, s30, 5
    s_add_u32 s44, s44, s31
    s_barrier
pad8_2:
    s_cbranch_execz pad8_3
    s_add_u32 m0, s42, 0
    s_nop 0
    buffer_load_dwordx4 v10, s[8:11], s40 offen sc1 lds
    s_add_u32 m0, s42, 1024
    s_nop 0
    buffer_load_dwordx4 v11, s[8:11], s40 offen sc1 lds
    s_add_u32 m0, s42, 2048
    s_nop 0
    buffer_load_dwordx4 v12, s[8:11], s40 offen sc1 lds
    s_add_u32 s40, s40, 2048
    s_add_u32 s62, s62, 1
    s_cmp_ge_u32 s62, 5
    s_cselect_b32 s62, 0, s62
    s_cselect_b32 s63, s65, s64
    s_add_u32 s42, s42, s63
    s_add_u32 m0, s42, 0
    s_nop 0
    buffer_load_dwordx4 v10, s[8:11], s40 offen sc1 lds
    s_add_u32 m0, s42, 1024
    s_nop 0
    buffer_load_dwordx4 v11, s[8:11], s40 offen sc1 lds
    s_add_u32 m0, s42, 2048
    s_nop 0
    buffer_load_dwordx4 v12, s[8:11], s40 offen sc1 lds
    s_add_u32 s40, s40, 2048
    s_add_u32 s62, s62, 1
    s_cmp_ge_u32 s62, 5
    s_cselect_b32 s62, 0, s62
    s_cselect_b32 s63, s65, s64
    s_add_u32 s42, s42, s63
    v_lshlrev_b32 v2, 3, v0
    buffer_load_dwordx2 v[216:217], v2, s[16:19], s38 offen offset:0 sc1
    buffer_load_dwordx2 v[218:219], v2, s[16:19], s38 offen offset:512 sc1
    buffer_load_dwordx2 v[220:221], v2, s[16:19], s38 offen offset:1024 sc1
    buffer_load_dwordx2 v[222:223], v2, s[16:19], s38 offen offset:1536 sc1
    buffer_load_dwordx2 v[224:225], v2, s[16:19], s38 offen offset:2048 sc1
    buffer_load_dwordx2 v[226:227], v2, s[16:19], s38 offen offset:2560 sc1
    buffer_load_dwordx2 v[228:229], v2, s[16:19], s38 offen offset:3072 sc1
    buffer_load_dwordx2 v[230:231], v2, s[16:19], s38 offen offset:3584 sc1
    s_waitcnt vmcnt(11)
    s_barrier
    ds_read_b128 v[152:155], v4 offset:0
    ds_read_b64_tr_b16 v[184:185], v5 offset:0
    ds_read_b64_tr_b16 v[186:187], v5 offset:1024
    ds_read_b128 v[156:159], v4 offset:256
    ds_read_b128 v[160:163], v4 offset:2048
    ds_read_b128 v[164:167], v4 offset:2304
    ds_read_b64_tr_b16 v[188:189], v5 offset:7168
    ds_read_b64_tr_b16 v[190:191], v5 offset:8192
    ds_read_b64_tr_b16 v[192:193], v6 offset:0
    ds_read_b64_tr_b16 v[194:195], v6 offset:1024
    ds_read_b64_tr_b16 v[196:197], v6 offset:7168
    ds_read_b64_tr_b16 v[198:199], v6 offset:8192
    ds_read_b64_tr_b16 v[200:201], v5 offset:2048
    ds_read_b64_tr_b16 v[202:203], v5 offset:3072
    ds_read_b64_tr_b16 v[204:205], v5 offset:9216
    ds_read_b64_tr_b16 v[206:207], v5 offset:10240
    ds_read_b64_tr_b16 v[208:209], v6 offset:2048
    ds_read_b64_tr_b16 v[210:211], v6 offset:3072
    ds_read_b64_tr_b16 v[212:213], v6 offset:9216
    ds_read_b64_tr_b16 v[214:215], v6 offset:10240
    s_waitcnt vmcnt(0)
    v_pk_add_f32 v[216:217], v[216:217], v[218:219]
    v_pk_add_f32 v[220:221], v[220:221], v[222:223]
    v_pk_add_f32 v[224:225], v[224:225], v[226:227]
    v_pk_add_f32 v[228:229], v[228:229], v[230:231]
    v_pk_add_f32 v[216:217], v[216:217], v[220:221]
    v_pk_add_f32 v[224:225], v[224:225], v[228:229]
    v_mov_b32 v218, v216
    v_mov_b32 v219, v217
    v_mov_b32 v226, v224
    v_mov_b32 v227, v225
    v_permlane16_swap_b32 v216, v218
    v_permlane16_swap_b32 v217, v219
    v_permlane16_swap_b32 v224, v226
    v_permlane16_swap_b32 v225, v227
    v_add_f32 v216, v216, v218
    v_add_f32 v217, v217, v219
    v_add_f32 v224, v224, v226
    v_add_f32 v225, v225, v227
    v_mov_b32 v218, v216
pad8_3:
    s_cbranch_execz wo_warm_ret
    v_mov_b32 v219, v217
    v_mov_b32 v226, v224
    v_mov_b32 v227, v225
    v_permlane32_swap_b32 v216, v218
    v_permlane32_swap_b32 v217, v219
    v_permlane32_swap_b32 v224, v226
    v_permlane32_swap_b32 v225, v227
    v_add_f32 v216, v216, v218
    v_add_f32 v217, v217, v219
    v_add_f32 v224, v224, v226
    v_add_f32 v225, v225, v227
    v_mov_b32 v17, 0x3727c5ac
    v_mov_b32 v19, 0x3727c5ac
    v_mov_b32 v21, 0x3727c5ac
    v_mov_b32 v23, 0x3727c5ac
    v_fmac_f32 v17, 0x3a800000, v216
    v_fmac_f32 v19, 0x3a800000, v217
    v_fmac_f32 v21, 0x3a800000, v224
    v_fmac_f32 v23, 0x3a800000, v225
    v_rsq_f32 v16, v17
    v_rsq_f32 v18, v19
    v_rsq_f32 v20, v21
    v_rsq_f32 v22, v23
    v_mul_f32 v16, 0xbfb8aa3b, v16
    v_mul_f32 v18, 0xbfb8aa3b, v18
    v_mul_f32 v20, 0xbfb8aa3b, v20
    v_mul_f32 v22, 0xbfb8aa3b, v22
    s_waitcnt lgkmcnt(15)
    v_mfma_f32_16x16x32_bf16 v[24:27], v[184:187], v[152:155], v[24:27]
    s_add_u32 s60, s60, 30720
    s_cmp_ge_u32 s60, 153600
    s_cselect_b32 s60, 0, s60
    v_add_u32 v4, s60, v7
    v_add_u32 v5, s60, v8
    v_xor_b32 v6, 32, v5
    s_add_u32 m0, s42, 0
    s_nop 0
    buffer_load_dwordx4 v10, s[8:11], s40 offen sc1 lds
    v_mfma_f32_16x16x32_bf16 v[28:31], v[184:187], v[156:159], v[28:31]
    s_add_u32 m0, s42, 1024
    s_nop 0
    buffer_load_dwordx4 v11, s[8:11], s40 offen sc1 lds
    s_add_u32 m0, s42, 2048
    s_nop 0
    buffer_load_dwordx4 v12, s[8:11], s40 offen sc1 lds
    s_add_u32 s40, s40, 2048
    s_add_u32 s62, s62, 1
    s_cmp_ge_u32 s62, 5
    s_cselect_b32 s62, 0, s62
    s_cselect_b32 s63, s65, s64
    s_add_u32 s42, s42, s63
    s_waitcnt lgkmcnt(0)
    s_waitcnt vmcnt(3)
    s_barrier
    v_mfma_f32_16x16x32_bf16 v[88:91], v[184:187], v[160:163], v[88:91]
    ds_read_b128 v[168:171], v4 offset:0
    v_mfma_f32_16x16x32_bf16 v[92:95], v[184:187], v[164:167], v[92:95]
    ds_read_b64_tr_b16 v[216:217], v5 offset:0
    v_mfma_f32_16x16x32_bf16 v[32:35], v[188:191], v[152:155], v[32:35]
    ds_read_b64_tr_b16 v[218:219], v5 offset:1024
    v_mfma_f32_16x16x32_bf16 v[36:39], v[188:191], v[156:159], v[36:39]
    ds_read_b128 v[172:175], v4 offset:256
    v_mfma_f32_16x16x32_bf16 v[96:99], v[188:191], v[160:163], v[96:99]
    ds_read_b128 v[176:179], v4 offset:2048
    v_mfma_f32_16x16x32_bf16 v[100:103], v[188:191], v[164:167], v[100:103]
    ds_read_b128 v[180:183], v4 offset:2304
    v_mfma_f32_16x16x32_bf16 v[40:43], v[192:195], v[152:155], v[40:43]
    ds_read_b64_tr_b16 v[220:221], v5 offset:7168
    v_mfma_f32_16x16x32_bf16 v[44:47], v[192:195], v[156:159], v[44:47]
    ds_read_b64_tr_b16 v[222:223], v5 offset:8192
    v_mfma_f32_16x16x32_bf16 v[104:107], v[192:195], v[160:163], v[104:107]
    ds_read_b64_tr_b16 v[224:225], v6 offset:0
    v_mfma_f32_16x16x32_bf16 v[108:111], v[192:195], v[164:167], v[108:111]
    ds_read_b64_tr_b16 v[226:227], v6 offset:1024
    v_mfma_f32_16x16x32_bf16 v[48:51], v[196:199], v[152:155], v[48:51]
    ds_read_b64_tr_b16 v[228:229], v6 offset:7168
    v_mfma_f32_16x16x32_bf16 v[52:55], v[196:199], v[156:159], v[52:55]
    ds_read_b64_tr_b16 v[230:231], v6 offset:8192
    v_mfma_f32_16x16x32_bf16 v[112:115], v[196:199], v[160:163], v[112:115]
    ds_read_b64_tr_b16 v[232:233], v5 offset:2048
padc9:
    s_cbranch_execz pad9_1
    v_mfma_f32_16x16x32_bf16 v[116:119], v[196:199], v[164:167], v[116:119]
    ds_read_b64_tr_b16 v[234:235], v5 offset:3072
    v_mfma_f32_16x16x32_bf16 v[56:59], v[200:203], v[152:155], v[56:59]
    ds_read_b64_tr_b16 v[236:237], v5 offset:9216
    v_mfma_f32_16x16x32_bf16 v[60:63], v[200:203], v[156:159], v[60:63]
    ds_read_b64_tr_b16 v[238:239], v5 offset:10240
    v_mfma_f32_16x16x32_bf16 v[120:123], v[200:203], v[160:163], v[120:123]
    ds_read_b64_tr_b16 v[240:241], v6 offset:2048
    v_mfma_f32_16x16x32_bf16 v[124:127], v[200:203], v[164:167], v[124:127]
    ds_read_b64_tr_b16 v[242:243], v6 offset:3072
    v_mfma_f32_16x16x32_bf16 v[64:67], v[204:207], v[152:155], v[64:67]
    ds_read_b64_tr_b16 v[244:245], v6 offset:9216
    v_mfma_f32_16x16x32_bf16 v[68:71], v[204:207], v[156:159], v[68:71]
    ds_read_b64_tr_b16 v[246:247], v6 offset:10240
    v_mfma_f32_16x16x32_bf16 v[128:131], v[204:207], v[160:163], v[128:131]
    v_mfma_f32_16x16x32_bf16 v[132:135], v[204:207], v[164:167], v[132:135]
    s_add_u32 m0, s42, 0
    v_mfma_f32_16x16x32_bf16 v[72:75], v[208:211], v[152:155], v[72:75]
    buffer_load_dwordx4 v10, s[8:11], s40 offen sc1 lds
    v_mfma_f32_16x16x32_bf16 v[76:79], v[208:211], v[156:159], v[76:79]
    v_mfma_f32_16x16x32_bf16 v[136:139], v[208:211], v[160:163], v[136:139]
    s_add_u32 m0, s42, 1024
    v_mfma_f32_16x16x32_bf16 v[140:143], v[208:211], v[164:167], v[140:143]
    buffer_load_dwordx4 v11, s[8:11], s40 offen sc1 lds
    v_mfma_f32_16x16x32_bf16 v[80:83], v[212:215], v[152:155], v[80:83]
    v_mfma_f32_16x16x32_bf16 v[84:87], v[212:215], v[156:159], v[84:87]
    s_add_u32 m0, s42, 2048
    v_mfma_f32_16x16x32_bf16 v[144:147], v[212:215], v[160:163], v[144:147]
    buffer_load_dwordx4 v12, s[8:11], s40 offen sc1 lds
    v_mfma_f32_16x16x32_bf16 v[148:151], v[212:215], v[164:167], v[148:151]
    s_add_u32 s40, s40, 2048
    s_add_u32 s62, s62, 1
    s_cmp_ge_u32 s62, 5
    s_cselect_b32 s62, 0, s62
    s_cselect_b32 s63, s65, s64
    s_add_u32 s42, s42, s63
    s_waitcnt lgkmcnt(15)
    v_mfma_f32_16x16x32_bf16 v[24:27], v[216:219], v[168:171], v[24:27]
    s_add_u32 s60, s60, 30720
    s_cmp_ge_u32 s60, 153600
    s_cselect_b32 s60, 0, s60
    v_add_u32 v4, s60, v7
    v_add_u32 v5, s60, v8
    v_xor_b32 v6, 32, v5
    s_add_u32 m0, s42, 0
    s_nop 0
    buffer_load_dwordx4 v10, s[8:11], s40 offen sc1 lds
    v_mfma_f32_16x16x32_bf16 v[28:31], v[216:219], v[172:175], v[28:31]
    s_add_u32 m0, s42, 1024
    s_nop 0
    buffer_load_dwordx4 v11, s[8:11], s40 offen sc1 lds
    s_add_u32 m0, s42, 2048
    s_nop 0
    buffer_load_dwordx4 v12, s[8:11], s40 offen sc1 lds
    s_add_u32 s40, s40, 2048
    s_add_u32 s62, s62, 1
    s_cmp_ge_u32 s62, 5
    s_cselect_b32 s62, 0, s62
    s_cselect_b32 s63, s65, s64
    s_add_u32 s42, s42, s63
    s_waitcnt lgkmcnt(0)
    s_waitcnt vmcnt(6)
    s_barrier
    v_mfma_f32_16x16x32_bf16 v[88:91], v[216:219], v[176:179], v[88:91]
    ds_read_b128 v[152:155], v4 offset:0
    v_mfma_f32_16x16x32_bf16 v[92:95], v[216:219], v[180:183], v[92:95]
    ds_read_b64_tr_b16 v[184:185], v5 offset:0
    v_mfma_f32_16x16x32_bf16 v[32:35], v[220:223], v[168:171], v[32:35]
    ds_read_b64_tr_b16 v[186:187], v5 offset:1024
    v_mfma_f32_16x16x32_bf16 v[36:39], v[220:223], v[172:175], v[36:39]
    ds_read_b128 v[156:159], v4 offset:256
    v_mfma_f32_16x16x32_bf16 v[96:99], v[220:223], v[176:179], v[96:99]
    ds_read_b128 v[160:163], v4 offset:2048
    v_mfma_f32_16x16x32_bf16 v[100:103], v[220:223], v[180:183], v[100:103]
    ds_read_b128 v[164:167], v4 offset:2304
pad9_1:
    s_cbranch_execz pad9_2
    v_mfma_f32_16x16x32_bf16 v[40:43], v[224:227], v[168:171], v[40:43]
    ds_read_b64_tr_b16 v[188:189], v5 offset:7168
    v_mfma_f32_16x16x32_bf16 v[44:47], v[224:227], v[172:175], v[44:47]
    ds_read_b64_tr_b16 v[190:191], v5 offset:8192
    v_mfma_f32_16x16x32_bf16 v[104:107], v[224:227], v[176:179], v[104:107]
    ds_read_b64_tr_b16 v[192:193], v6 offset:0
    v_mfma_f32_16x16x32_bf16 v[108:111], v[224:227], v[180:183], v[108:111]
    ds_read_b64_tr_b16 v[194:195], v6 offset:1024
    v_mfma_f32_16x16x32_bf16 v[48:51], v[228:231], v[168:171], v[48:51]
    ds_read_b64_tr_b16 v[196:197], v6 offset:7168
    v_mfma_f32_16x16x32_bf16 v[52:55], v[228:231], v[172:175], v[52:55]
    ds_read_b64_tr_b16 v[198:199], v6 offset:8192
    v_mfma_f32_16x16x32_bf16 v[112:115], v[228:231], v[176:179], v[112:115]
    ds_read_b64_tr_b16 v[200:201], v5 offset:2048
    v_mfma_f32_16x16x32_bf16 v[116:119], v[228:231], v[180:183], v[116:119]
    ds_read_b64_tr_b16 v[202:203], v5 offset:3072
    v_mfma_f32_16x16x32_bf16 v[56:59], v[232:235], v[168:171], v[56:59]
    ds_read_b64_tr_b16 v[204:205], v5 offset:9216
    v_mfma_f32_16x16x32_bf16 v[60:63], v[232:235], v[172:175], v[60:63]
    ds_read_b64_tr_b16 v[206:207], v5 offset:10240
    v_mfma_f32_16x16x32_bf16 v[120:123], v[232:235], v[176:179], v[120:123]
    ds_read_b64_tr_b16 v[208:209], v6 offset:2048
    v_mfma_f32_16x16x32_bf16 v[124:127], v[232:235], v[180:183], v[124:127]
    ds_read_b64_tr_b16 v[210:211], v6 offset:3072
    v_mfma_f32_16x16x32_bf16 v[64:67], v[236:239], v[168:171], v[64:67]
    ds_read_b64_tr_b16 v[212:213], v6 offset:9216
    v_mfma_f32_16x16x32_bf16 v[68:71], v[236:239], v[172:175], v[68:71]
    ds_read_b64_tr_b16 v[214:215], v6 offset:10240
    v_mfma_f32_16x16x32_bf16 v[128:131], v[236:239], v[176:179], v[128:131]
    v_mfma_f32_16x16x32_bf16 v[132:135], v[236:239], v[180:183], v[132:135]
    s_add_u32 m0, s42, 0
    v_mfma_f32_16x16x32_bf16 v[72:75], v[240:243], v[168:171], v[72:75]
    buffer_load_dwordx4 v10, s[8:11], s40 offen sc1 lds
    v_mfma_f32_16x16x32_bf16 v[76:79], v[240:243], v[172:175], v[76:79]
    v_mfma_f32_16x16x32_bf16 v[136:139], v[240:243], v[176:179], v[136:139]
    s_add_u32 m0, s42, 1024
    v_mfma_f32_16x16x32_bf16 v[140:143], v[240:243], v[180:183], v[140:143]
    buffer_load_dwordx4 v11, s[8:11], s40 offen sc1 lds
    v_mfma_f32_16x16x32_bf16 v[80:83], v[244:247], v[168:171], v[80:83]
    v_mfma_f32_16x16x32_bf16 v[84:87], v[244:247], v[172:175], v[84:87]
    s_add_u32 m0, s42, 2048
    v_mfma_f32_16x16x32_bf16 v[144:147], v[244:247], v[176:179], v[144:147]
    buffer_load_dwordx4 v12, s[8:11], s40 offen sc1 lds
    v_mfma_f32_16x16x32_bf16 v[148:151], v[244:247], v[180:183], v[148:151]
    s_add_u32 s40, s40, 2048
    s_add_u32 s62, s62, 1
    s_cmp_ge_u32 s62, 5
    s_cselect_b32 s62, 0, s62
    s_cselect_b32 s63, s65, s64
    s_add_u32 s42, s42, s63
    s_waitcnt lgkmcnt(15)
    v_mfma_f32_16x16x32_bf16 v[24:27], v[184:187], v[152:155], v[24:27]
    s_add_u32 s60, s60, 30720
    s_cmp_ge_u32 s60, 153600
    s_cselect_b32 s60, 0, s60
    v_add_u32 v4, s60, v7
    v_add_u32 v5, s60, v8
    v_xor_b32 v6, 32, v5
    s_add_u32 m0, s42, 0
    s_nop 0
    buffer_load_dwordx4 v10, s[8:11], s40 offen sc1 lds
    v_mfma_f32_16x16x32_bf16 v[28:31], v[184:187], v[156:159], v[28:31]
    s_add_u32 m0, s42, 1024
    s_nop 0
    buffer_load_dwordx4 v11, s[8:11], s40 offen sc1 lds
    s_add_u32 m0, s42, 2048
    s_nop 0
    buffer_load_dwordx4 v12, s[8:11], s40 offen sc1 lds
    s_add_u32 s40, s40, 2048
    s_add_u32 s62, s62, 1
    s_cmp_ge_u32 s62, 5
    s_cselect_b32 s62, 0, s62
pad9_2:
    s_cbranch_execz pad9_3
    s_cselect_b32 s63, s65, s64
    s_add_u32 s42, s42, s63
    s_waitcnt lgkmcnt(0)
    s_waitcnt vmcnt(9)
    s_barrier
    v_mfma_f32_16x16x32_bf16 v[88:91], v[184:187], v[160:163], v[88:91]
    ds_read_b128 v[168:171], v4 offset:0
    v_mfma_f32_16x16x32_bf16 v[92:95], v[184:187], v[164:167], v[92:95]
    ds_read_b64_tr_b16 v[216:217], v5 offset:0
    v_mfma_f32_16x16x32_bf16 v[32:35], v[188:191], v[152:155], v[32:35]
    ds_read_b64_tr_b16 v[218:219], v5 offset:1024
    v_mfma_f32_16x16x32_bf16 v[36:39], v[188:191], v[156:159], v[36:39]
    ds_read_b128 v[172:175], v4 offset:256
    v_mfma_f32_16x16x32_bf16 v[96:99], v[188:191], v[160:163], v[96:99]
    ds_read_b128 v[176:179], v4 offset:2048
    v_mfma_f32_16x16x32_bf16 v[100:103], v[188:191], v[164:167], v[100:103]
    ds_read_b128 v[180:183], v4 offset:2304
    v_mfma_f32_16x16x32_bf16 v[40:43], v[192:195], v[152:155], v[40:43]
    ds_read_b64_tr_b16 v[220:221], v5 offset:7168
    v_mfma_f32_16x16x32_bf16 v[44:47], v[192:195], v[156:159], v[44:47]
    ds_read_b64_tr_b16 v[222:223], v5 offset:8192
    v_mfma_f32_16x16x32_bf16 v[104:107], v[192:195], v[160:163], v[104:107]
    ds_read_b64_tr_b16 v[224:225], v6 offset:0
    v_mfma_f32_16x16x32_bf16 v[108:111], v[192:195], v[164:167], v[108:111]
    ds_read_b64_tr_b16 v[226:227], v6 offset:1024
    v_mfma_f32_16x16x32_bf16 v[48:51], v[196:199], v[152:155], v[48:51]
    ds_read_b64_tr_b16 v[228:229], v6 offset:7168
    v_mfma_f32_16x16x32_bf16 v[52:55], v[196:199], v[156:159], v[52:55]
    ds_read_b64_tr_b16 v[230:231], v6 offset:8192
    v_mfma_f32_16x16x32_bf16 v[112:115], v[196:199], v[160:163], v[112:115]
    ds_read_b64_tr_b16 v[232:233], v5 offset:2048
    v_mfma_f32_16x16x32_bf16 v[116:119], v[196:199], v[164:167], v[116:119]
    ds_read_b64_tr_b16 v[234:235], v5 offset:3072
    v_mfma_f32_16x16x32_bf16 v[56:59], v[200:203], v[152:155], v[56:59]
    ds_read_b64_tr_b16 v[236:237], v5 offset:9216
    v_mfma_f32_16x16x32_bf16 v[60:63], v[200:203], v[156:159], v[60:63]
    ds_read_b64_tr_b16 v[238:239], v5 offset:10240
    v_mfma_f32_16x16x32_bf16 v[120:123], v[200:203], v[160:163], v[120:123]
    ds_read_b64_tr_b16 v[240:241], v6 offset:2048
    v_mfma_f32_16x16x32_bf16 v[124:127], v[200:203], v[164:167], v[124:127]
    ds_read_b64_tr_b16 v[242:243], v6 offset:3072
    v_mfma_f32_16x16x32_bf16 v[64:67], v[204:207], v[152:155], v[64:67]
    ds_read_b64_tr_b16 v[244:245], v6 offset:9216
    v_mfma_f32_16x16x32_bf16 v[68:71], v[204:207], v[156:159], v[68:71]
    ds_read_b64_tr_b16 v[246:247], v6 offset:10240
    v_mfma_f32_16x16x32_bf16 v[128:131], v[204:207], v[160:163], v[128:131]
    v_mfma_f32_16x16x32_bf16 v[132:135], v[204:207], v[164:167], v[132:135]
    s_add_u32 m0, s42, 0
    v_mfma_f32_16x16x32_bf16 v[72:75], v[208:211], v[152:155], v[72:75]
    buffer_load_dwordx4 v10, s[8:11], s40 offen sc1 lds
    v_mfma_f32_16x16x32_bf16 v[76:79], v[208:211], v[156:159], v[76:79]
    v_mfma_f32_16x16x32_bf16 v[136:139], v[208:211], v[160:163], v[136:139]
    s_add_u32 m0, s42, 1024
    v_mfma_f32_16x16x32_bf16 v[140:143], v[208:211], v[164:167], v[140:143]
    buffer_load_dwordx4 v11, s[8:11], s40 offen sc1 lds
    v_mfma_f32_16x16x32_bf16 v[80:83], v[212:215], v[152:155], v[80:83]
    v_mfma_f32_16x16x32_bf16 v[84:87], v[212:215], v[156:159], v[84:87]
    s_add_u32 m0, s42, 2048
    v_mfma_f32_16x16x32_bf16 v[144:147], v[212:215], v[160:163], v[144:147]
    buffer_load_dwordx4 v12, s[8:11], s40 offen sc1 lds
    v_mfma_f32_16x16x32_bf16 v[148:151], v[212:215], v[164:167], v[148:151]
    s_add_u32 s40, s40, 2048
    s_add_u32 s62, s62, 1
    s_cmp_ge_u32 s62, 5
    s_cselect_b32 s62, 0, s62
    s_cselect_b32 s63, s65, s64
    s_add_u32 s42, s42, s63
    s_mov_b32 s61, 12
    .p2align 4
qkv_loop21:
    s_waitcnt lgkmcnt(15)
    v_mfma_f32_16x16x32_bf16 v[24:27], v[216:219], v[168:171], v[24:27]
    s_add_u32 s60, s60, 30720
    s_cmp_ge_u32 s60, 153600
    s_cselect_b32 s60, 0, s60
    v_add_u32 v4, s60, v7
    v_add_u32 v5, s60, v8
    v_xor_b32 v6, 32, v5
    v_mfma_f32_16x16x32_bf16 v[28:31], v[216:219], v[172:175], v[28:31]
    s_waitcnt lgkmcnt(0)
    s_waitcnt vmcnt(9)
    s_barrier
    v_mfma_f32_16x16x32_bf16 v[88:91], v[216:219], v[176:179], v[88:91]
    ds_read_b128 v[152:155], v4 offset:0
    v_mfma_f32_16x16x32_bf16 v[92:95], v[216:219], v[180:183], v[92:95]
    ds_read_b64_tr_b16 v[184:185], v5 offset:0
    v_mfma_f32_16x16x32_bf16 v[32:35], v[220:223], v[168:171], v[32:35]
    ds_read_b64_tr_b16 v[186:187], v5 offset:1024
    v_mfma_f32_16x16x32_bf16 v[36:39], v[220:223], v[172:175], v[36:39]
    ds_read_b128 v[156:159], v4 offset:256
    v_mfma_f32_16x16x32_bf16 v[96:99], v[220:223], v[176:179], v[96:99]
    ds_read_b128 v[160:163], v4 offset:2048
    v_mfma_f32_16x16x32_bf16 v[100:103], v[220:223], v[180:183], v[100:103]
    ds_read_b128 v[164:167], v4 offset:2304
    v_mfma_f32_16x16x32_bf16 v[40:43], v[224:227], v[168:171], v[40:43]
    ds_read_b64_tr_b16 v[188:189], v5 offset:7168
    v_mfma_f32_16x16x32_bf16 v[44:47], v[224:227], v[172:175], v[44:47]
    ds_read_b64_tr_b16 v[190:191], v5 offset:8192
    v_mfma_f32_16x16x32_bf16 v[104:107], v[224:227], v[176:179], v[104:107]
    ds_read_b64_tr_b16 v[192:193], v6 offset:0
    v_mfma_f32_16x16x32_bf16 v[108:111], v[224:227], v[180:183], v[108:111]
    ds_read_b64_tr_b16 v[194:195], v6 offset:1024
    v_mfma_f32_16x16x32_bf16 v[48:51], v[228:231], v[168:171], v[48:51]
    ds_read_b64_tr_b16 v[196:197], v6 offset:7168
    v_mfma_f32_16x16x32_bf16 v[52:55], v[228:231], v[172:175], v[52:55]
    ds_read_b64_tr_b16 v[198:199], v6 offset:8192
    v_mfma_f32_16x16x32_bf16 v[112:115], v[228:231], v[176:179], v[112:115]
    ds_read_b64_tr_b16 v[200:201], v5 offset:2048
    v_mfma_f32_16x16x32_bf16 v[116:119], v[228:231], v[180:183], v[116:119]
    ds_read_b64_tr_b16 v[202:203], v5 offset:3072
    v_mfma_f32_16x16x32_bf16 v[56:59], v[232:235], v[168:171], v[56:59]
    ds_read_b64_tr_b16 v[204:205], v5 offset:9216
    v_mfma_f32_16x16x32_bf16 v[60:63], v[232:235], v[172:175], v[60:63]
    ds_read_b64_tr_b16 v[206:207], v5 offset:10240
    v_mfma_f32_16x16x32_bf16 v[120:123], v[232:235], v[176:179], v[120:123]
    ds_read_b64_tr_b16 v[208:209], v6 offset:2048
    v_mfma_f32_16x16x32_bf16 v[124:127], v[232:235], v[180:183], v[124:127]
    ds_read_b64_tr_b16 v[210:211], v6 offset:3072
    v_mfma_f32_16x16x32_bf16 v[64:67], v[236:239], v[168:171], v[64:67]
    ds_read_b64_tr_b16 v[212:213], v6 offset:9216
    v_mfma_f32_16x16x32_bf16 v[68:71], v[236:239], v[172:175], v[68:71]
    ds_read_b64_tr_b16 v[214:215], v6 offset:10240
    v_mfma_f32_16x16x32_bf16 v[128:131], v[236:239], v[176:179], v[128:131]
    v_mfma_f32_16x16x32_bf16 v[132:135], v[236:239], v[180:183], v[132:135]
    s_add_u32 m0, s42, 0
    v_mfma_f32_16x16x32_bf16 v[72:75], v[240:243], v[168:171], v[72:75]
    buffer_load_dwordx4 v10, s[8:11], s40 offen sc1 lds
    v_mfma_f32_16x16x32_bf16 v[76:79], v[240:243], v[172:175], v[76:79]
    v_mfma_f32_16x16x32_bf16 v[136:139], v[240:243], v[176:179], v[136:139]
    s_add_u32 m0, s42, 1024
    v_mfma_f32_16x16x32_bf16 v[140:143], v[240:243], v[180:183], v[140:143]
    buffer_load_dwordx4 v11, s[8:11], s40 offen sc1 lds
    v_mfma_f32_16x16x32_bf16 v[80:83], v[244:247], v[168:171], v[80:83]
    v_mfma_f32_16x16x32_bf16 v[84:87], v[244:247], v[172:175], v[84:87]
    s_add_u32 m0, s42, 2048
    v_mfma_f32_16x16x32_bf16 v[144:147], v[244:247], v[176:179], v[144:147]
    buffer_load_dwordx4 v12, s[8:11], s40 offen sc1 lds
    v_mfma_f32_16x16x32_bf16 v[148:151], v[244:247], v[180:183], v[148:151]
    s_add_u32 s40, s40, 2048
    s_add_u32 s62, s62, 1
    s_cmp_ge_u32 s62, 5
    s_cselect_b32 s62, 0, s62
    s_cselect_b32 s63, s65, s64
    s_add_u32 s42, s42, s63
    s_waitcnt lgkmcnt(15)
    v_mfma_f32_16x16x32_bf16 v[24:27], v[184:187], v[152:155], v[24:27]
    s_add_u32 s60, s60, 30720
    s_cmp_ge_u32 s60, 153600
    s_cselect_b32 s60, 0, s60
    v_add_u32 v4, s60, v7
    v_add_u32 v5, s60, v8
    v_xor_b32 v6, 32, v5
    v_mfma_f32_16x16x32_bf16 v[28:31], v[184:187], v[156:159], v[28:31]
    s_waitcnt lgkmcnt(0)
    s_waitcnt vmcnt(9)
    s_barrier
    v_mfma_f32_16x16x32_bf16 v[88:91], v[184:187], v[160:163], v[88:91]
    ds_read_b128 v[168:171], v4 offset:0
    v_mfma_f32_16x16x32_bf16 v[92:95], v[184:187], v[164:167], v[92:95]
    ds_read_b64_tr_b16 v[216:217], v5 offset:0
    v_mfma_f32_16x16x32_bf16 v[32:35], v[188:191], v[152:155], v[32:35]
    ds_read_b64_tr_b16 v[218:219], v5 offset:1024
    v_mfma_f32_16x16x32_bf16 v[36:39], v[188:191], v[156:159], v[36:39]
    ds_read_b128 v[172:175], v4 offset:256
    v_mfma_f32_16x16x32_bf16 v[96:99], v[188:191], v[160:163], v[96:99]
    ds_read_b128 v[176:179], v4 offset:2048
    v_mfma_f32_16x16x32_bf16 v[100:103], v[188:191], v[164:167], v[100:103]
    ds_read_b128 v[180:183], v4 offset:2304
    v_mfma_f32_16x16x32_bf16 v[40:43], v[192:195], v[152:155], v[40:43]
    ds_read_b64_tr_b16 v[220:221], v5 offset:7168
    v_mfma_f32_16x16x32_bf16 v[44:47], v[192:195], v[156:159], v[44:47]
    ds_read_b64_tr_b16 v[222:223], v5 offset:8192
    v_mfma_f32_16x16x32_bf16 v[104:107], v[192:195], v[160:163], v[104:107]
    ds_read_b64_tr_b16 v[224:225], v6 offset:0
    v_mfma_f32_16x16x32_bf16 v[108:111], v[192:195], v[164:167], v[108:111]
    ds_read_b64_tr_b16 v[226:227], v6 offset:1024
    v_mfma_f32_16x16x32_bf16 v[48:51], v[196:199], v[152:155], v[48:51]
    ds_read_b64_tr_b16 v[228:229], v6 offset:7168
    v_mfma_f32_16x16x32_bf16 v[52:55], v[196:199], v[156:159], v[52:55]
    ds_read_b64_tr_b16 v[230:231], v6 offset:8192
    v_mfma_f32_16x16x32_bf16 v[112:115], v[196:199], v[160:163], v[112:115]
    ds_read_b64_tr_b16 v[232:233], v5 offset:2048
    v_mfma_f32_16x16x32_bf16 v[116:119], v[196:199], v[164:167], v[116:119]
    ds_read_b64_tr_b16 v[234:235], v5 offset:3072
    v_mfma_f32_16x16x32_bf16 v[56:59], v[200:203], v[152:155], v[56:59]
    ds_read_b64_tr_b16 v[236:237], v5 offset:9216
    v_mfma_f32_16x16x32_bf16 v[60:63], v[200:203], v[156:159], v[60:63]
    ds_read_b64_tr_b16 v[238:239], v5 offset:10240
    v_mfma_f32_16x16x32_bf16 v[120:123], v[200:203], v[160:163], v[120:123]
    ds_read_b64_tr_b16 v[240:241], v6 offset:2048
    v_mfma_f32_16x16x32_bf16 v[124:127], v[200:203], v[164:167], v[124:127]
    ds_read_b64_tr_b16 v[242:243], v6 offset:3072
    v_mfma_f32_16x16x32_bf16 v[64:67], v[204:207], v[152:155], v[64:67]
    ds_read_b64_tr_b16 v[244:245], v6 offset:9216
    v_mfma_f32_16x16x32_bf16 v[68:71], v[204:207], v[156:159], v[68:71]
    ds_read_b64_tr_b16 v[246:247], v6 offset:10240
    v_mfma_f32_16x16x32_bf16 v[128:131], v[204:207], v[160:163], v[128:131]
    v_mfma_f32_16x16x32_bf16 v[132:135], v[204:207], v[164:167], v[132:135]
    s_add_u32 m0, s42, 0
    v_mfma_f32_16x16x32_bf16 v[72:75], v[208:211], v[152:155], v[72:75]
    buffer_load_dwordx4 v10, s[8:11], s40 offen sc1 lds
    v_mfma_f32_16x16x32_bf16 v[76:79], v[208:211], v[156:159], v[76:79]
    v_mfma_f32_16x16x32_bf16 v[136:139], v[208:211], v[160:163], v[136:139]
    s_add_u32 m0, s42, 1024
    v_mfma_f32_16x16x32_bf16 v[140:143], v[208:211], v[164:167], v[140:143]
    buffer_load_dwordx4 v11, s[8:11], s40 offen sc1 lds
    v_mfma_f32_16x16x32_bf16 v[80:83], v[212:215], v[152:155], v[80:83]
    v_mfma_f32_16x16x32_bf16 v[84:87], v[212:215], v[156:159], v[84:87]
    s_add_u32 m0, s42, 2048
    v_mfma_f32_16x16x32_bf16 v[144:147], v[212:215], v[160:163], v[144:147]
    buffer_load_dwordx4 v12, s[8:11], s40 offen sc1 lds
    v_mfma_f32_16x16x32_bf16 v[148:151], v[212:215], v[164:167], v[148:151]
    s_add_u32 s40, s40, 2048
    s_add_u32 s62, s62, 1
    s_cmp_ge_u32 s62, 5
    s_cselect_b32 s62, 0, s62
    s_cselect_b32 s63, s65, s64
    s_add_u32 s42, s42, s63
    s_sub_u32 s61, s61, 1
    s_cmp_lg_u32 s61, 0
    s_cbranch_scc1 qkv_loop21
pad9_3:
    s_cbranch_execz wo_warm_ret
    s_waitcnt lgkmcnt(15)
    v_mfma_f32_16x16x32_bf16 v[24:27], v[216:219], v[168:171], v[24:27]
    s_add_u32 s60, s60, 30720
    s_cmp_ge_u32 s60, 153600
    s_cselect_b32 s60, 0, s60
    v_add_u32 v4, s60, v7
    v_add_u32 v5, s60, v8
    v_xor_b32 v6, 32, v5
    v_mfma_f32_16x16x32_bf16 v[28:31], v[216:219], v[172:175], v[28:31]
    s_waitcnt lgkmcnt(0)
    s_waitcnt vmcnt(9)
    s_barrier
    v_mfma_f32_16x16x32_bf16 v[88:91], v[216:219], v[176:179], v[88:91]
    ds_read_b128 v[152:155], v4 offset:0
    v_mfma_f32_16x16x32_bf16 v[92:95], v[216:219], v[180:183], v[92:95]
    ds_read_b64_tr_b16 v[184:185], v5 offset:0
    v_mfma_f32_16x16x32_bf16 v[32:35], v[220:223], v[168:171], v[32:35]
    ds_read_b64_tr_b16 v[186:187], v5 offset:1024
    v_mfma_f32_16x16x32_bf16 v[36:39], v[220:223], v[172:175], v[36:39]
    ds_read_b128 v[156:159], v4 offset:256
    v_mfma_f32_16x16x32_bf16 v[96:99], v[220:223], v[176:179], v[96:99]
    ds_read_b128 v[160:163], v4 offset:2048
    v_mfma_f32_16x16x32_bf16 v[100:103], v[220:223], v[180:183], v[100:103]
    ds_read_b128 v[164:167], v4 offset:2304
    v_mfma_f32_16x16x32_bf16 v[40:43], v[224:227], v[168:171], v[40:43]
    ds_read_b64_tr_b16 v[188:189], v5 offset:7168
    v_mfma_f32_16x16x32_bf16 v[44:47], v[224:227], v[172:175], v[44:47]
    ds_read_b64_tr_b16 v[190:191], v5 offset:8192
    v_mfma_f32_16x16x32_bf16 v[104:107], v[224:227], v[176:179], v[104:107]
    ds_read_b64_tr_b16 v[192:193], v6 offset:0
    v_mfma_f32_16x16x32_bf16 v[108:111], v[224:227], v[180:183], v[108:111]
    ds_read_b64_tr_b16 v[194:195], v6 offset:1024
    v_mfma_f32_16x16x32_bf16 v[48:51], v[228:231], v[168:171], v[48:51]
    ds_read_b64_tr_b16 v[196:197], v6 offset:7168
    v_mfma_f32_16x16x32_bf16 v[52:55], v[228:231], v[172:175], v[52:55]
    ds_read_b64_tr_b16 v[198:199], v6 offset:8192
    v_mfma_f32_16x16x32_bf16 v[112:115], v[228:231], v[176:179], v[112:115]
    ds_read_b64_tr_b16 v[200:201], v5 offset:2048
    v_mfma_f32_16x16x32_bf16 v[116:119], v[228:231], v[180:183], v[116:119]
    ds_read_b64_tr_b16 v[202:203], v5 offset:3072
    v_mfma_f32_16x16x32_bf16 v[56:59], v[232:235], v[168:171], v[56:59]
    ds_read_b64_tr_b16 v[204:205], v5 offset:9216
    v_mfma_f32_16x16x32_bf16 v[60:63], v[232:235], v[172:175], v[60:63]
    ds_read_b64_tr_b16 v[206:207], v5 offset:10240
    v_mfma_f32_16x16x32_bf16 v[120:123], v[232:235], v[176:179], v[120:123]
    ds_read_b64_tr_b16 v[208:209], v6 offset:2048
    v_mfma_f32_16x16x32_bf16 v[124:127], v[232:235], v[180:183], v[124:127]
    ds_read_b64_tr_b16 v[210:211], v6 offset:3072
    v_mfma_f32_16x16x32_bf16 v[64:67], v[236:239], v[168:171], v[64:67]
    ds_read_b64_tr_b16 v[212:213], v6 offset:9216
    v_mfma_f32_16x16x32_bf16 v[68:71], v[236:239], v[172:175], v[68:71]
    ds_read_b64_tr_b16 v[214:215], v6 offset:10240
    v_mfma_f32_16x16x32_bf16 v[128:131], v[236:239], v[176:179], v[128:131]
    v_mfma_f32_16x16x32_bf16 v[132:135], v[236:239], v[180:183], v[132:135]
    v_mfma_f32_16x16x32_bf16 v[72:75], v[240:243], v[168:171], v[72:75]
    v_mfma_f32_16x16x32_bf16 v[76:79], v[240:243], v[172:175], v[76:79]
    v_mfma_f32_16x16x32_bf16 v[136:139], v[240:243], v[176:179], v[136:139]
    v_mfma_f32_16x16x32_bf16 v[140:143], v[240:243], v[180:183], v[140:143]
    v_mfma_f32_16x16x32_bf16 v[80:83], v[244:247], v[168:171], v[80:83]
    v_mfma_f32_16x16x32_bf16 v[84:87], v[244:247], v[172:175], v[84:87]
padc10:
    s_cbranch_execz pad10_1
    v_mfma_f32_16x16x32_bf16 v[144:147], v[244:247], v[176:179], v[144:147]
    v_mfma_f32_16x16x32_bf16 v[148:151], v[244:247], v[180:183], v[148:151]
    s_waitcnt lgkmcnt(15)
    v_mfma_f32_16x16x32_bf16 v[24:27], v[184:187], v[152:155], v[24:27]
    s_add_u32 s60, s60, 30720
    s_cmp_ge_u32 s60, 153600
    s_cselect_b32 s60, 0, s60
    v_add_u32 v4, s60, v7
    v_add_u32 v5, s60, v8
    v_xor_b32 v6, 32, v5
    v_mfma_f32_16x16x32_bf16 v[28:31], v[184:187], v[156:159], v[28:31]
    s_waitcnt lgkmcnt(0)
    s_waitcnt vmcnt(0)
    s_barrier
    v_mfma_f32_16x16x32_bf16 v[88:91], v[184:187], v[160:163], v[88:91]
    ds_read_b128 v[168:171], v4 offset:0
    v_mfma_f32_16x16x32_bf16 v[92:95], v[184:187], v[164:167], v[92:95]
    ds_read_b64_tr_b16 v[216:217], v5 offset:0
    v_mfma_f32_16x16x32_bf16 v[32:35], v[188:191], v[152:155], v[32:35]
    ds_read_b64_tr_b16 v[218:219], v5 offset:1024
    v_mfma_f32_16x16x32_bf16 v[36:39], v[188:191], v[156:159], v[36:39]
    ds_read_b128 v[172:175], v4 offset:256
    v_mfma_f32_16x16x32_bf16 v[96:99], v[188:191], v[160:163], v[96:99]
    ds_read_b128 v[176:179], v4 offset:2048
    v_mfma_f32_16x16x32_bf16 v[100:103], v[188:191], v[164:167], v[100:103]
    ds_read_b128 v[180:183], v4 offset:2304
    v_mfma_f32_16x16x32_bf16 v[40:43], v[192:195], v[152:155], v[40:43]
    ds_read_b64_tr_b16 v[220:221], v5 offset:7168
    v_mfma_f32_16x16x32_bf16 v[44:47], v[192:195], v[156:159], v[44:47]
    ds_read_b64_tr_b16 v[222:223], v5 offset:8192
    v_mfma_f32_16x16x32_bf16 v[104:107], v[192:195], v[160:163], v[104:107]
    ds_read_b64_tr_b16 v[224:225], v6 offset:0
    v_mfma_f32_16x16x32_bf16 v[108:111], v[192:195], v[164:167], v[108:111]
    ds_read_b64_tr_b16 v[226:227], v6 offset:1024
    v_mfma_f32_16x16x32_bf16 v[48:51], v[196:199], v[152:155], v[48:51]
    ds_read_b64_tr_b16 v[228:229], v6 offset:7168
    v_mfma_f32_16x16x32_bf16 v[52:55], v[196:199], v[156:159], v[52:55]
    ds_read_b64_tr_b16 v[230:231], v6 offset:8192
    v_mfma_f32_16x16x32_bf16 v[112:115], v[196:199], v[160:163], v[112:115]
    ds_read_b64_tr_b16 v[232:233], v5 offset:2048
    v_mfma_f32_16x16x32_bf16 v[116:119], v[196:199], v[164:167], v[116:119]
    ds_read_b64_tr_b16 v[234:235], v5 offset:3072
    v_mfma_f32_16x16x32_bf16 v[56:59], v[200:203], v[152:155], v[56:59]
    ds_read_b64_tr_b16 v[236:237], v5 offset:9216
    v_mfma_f32_16x16x32_bf16 v[60:63], v[200:203], v[156:159], v[60:63]
    ds_read_b64_tr_b16 v[238:239], v5 offset:10240
    v_mfma_f32_16x16x32_bf16 v[120:123], v[200:203], v[160:163], v[120:123]
    ds_read_b64_tr_b16 v[240:241], v6 offset:2048
    v_mfma_f32_16x16x32_bf16 v[124:127], v[200:203], v[164:167], v[124:127]
    ds_read_b64_tr_b16 v[242:243], v6 offset:3072
    v_mfma_f32_16x16x32_bf16 v[64:67], v[204:207], v[152:155], v[64:67]
    ds_read_b64_tr_b16 v[244:245], v6 offset:9216
    v_mfma_f32_16x16x32_bf16 v[68:71], v[204:207], v[156:159], v[68:71]
    ds_read_b64_tr_b16 v[246:247], v6 offset:10240
    v_mfma_f32_16x16x32_bf16 v[128:131], v[204:207], v[160:163], v[128:131]
    v_mfma_f32_16x16x32_bf16 v[132:135], v[204:207], v[164:167], v[132:135]
    v_mfma_f32_16x16x32_bf16 v[72:75], v[208:211], v[152:155], v[72:75]
    v_mfma_f32_16x16x32_bf16 v[76:79], v[208:211], v[156:159], v[76:79]
    v_mfma_f32_16x16x32_bf16 v[136:139], v[208:211], v[160:163], v[136:139]
    v_mfma_f32_16x16x32_bf16 v[140:143], v[208:211], v[164:167], v[140:143]
    v_mfma_f32_16x16x32_bf16 v[80:83], v[212:215], v[152:155], v[80:83]
    v_mfma_f32_16x16x32_bf16 v[84:87], v[212:215], v[156:159], v[84:87]
    v_mfma_f32_16x16x32_bf16 v[144:147], v[212:215], v[160:163], v[144:147]
    v_mfma_f32_16x16x32_bf16 v[148:151], v[212:215], v[164:167], v[148:151]
    s_waitcnt lgkmcnt(15)
    v_mfma_f32_16x16x32_bf16 v[24:27], v[216:219], v[168:171], v[24:27]
    s_add_u32 s60, s60, 30720
    s_cmp_ge_u32 s60, 153600
pad10_1:
    s_cbranch_execz pad10_2
    s_cselect_b32 s60, 0, s60
    v_add_u32 v4, s60, v7
    v_add_u32 v5, s60, v8
    v_xor_b32 v6, 32, v5
    v_mfma_f32_16x16x32_bf16 v[28:31], v[216:219], v[172:175], v[28:31]
    s_waitcnt lgkmcnt(0)
    v_mfma_f32_16x16x32_bf16 v[88:91], v[216:219], v[176:179], v[88:91]
    ds_read_b128 v[152:155], v4 offset:0
    v_mfma_f32_16x16x32_bf16 v[92:95], v[216:219], v[180:183], v[92:95]
    ds_read_b64_tr_b16 v[184:185], v5 offset:0
    v_mfma_f32_16x16x32_bf16 v[32:35], v[220:223], v[168:171], v[32:35]
    ds_read_b64_tr_b16 v[186:187], v5 offset:1024
    v_mfma_f32_16x16x32_bf16 v[36:39], v[220:223], v[172:175], v[36:39]
    ds_read_b128 v[156:159], v4 offset:256
    v_mfma_f32_16x16x32_bf16 v[96:99], v[220:223], v[176:179], v[96:99]
    ds_read_b128 v[160:163], v4 offset:2048
    v_mfma_f32_16x16x32_bf16 v[100:103], v[220:223], v[180:183], v[100:103]
    ds_read_b128 v[164:167], v4 offset:2304
    v_mfma_f32_16x16x32_bf16 v[40:43], v[224:227], v[168:171], v[40:43]
    ds_read_b64_tr_b16 v[188:189], v5 offset:7168
    v_mfma_f32_16x16x32_bf16 v[44:47], v[224:227], v[172:175], v[44:47]
    ds_read_b64_tr_b16 v[190:191], v5 offset:8192
    v_mfma_f32_16x16x32_bf16 v[104:107], v[224:227], v[176:179], v[104:107]
    ds_read_b64_tr_b16 v[192:193], v6 offset:0
    v_mfma_f32_16x16x32_bf16 v[108:111], v[224:227], v[180:183], v[108:111]
    ds_read_b64_tr_b16 v[194:195], v6 offset:1024
    v_mfma_f32_16x16x32_bf16 v[48:51], v[228:231], v[168:171], v[48:51]
    ds_read_b64_tr_b16 v[196:197], v6 offset:7168
    v_mfma_f32_16x16x32_bf16 v[52:55], v[228:231], v[172:175], v[52:55]
    ds_read_b64_tr_b16 v[198:199], v6 offset:8192
    v_mfma_f32_16x16x32_bf16 v[112:115], v[228:231], v[176:179], v[112:115]
    ds_read_b64_tr_b16 v[200:201], v5 offset:2048
    v_mfma_f32_16x16x32_bf16 v[116:119], v[228:231], v[180:183], v[116:119]
    ds_read_b64_tr_b16 v[202:203], v5 offset:3072
    v_mfma_f32_16x16x32_bf16 v[56:59], v[232:235], v[168:171], v[56:59]
    ds_read_b64_tr_b16 v[204:205], v5 offset:9216
    v_mfma_f32_16x16x32_bf16 v[60:63], v[232:235], v[172:175], v[60:63]
    ds_read_b64_tr_b16 v[206:207], v5 offset:10240
    v_mfma_f32_16x16x32_bf16 v[120:123], v[232:235], v[176:179], v[120:123]
    ds_read_b64_tr_b16 v[208:209], v6 offset:2048
    v_mfma_f32_16x16x32_bf16 v[124:127], v[232:235], v[180:183], v[124:127]
    ds_read_b64_tr_b16 v[210:211], v6 offset:3072
    v_mfma_f32_16x16x32_bf16 v[64:67], v[236:239], v[168:171], v[64:67]
    ds_read_b64_tr_b16 v[212:213], v6 offset:9216
    v_mfma_f32_16x16x32_bf16 v[68:71], v[236:239], v[172:175], v[68:71]
    ds_read_b64_tr_b16 v[214:215], v6 offset:10240
    v_mfma_f32_16x16x32_bf16 v[128:131], v[236:239], v[176:179], v[128:131]
    v_mfma_f32_16x16x32_bf16 v[132:135], v[236:239], v[180:183], v[132:135]
    v_mfma_f32_16x16x32_bf16 v[72:75], v[240:243], v[168:171], v[72:75]
    v_mfma_f32_16x16x32_bf16 v[76:79], v[240:243], v[172:175], v[76:79]
    v_mfma_f32_16x16x32_bf16 v[136:139], v[240:243], v[176:179], v[136:139]
    v_mfma_f32_16x16x32_bf16 v[140:143], v[240:243], v[180:183], v[140:143]
    v_mfma_f32_16x16x32_bf16 v[80:83], v[244:247], v[168:171], v[80:83]
    v_mfma_f32_16x16x32_bf16 v[84:87], v[244:247], v[172:175], v[84:87]
    v_mfma_f32_16x16x32_bf16 v[144:147], v[244:247], v[176:179], v[144:147]
    v_mfma_f32_16x16x32_bf16 v[148:151], v[244:247], v[180:183], v[148:151]
    s_waitcnt lgkmcnt(15)
    v_mfma_f32_16x16x32_bf16 v[24:27], v[184:187], v[152:155], v[24:27]
    s_add_u32 s60, s60, 30720
    s_cmp_ge_u32 s60, 153600
    s_cselect_b32 s60, 0, s60
    v_add_u32 v4, s60, v7
    v_add_u32 v5, s60, v8
    v_xor_b32 v6, 32, v5
    v_mfma_f32_16x16x32_bf16 v[28:31], v[184:187], v[156:159], v[28:31]
    s_waitcnt lgkmcnt(0)
    v_mfma_f32_16x16x32_bf16 v[88:91], v[184:187], v[160:163], v[88:91]
    ds_read_b128 v[168:171], v4 offset:0
    v_mfma_f32_16x16x32_bf16 v[92:95], v[184:187], v[164:167], v[92:95]
pad10_2:
    s_cbranch_execz pad10_3
    ds_read_b64_tr_b16 v[216:217], v5 offset:0
    v_mfma_f32_16x16x32_bf16 v[32:35], v[188:191], v[152:155], v[32:35]
    ds_read_b64_tr_b16 v[218:219], v5 offset:1024
    v_mfma_f32_16x16x32_bf16 v[36:39], v[188:191], v[156:159], v[36:39]
    ds_read_b128 v[172:175], v4 offset:256
    v_mfma_f32_16x16x32_bf16 v[96:99], v[188:191], v[160:163], v[96:99]
    ds_read_b128 v[176:179], v4 offset:2048
    v_mfma_f32_16x16x32_bf16 v[100:103], v[188:191], v[164:167], v[100:103]
    ds_read_b128 v[180:183], v4 offset:2304
    v_mfma_f32_16x16x32_bf16 v[40:43], v[192:195], v[152:155], v[40:43]
    ds_read_b64_tr_b16 v[220:221], v5 offset:7168
    v_mfma_f32_16x16x32_bf16 v[44:47], v[192:195], v[156:159], v[44:47]
    ds_read_b64_tr_b16 v[222:223], v5 offset:8192
    v_mfma_f32_16x16x32_bf16 v[104:107], v[192:195], v[160:163], v[104:107]
    ds_read_b64_tr_b16 v[224:225], v6 offset:0
    v_mfma_f32_16x16x32_bf16 v[108:111], v[192:195], v[164:167], v[108:111]
    ds_read_b64_tr_b16 v[226:227], v6 offset:1024
    v_mfma_f32_16x16x32_bf16 v[48:51], v[196:199], v[152:155], v[48:51]
    ds_read_b64_tr_b16 v[228:229], v6 offset:7168
    v_mfma_f32_16x16x32_bf16 v[52:55], v[196:199], v[156:159], v[52:55]
    ds_read_b64_tr_b16 v[230:231], v6 offset:8192
    v_mfma_f32_16x16x32_bf16 v[112:115], v[196:199], v[160:163], v[112:115]
    ds_read_b64_tr_b16 v[232:233], v5 offset:2048
    v_mfma_f32_16x16x32_bf16 v[116:119], v[196:199], v[164:167], v[116:119]
    ds_read_b64_tr_b16 v[234:235], v5 offset:3072
    v_mfma_f32_16x16x32_bf16 v[56:59], v[200:203], v[152:155], v[56:59]
    ds_read_b64_tr_b16 v[236:237], v5 offset:9216
    v_mfma_f32_16x16x32_bf16 v[60:63], v[200:203], v[156:159], v[60:63]
    ds_read_b64_tr_b16 v[238:239], v5 offset:10240
    v_mfma_f32_16x16x32_bf16 v[120:123], v[200:203], v[160:163], v[120:123]
    ds_read_b64_tr_b16 v[240:241], v6 offset:2048
    v_mfma_f32_16x16x32_bf16 v[124:127], v[200:203], v[164:167], v[124:127]
    ds_read_b64_tr_b16 v[242:243], v6 offset:3072
    v_mfma_f32_16x16x32_bf16 v[64:67], v[204:207], v[152:155], v[64:67]
    ds_read_b64_tr_b16 v[244:245], v6 offset:9216
    v_mfma_f32_16x16x32_bf16 v[68:71], v[204:207], v[156:159], v[68:71]
    ds_read_b64_tr_b16 v[246:247], v6 offset:10240
    v_mfma_f32_16x16x32_bf16 v[128:131], v[204:207], v[160:163], v[128:131]
    v_mfma_f32_16x16x32_bf16 v[132:135], v[204:207], v[164:167], v[132:135]
    v_mfma_f32_16x16x32_bf16 v[72:75], v[208:211], v[152:155], v[72:75]
    v_mfma_f32_16x16x32_bf16 v[76:79], v[208:211], v[156:159], v[76:79]
    v_mfma_f32_16x16x32_bf16 v[136:139], v[208:211], v[160:163], v[136:139]
    v_mfma_f32_16x16x32_bf16 v[140:143], v[208:211], v[164:167], v[140:143]
    v_mfma_f32_16x16x32_bf16 v[80:83], v[212:215], v[152:155], v[80:83]
    v_mfma_f32_16x16x32_bf16 v[84:87], v[212:215], v[156:159], v[84:87]
    v_mfma_f32_16x16x32_bf16 v[144:147], v[212:215], v[160:163], v[144:147]
    v_mfma_f32_16x16x32_bf16 v[148:151], v[212:215], v[164:167], v[148:151]
    s_waitcnt lgkmcnt(15)
    v_mfma_f32_16x16x32_bf16 v[24:27], v[216:219], v[168:171], v[24:27]
    v_mfma_f32_16x16x32_bf16 v[28:31], v[216:219], v[172:175], v[28:31]
    v_mfma_f32_16x16x32_bf16 v[88:91], v[216:219], v[176:179], v[88:91]
    s_waitcnt lgkmcnt(14)
    v_mfma_f32_16x16x32_bf16 v[92:95], v[216:219], v[180:183], v[92:95]
    s_waitcnt lgkmcnt(12)
    v_mfma_f32_16x16x32_bf16 v[32:35], v[220:223], v[168:171], v[32:35]
    v_mfma_f32_16x16x32_bf16 v[36:39], v[220:223], v[172:175], v[36:39]
    v_mfma_f32_16x16x32_bf16 v[96:99], v[220:223], v[176:179], v[96:99]
    v_mfma_f32_16x16x32_bf16 v[100:103], v[220:223], v[180:183], v[100:103]
    s_waitcnt lgkmcnt(10)
    v_mfma_f32_16x16x32_bf16 v[40:43], v[224:227], v[168:171], v[40:43]
    v_mfma_f32_16x16x32_bf16 v[44:47], v[224:227], v[172:175], v[44:47]
    v_mfma_f32_16x16x32_bf16 v[104:107], v[224:227], v[176:179], v[104:107]
    v_mfma_f32_16x16x32_bf16 v[108:111], v[224:227], v[180:183], v[108:111]
    s_waitcnt lgkmcnt(8)
    v_mfma_f32_16x16x32_bf16 v[48:51], v[228:231], v[168:171], v[48:51]
    v_mfma_f32_16x16x32_bf16 v[52:55], v[228:231], v[172:175], v[52:55]
pad10_3:
    s_cbranch_execz pad10_4
    v_mfma_f32_16x16x32_bf16 v[112:115], v[228:231], v[176:179], v[112:115]
    v_mfma_f32_16x16x32_bf16 v[116:119], v[228:231], v[180:183], v[116:119]
    s_waitcnt lgkmcnt(6)
    v_mfma_f32_16x16x32_bf16 v[56:59], v[232:235], v[168:171], v[56:59]
    v_mfma_f32_16x16x32_bf16 v[60:63], v[232:235], v[172:175], v[60:63]
    v_mfma_f32_16x16x32_bf16 v[120:123], v[232:235], v[176:179], v[120:123]
    v_mfma_f32_16x16x32_bf16 v[124:127], v[232:235], v[180:183], v[124:127]
    s_waitcnt lgkmcnt(4)
    v_mfma_f32_16x16x32_bf16 v[64:67], v[236:239], v[168:171], v[64:67]
    v_mfma_f32_16x16x32_bf16 v[68:71], v[236:239], v[172:175], v[68:71]
    v_mfma_f32_16x16x32_bf16 v[128:131], v[236:239], v[176:179], v[128:131]
    v_mfma_f32_16x16x32_bf16 v[132:135], v[236:239], v[180:183], v[132:135]
    s_waitcnt lgkmcnt(2)
    v_mfma_f32_16x16x32_bf16 v[72:75], v[240:243], v[168:171], v[72:75]
    v_mfma_f32_16x16x32_bf16 v[76:79], v[240:243], v[172:175], v[76:79]
    v_mfma_f32_16x16x32_bf16 v[136:139], v[240:243], v[176:179], v[136:139]
    v_mfma_f32_16x16x32_bf16 v[140:143], v[240:243], v[180:183], v[140:143]
    s_waitcnt lgkmcnt(0)
    v_mfma_f32_16x16x32_bf16 v[80:83], v[244:247], v[168:171], v[80:83]
    v_mfma_f32_16x16x32_bf16 v[84:87], v[244:247], v[172:175], v[84:87]
    v_mfma_f32_16x16x32_bf16 v[144:147], v[244:247], v[176:179], v[144:147]
    v_mfma_f32_16x16x32_bf16 v[148:151], v[244:247], v[180:183], v[148:151]
    s_add_u32 s8, s86, 0x1800000
    s_addc_u32 s9, s87, 0
    s_mov_b32 s10, 0xe00000
    s_mov_b32 s11, 0x00020000
    s_mul_i32 s37, s37, 224*1024
    s_add_u32 s44, s35, 0
    s_lshl_b32 s44, s44, 6
    s_add_u32 s44, s44, s37
    s_add_u32 s45, s44, 224*1024
    v_mul_f32 v152, v24, v16
    v_mul_f32 v153, v25, v16
    v_mul_f32 v154, v26, v16
    v_mul_f32 v155, v27, v16
    v_mul_f32 v156, v28, v18
    v_mul_f32 v157, v29, v18
    v_mul_f32 v158, v30, v18
    v_mul_f32 v159, v31, v18
    v_exp_f32 v152, v152
    v_exp_f32 v153, v153
    v_exp_f32 v154, v154
    v_exp_f32 v155, v155
    v_exp_f32 v156, v156
    v_exp_f32 v157, v157
    v_exp_f32 v158, v158
    v_exp_f32 v159, v159
    v_mul_f32 v24, v24, v32
    v_mul_f32 v25, v25, v33
    v_mul_f32 v26, v26, v34
    v_mul_f32 v27, v27, v35
    v_mul_f32 v28, v28, v36
    v_mul_f32 v29, v29, v37
    v_mul_f32 v30, v30, v38
    v_mul_f32 v31, v31, v39
    v_fma_f32 v152, v152, v17, v17
    v_fma_f32 v153, v153, v17, v17
    v_fma_f32 v154, v154, v17, v17
    v_fma_f32 v155, v155, v17, v17
    v_fma_f32 v156, v156, v19, v19
    v_fma_f32 v157, v157, v19, v19
    v_fma_f32 v158, v158, v19, v19
    v_fma_f32 v159, v159, v19, v19
    v_rcp_f32 v152, v152
    v_rcp_f32 v153, v153
    v_rcp_f32 v154, v154
    v_rcp_f32 v155, v155
    v_rcp_f32 v156, v156
    v_rcp_f32 v157, v157
    v_rcp_f32 v158, v158
    v_rcp_f32 v159, v159
    v_mul_f32 v24, v24, v152
    v_mul_f32 v25, v25, v153
    v_mul_f32 v26, v26, v154
    v_mul_f32 v27, v27, v155
    v_mul_f32 v28, v28, v156
    v_mul_f32 v29, v29, v157
    v_mul_f32 v30, v30, v158
    v_mul_f32 v31, v31, v159
    v_cvt_pk_bf16_f32 v32, v24, v25
    v_cvt_pk_bf16_f32 v33, v26, v27
    v_cvt_pk_bf16_f32 v34, v28, v29
    v_cvt_pk_bf16_f32 v35, v30, v31
    s_nop 0
    v_permlane16_swap_b32 v32, v34
    v_permlane16_swap_b32 v33, v35
    buffer_store_dwordx4 v[32:35], v9, s[8:11], s44 offen sc1
    v_mul_f32 v152, v88, v20
    v_mul_f32 v153, v89, v20
    v_mul_f32 v154, v90, v20
    v_mul_f32 v155, v91, v20
pad10_4:
    s_cbranch_execz wo_warm_ret
    v_mul_f32 v156, v92, v22
    v_mul_f32 v157, v93, v22
    v_mul_f32 v158, v94, v22
    v_mul_f32 v159, v95, v22
    v_exp_f32 v152, v152
    v_exp_f32 v153, v153
    v_exp_f32 v154, v154
    v_exp_f32 v155, v155
    v_exp_f32 v156, v156
    v_exp_f32 v157, v157
    v_exp_f32 v158, v158
    v_exp_f32 v159, v159
    v_mul_f32 v88, v88, v96
    v_mul_f32 v89, v89, v97
    v_mul_f32 v90, v90, v98
    v_mul_f32 v91, v91, v99
    v_mul_f32 v92, v92, v100
    v_mul_f32 v93, v93, v101
    v_mul_f32 v94, v94, v102
    v_mul_f32 v95, v95, v103
    v_fma_f32 v152, v152, v21, v21
    v_fma_f32 v153, v153, v21, v21
    v_fma_f32 v154, v154, v21, v21
    v_fma_f32 v155, v155, v21, v21
    v_fma_f32 v156, v156, v23, v23
    v_fma_f32 v157, v157, v23, v23
    v_fma_f32 v158, v158, v23, v23
    v_fma_f32 v159, v159, v23, v23
    v_rcp_f32 v152, v152
    v_rcp_f32 v153, v153
    v_rcp_f32 v154, v154
    v_rcp_f32 v155, v155
    v_rcp_f32 v156, v156
    v_rcp_f32 v157, v157
    v_rcp_f32 v158, v158
    v_rcp_f32 v159, v159
    v_mul_f32 v88, v88, v152
    v_mul_f32 v89, v89, v153
    v_mul_f32 v90, v90, v154
    v_mul_f32 v91, v91, v155
    v_mul_f32 v92, v92, v156
    v_mul_f32 v93, v93, v157
    v_mul_f32 v94, v94, v158
    v_mul_f32 v95, v95, v159
    v_cvt_pk_bf16_f32 v96, v88, v89
    v_cvt_pk_bf16_f32 v97, v90, v91
    v_cvt_pk_bf16_f32 v98, v92, v93
    v_cvt_pk_bf16_f32 v99, v94, v95
    s_nop 0
    v_permlane16_swap_b32 v96, v98
    v_permlane16_swap_b32 v97, v99
    buffer_store_dwordx4 v[96:99], v9, s[8:11], s45 offen sc1
    s_add_u32 s44, s35, 16
    s_lshl_b32 s44, s44, 6
    s_add_u32 s44, s44, s37
    s_add_u32 s45, s44, 224*1024
    v_mul_f32 v152, v40, v16
    v_mul_f32 v153, v41, v16
    v_mul_f32 v154, v42, v16
    v_mul_f32 v155, v43, v16
    v_mul_f32 v156, v44, v18
    v_mul_f32 v157, v45, v18
    v_mul_f32 v158, v46, v18
    v_mul_f32 v159, v47, v18
    v_exp_f32 v152, v152
    v_exp_f32 v153, v153
    v_exp_f32 v154, v154
    v_exp_f32 v155, v155
    v_exp_f32 v156, v156
    v_exp_f32 v157, v157
    v_exp_f32 v158, v158
    v_exp_f32 v159, v159
    v_mul_f32 v40, v40, v48
    v_mul_f32 v41, v41, v49
    v_mul_f32 v42, v42, v50
    v_mul_f32 v43, v43, v51
    v_mul_f32 v44, v44, v52
    v_mul_f32 v45, v45, v53
    v_mul_f32 v46, v46, v54
    v_mul_f32 v47, v47, v55
    v_fma_f32 v152, v152, v17, v17
    v_fma_f32 v153, v153, v17, v17
    v_fma_f32 v154, v154, v17, v17
    v_fma_f32 v155, v155, v17, v17
    v_fma_f32 v156, v156, v19, v19
    v_fma_f32 v157, v157, v19, v19
    v_fma_f32 v158, v158, v19, v19
    v_fma_f32 v159, v159, v19, v19
    v_rcp_f32 v152, v152
    v_rcp_f32 v153, v153
    v_rcp_f32 v154, v154
    v_rcp_f32 v155, v155
    v_rcp_f32 v156, v156
    v_rcp_f32 v157, v157
    v_rcp_f32 v158, v158
    v_rcp_f32 v159, v159
    v_mul_f32 v40, v40, v152
    v_mul_f32 v41, v41, v153
    v_mul_f32 v42, v42, v154
    v_mul_f32 v43, v43, v155
    v_mul_f32 v44, v44, v156
    v_mul_f32 v45, v45, v157
    v_mul_f32 v46, v46, v158
    v_mul_f32 v47, v47, v159
    v_cvt_pk_bf16_f32 v48, v40, v41
padc11:
    s_cbranch_execz pad11_1
    v_cvt_pk_bf16_f32 v49, v42, v43
    v_cvt_pk_bf16_f32 v50, v44, v45
    v_cvt_pk_bf16_f32 v51, v46, v47
    s_nop 0
    v_permlane16_swap_b32 v48, v50
    v_permlane16_swap_b32 v49, v51
    buffer_store_dwordx4 v[48:51], v9, s[8:11], s44 offen sc1
    v_mul_f32 v152, v104, v20
    v_mul_f32 v153, v105, v20
    v_mul_f32 v154, v106, v20
    v_mul_f32 v155, v107, v20
    v_mul_f32 v156, v108, v22
    v_mul_f32 v157, v109, v22
    v_mul_f32 v158, v110, v22
    v_mul_f32 v159, v111, v22
    v_exp_f32 v152, v152
    v_exp_f32 v153, v153
    v_exp_f32 v154, v154
    v_exp_f32 v155, v155
    v_exp_f32 v156, v156
    v_exp_f32 v157, v157
    v_exp_f32 v158, v158
    v_exp_f32 v159, v159
    v_mul_f32 v104, v104, v112
    v_mul_f32 v105, v105, v113
    v_mul_f32 v106, v106, v114
    v_mul_f32 v107, v107, v115
    v_mul_f32 v108, v108, v116
    v_mul_f32 v109, v109, v117
    v_mul_f32 v110, v110, v118
    v_mul_f32 v111, v111, v119
    v_fma_f32 v152, v152, v21, v21
    v_fma_f32 v153, v153, v21, v21
    v_fma_f32 v154, v154, v21, v21
    v_fma_f32 v155, v155, v21, v21
    v_fma_f32 v156, v156, v23, v23
    v_fma_f32 v157, v157, v23, v23
    v_fma_f32 v158, v158, v23, v23
    v_fma_f32 v159, v159, v23, v23
    v_rcp_f32 v152, v152
    v_rcp_f32 v153, v153
    v_rcp_f32 v154, v154
    v_rcp_f32 v155, v155
    v_rcp_f32 v156, v156
    v_rcp_f32 v157, v157
    v_rcp_f32 v158, v158
    v_rcp_f32 v159, v159
    v_mul_f32 v104, v104, v152
    v_mul_f32 v105, v105, v153
    v_mul_f32 v106, v106, v154
    v_mul_f32 v107, v107, v155
    v_mul_f32 v108, v108, v156
    v_mul_f32 v109, v109, v157
    v_mul_f32 v110, v110, v158
    v_mul_f32 v111, v111, v159
    v_cvt_pk_bf16_f32 v112, v104, v105
    v_cvt_pk_bf16_f32 v113, v106, v107
    v_cvt_pk_bf16_f32 v114, v108, v109
    v_cvt_pk_bf16_f32 v115, v110, v111
    s_nop 0
    v_permlane16_swap_b32 v112, v114
    v_permlane16_swap_b32 v113, v115
    buffer_store_dwordx4 v[112:115], v9, s[8:11], s45 offen sc1
    s_add_u32 s44, s35, 32
    s_lshl_b32 s44, s44, 6
    s_add_u32 s44, s44, s37
    s_add_u32 s45, s44, 224*1024
    v_mul_f32 v152, v56, v16
    v_mul_f32 v153, v57, v16
    v_mul_f32 v154, v58, v16
    v_mul_f32 v155, v59, v16
    v_mul_f32 v156, v60, v18
    v_mul_f32 v157, v61, v18
    v_mul_f32 v158, v62, v18
    v_mul_f32 v159, v63, v18
    v_exp_f32 v152, v152
    v_exp_f32 v153, v153
    v_exp_f32 v154, v154
    v_exp_f32 v155, v155
    v_exp_f32 v156, v156
    v_exp_f32 v157, v157
    v_exp_f32 v158, v158
    v_exp_f32 v159, v159
    v_mul_f32 v56, v56, v64
    v_mul_f32 v57, v57, v65
    v_mul_f32 v58, v58, v66
    v_mul_f32 v59, v59, v67
    v_mul_f32 v60, v60, v68
    v_mul_f32 v61, v61, v69
    v_mul_f32 v62, v62, v70
    v_mul_f32 v63, v63, v71
    v_fma_f32 v152, v152, v17, v17
    v_fma_f32 v153, v153, v17, v17
    v_fma_f32 v154, v154, v17, v17
    v_fma_f32 v155, v155, v17, v17
    v_fma_f32 v156, v156, v19, v19
    v_fma_f32 v157, v157, v19, v19
    v_fma_f32 v158, v158, v19, v19
    v_fma_f32 v159, v159, v19, v19
    v_rcp_f32 v152, v152
pad11_1:
    s_cbranch_execz pad11_2
    v_rcp_f32 v153, v153
    v_rcp_f32 v154, v154
    v_rcp_f32 v155, v155
    v_rcp_f32 v156, v156
    v_rcp_f32 v157, v157
    v_rcp_f32 v158, v158
    v_rcp_f32 v159, v159
    v_mul_f32 v56, v56, v152
    v_mul_f32 v57, v57, v153
    v_mul_f32 v58, v58, v154
    v_mul_f32 v59, v59, v155
    v_mul_f32 v60, v60, v156
    v_mul_f32 v61, v61, v157
    v_mul_f32 v62, v62, v158
    v_mul_f32 v63, v63, v159
    v_cvt_pk_bf16_f32 v64, v56, v57
    v_cvt_pk_bf16_f32 v65, v58, v59
    v_cvt_pk_bf16_f32 v66, v60, v61
    v_cvt_pk_bf16_f32 v67, v62, v63
    s_nop 0
    v_permlane16_swap_b32 v64, v66
    v_permlane16_swap_b32 v65, v67
    buffer_store_dwordx4 v[64:67], v9, s[8:11], s44 offen sc1
    v_mul_f32 v152, v120, v20
    v_mul_f32 v153, v121, v20
    v_mul_f32 v154, v122, v20
    v_mul_f32 v155, v123, v20
    v_mul_f32 v156, v124, v22
    v_mul_f32 v157, v125, v22
    v_mul_f32 v158, v126, v22
    v_mul_f32 v159, v127, v22
    v_exp_f32 v152, v152
    v_exp_f32 v153, v153
    v_exp_f32 v154, v154
    v_exp_f32 v155, v155
    v_exp_f32 v156, v156
    v_exp_f32 v157, v157
    v_exp_f32 v158, v158
    v_exp_f32 v159, v159
    v_mul_f32 v120, v120, v128
    v_mul_f32 v121, v121, v129
    v_mul_f32 v122, v122, v130
    v_mul_f32 v123, v123, v131
    v_mul_f32 v124, v124, v132
    v_mul_f32 v125, v125, v133
    v_mul_f32 v126, v126, v134
    v_mul_f32 v127, v127, v135
    v_fma_f32 v152, v152, v21, v21
    v_fma_f32 v153, v153, v21, v21
    v_fma_f32 v154, v154, v21, v21
    v_fma_f32 v155, v155, v21, v21
    v_fma_f32 v156, v156, v23, v23
    v_fma_f32 v157, v157, v23, v23
    v_fma_f32 v158, v158, v23, v23
    v_fma_f32 v159, v159, v23, v23
    v_rcp_f32 v152, v152
    v_rcp_f32 v153, v153
    v_rcp_f32 v154, v154
    v_rcp_f32 v155, v155
    v_rcp_f32 v156, v156
    v_rcp_f32 v157, v157
    v_rcp_f32 v158, v158
    v_rcp_f32 v159, v159
    v_mul_f32 v120, v120, v152
    v_mul_f32 v121, v121, v153
    v_mul_f32 v122, v122, v154
    v_mul_f32 v123, v123, v155
    v_mul_f32 v124, v124, v156
    v_mul_f32 v125, v125, v157
    v_mul_f32 v126, v126, v158
    v_mul_f32 v127, v127, v159
    v_cvt_pk_bf16_f32 v128, v120, v121
    v_cvt_pk_bf16_f32 v129, v122, v123
    v_cvt_pk_bf16_f32 v130, v124, v125
    v_cvt_pk_bf16_f32 v131, v126, v127
    s_nop 0
    v_permlane16_swap_b32 v128, v130
    v_permlane16_swap_b32 v129, v131
    buffer_store_dwordx4 v[128:131], v9, s[8:11], s45 offen sc1
    s_add_u32 s44, s35, 48
    s_lshl_b32 s44, s44, 6
    s_add_u32 s44, s44, s37
    s_add_u32 s45, s44, 224*1024
    v_mul_f32 v152, v72, v16
    v_mul_f32 v153, v73, v16
    v_mul_f32 v154, v74, v16
    v_mul_f32 v155, v75, v16
    v_mul_f32 v156, v76, v18
    v_mul_f32 v157, v77, v18
    v_mul_f32 v158, v78, v18
    v_mul_f32 v159, v79, v18
    v_exp_f32 v152, v152
    v_exp_f32 v153, v153
    v_exp_f32 v154, v154
    v_exp_f32 v155, v155
    v_exp_f32 v156, v156
    v_exp_f32 v157, v157
    v_exp_f32 v158, v158
    v_exp_f32 v159, v159
    v_mul_f32 v72, v72, v80
    v_mul_f32 v73, v73, v81
    v_mul_f32 v74, v74, v82
    v_mul_f32 v75, v75, v83
    v_mul_f32 v76, v76, v84
    v_mul_f32 v77, v77, v85
    v_mul_f32 v78, v78, v86
    v_mul_f32 v79, v79, v87
    v_fma_f32 v152, v152, v17, v17
pad11_2:
    s_cbranch_execz pad11_3
    v_fma_f32 v153, v153, v17, v17
    v_fma_f32 v154, v154, v17, v17
    v_fma_f32 v155, v155, v17, v17
    v_fma_f32 v156, v156, v19, v19
    v_fma_f32 v157, v157, v19, v19
    v_fma_f32 v158, v158, v19, v19
    v_fma_f32 v159, v159, v19, v19
    v_rcp_f32 v152, v152
    v_rcp_f32 v153, v153
    v_rcp_f32 v154, v154
    v_rcp_f32 v155, v155
    v_rcp_f32 v156, v156
    v_rcp_f32 v157, v157
    v_rcp_f32 v158, v158
    v_rcp_f32 v159, v159
    v_mul_f32 v72, v72, v152
    v_mul_f32 v73, v73, v153
    v_mul_f32 v74, v74, v154
    v_mul_f32 v75, v75, v155
    v_mul_f32 v76, v76, v156
    v_mul_f32 v77, v77, v157
    v_mul_f32 v78, v78, v158
    v_mul_f32 v79, v79, v159
    v_cvt_pk_bf16_f32 v80, v72, v73
    v_cvt_pk_bf16_f32 v81, v74, v75
    v_cvt_pk_bf16_f32 v82, v76, v77
    v_cvt_pk_bf16_f32 v83, v78, v79
    s_nop 0
    v_permlane16_swap_b32 v80, v82
    v_permlane16_swap_b32 v81, v83
    buffer_store_dwordx4 v[80:83], v9, s[8:11], s44 offen sc1
    v_mul_f32 v152, v136, v20
    v_mul_f32 v153, v137, v20
    v_mul_f32 v154, v138, v20
    v_mul_f32 v155, v139, v20
    v_mul_f32 v156, v140, v22
    v_mul_f32 v157, v141, v22
    v_mul_f32 v158, v142, v22
    v_mul_f32 v159, v143, v22
    v_exp_f32 v152, v152
    v_exp_f32 v153, v153
    v_exp_f32 v154, v154
    v_exp_f32 v155, v155
    v_exp_f32 v156, v156
    v_exp_f32 v157, v157
    v_exp_f32 v158, v158
    v_exp_f32 v159, v159
    v_mul_f32 v136, v136, v144
    v_mul_f32 v137, v137, v145
    v_mul_f32 v138, v138, v146
    v_mul_f32 v139, v139, v147
    v_mul_f32 v140, v140, v148
    v_mul_f32 v141, v141, v149
    v_mul_f32 v142, v142, v150
    v_mul_f32 v143, v143, v151
    v_fma_f32 v152, v152, v21, v21
    v_fma_f32 v153, v153, v21, v21
    v_fma_f32 v154, v154, v21, v21
    v_fma_f32 v155, v155, v21, v21
    v_fma_f32 v156, v156, v23, v23
    v_fma_f32 v157, v157, v23, v23
    v_fma_f32 v158, v158, v23, v23
    v_fma_f32 v159, v159, v23, v23
    v_rcp_f32 v152, v152
    v_rcp_f32 v153, v153
    v_rcp_f32 v154, v154
    v_rcp_f32 v155, v155
    v_rcp_f32 v156, v156
    v_rcp_f32 v157, v157
    v_rcp_f32 v158, v158
    v_rcp_f32 v159, v159
    v_mul_f32 v136, v136, v152
    v_mul_f32 v137, v137, v153
    v_mul_f32 v138, v138, v154
    v_mul_f32 v139, v139, v155
    v_mul_f32 v140, v140, v156
    v_mul_f32 v141, v141, v157
    v_mul_f32 v142, v142, v158
    v_mul_f32 v143, v143, v159
    v_cvt_pk_bf16_f32 v144, v136, v137
    v_cvt_pk_bf16_f32 v145, v138, v139
    v_cvt_pk_bf16_f32 v146, v140, v141
    v_cvt_pk_bf16_f32 v147, v142, v143
    s_nop 0
    v_permlane16_swap_b32 v144, v146
    v_permlane16_swap_b32 v145, v147
    buffer_store_dwordx4 v[144:147], v9, s[8:11], s45 offen sc1
    s_add_u32 s96, s86, 0x4400000
    s_addc_u32 s97, s87, 0
    s_mov_b32 s98, 0x8000
    s_mov_b32 s99, 0x00020000
    v_mov_b32 v1, 163592
    v_mov_b32 v2, 1
    v_mul_u32_u24 v3, 256, v0
    s_mov_b64 exec, 1
    s_waitcnt vmcnt(0)
    ds_add_rtn_u32 v1, v1, v2
    s_waitcnt lgkmcnt(0)
    v_readfirstlane_b32 s89, v1
    s_nop 0
    s_cmp_eq_u32 s89, 7
    s_cbranch_scc0 qkv_sg22
    s_mov_b32 exec_lo, 0xffff
    buffer_store_byte v2, v3, s[96:99], s88 offen sc1
qkv_sg22:
    s_mov_b64 exec, -1
pad11_3:
    s_cbranch_execz wo_warm_ret
    s_branch down_begin
gu_b:
    s_lshr_b32 s45, s32, 1
    s_add_u32 s45, s45, 6
    s_lshl_b32 s45, s45, 16
    s_and_b32 s47, s32, 1
    s_lshl_b32 s44, s47, 10
    s_add_u32 s45, s45, s44
    s_add_u32 s45, s45, s46
    v_add_u32 v10, s45, v9
    s_add_u32 s42, s32, 12
    s_lshl_b32 s42, s42, 10
    s_lshr_b32 s43, s32, 1
    s_mul_i32 s43, s43, 7168
    s_lshl_b32 s44, s47, 12
    s_add_u32 s43, s43, s44
    s_add_u32 s43, s43, 16384
    v_lshlrev_b32 v2, 3, v1
    v_bfe_u32 v3, v0, 2, 2
    v_add_u32 v2, v2, v3
    v_mul_u32_u24 v2, 7168, v2
    v_lshlrev_b32 v3, 1, v1
    v_xor_b32 v3, v3, v0
    v_and_b32 v3, 3, v3
    v_lshl_add_u32 v2, v3, 4, v2
    v_lshrrev_b32 v3, 1, v3
    s_lshl_b32 s44, s35, 1
    s_lshl_b32 s45, s47, 7
    s_add_u32 s44, s44, s45
    v_add_u32 v11, s44, v2
    v_add_u32 v12, 28672, v11
    s_lshl_b32 s45, s36, 1
    s_add_u32 s44, s44, 64
    s_cmp_eq_u32 s47, 0
    s_cselect_b32 s44, s44, s45
    s_cselect_b32 s45, 0, 28640
    s_cselect_b32 s48, 28672, 0x40000000
    s_cselect_b32 s49, s43, 150528
    v_add_u32 v13, s44, v2
    v_add_u32 v14, s48, v13
    v_mad_u32_u24 v13, v3, s45, v13
    s_cmp_ge_u32 s32, 2
    s_waitcnt lgkmcnt(0)
    s_cselect_b32 s4, s6, s4
    s_cselect_b32 s5, s7, s5
    s_mov_b32 s12, s4
    s_mov_b32 s13, s5
    s_mov_b32 s14, 0x700000
    s_mov_b32 s15, 0x00020000
    s_add_u32 s8, s24, 0x2a00000
    s_addc_u32 s9, s25, 0
    s_mov_b32 s10, 0x400000
    s_mov_b32 s11, 0x00020000
    s_add_u32 s16, s24, 0x2800000
    s_addc_u32 s17, s25, 0
    s_mov_b32 s18, 0x20000
    s_mov_b32 s19, 0x00020000
    s_mov_b32 s64, 30720
    s_mov_b32 s65, -122880
    s_mov_b32 s41, 688128
    s_lshl_b32 s44, s32, 12
    v_add_u32 v7, s44, v7
    v_lshlrev_b32 v8, 8, v1
    v_bfe_u32 v2, v0, 2, 2
    v_lshl_add_u32 v8, v2, 6, v8
    v_and_b32 v2, 3, v0
    v_lshl_add_u32 v8, v2, 3, v8
    v_and_b32 v2, 1, v1
    v_lshl_add_u32 v8, v2, 5, v8
    v_add_u32 v8, 16384, v8
    s_mov_b32 s60, 92160
    v_add_u32 v4, s60, v7
    v_add_u32 v5, s60, v8
    v_xor_b32 v6, 32, v5
    v_mov_b32 v24, 0
    v_mov_b32 v25, 0
    v_mov_b32 v26, 0
    v_mov_b32 v27, 0
    v_mov_b32 v28, 0
    v_mov_b32 v29, 0
    v_mov_b32 v30, 0
    v_mov_b32 v31, 0
    v_mov_b32 v32, 0
    v_mov_b32 v33, 0
    v_mov_b32 v34, 0
    v_mov_b32 v35, 0
    v_mov_b32 v36, 0
    v_mov_b32 v37, 0
    v_mov_b32 v38, 0
padc12:
    s_cbranch_execz pad12_1
    v_mov_b32 v39, 0
    v_mov_b32 v40, 0
    v_mov_b32 v41, 0
    v_mov_b32 v42, 0
    v_mov_b32 v43, 0
    v_mov_b32 v44, 0
    v_mov_b32 v45, 0
    v_mov_b32 v46, 0
    v_mov_b32 v47, 0
    v_mov_b32 v48, 0
    v_mov_b32 v49, 0
    v_mov_b32 v50, 0
    v_mov_b32 v51, 0
    v_mov_b32 v52, 0
    v_mov_b32 v53, 0
    v_mov_b32 v54, 0
    v_mov_b32 v55, 0
    v_mov_b32 v56, 0
    v_mov_b32 v57, 0
    v_mov_b32 v58, 0
    v_mov_b32 v59, 0
    v_mov_b32 v60, 0
    v_mov_b32 v61, 0
    v_mov_b32 v62, 0
    v_mov_b32 v63, 0
    v_mov_b32 v64, 0
    v_mov_b32 v65, 0
    v_mov_b32 v66, 0
    v_mov_b32 v67, 0
    v_mov_b32 v68, 0
    v_mov_b32 v69, 0
    v_mov_b32 v70, 0
    v_mov_b32 v71, 0
    v_mov_b32 v72, 0
    v_mov_b32 v73, 0
    v_mov_b32 v74, 0
    v_mov_b32 v75, 0
    v_mov_b32 v76, 0
    v_mov_b32 v77, 0
    v_mov_b32 v78, 0
    v_mov_b32 v79, 0
    v_mov_b32 v80, 0
    v_mov_b32 v81, 0
    v_mov_b32 v82, 0
    v_mov_b32 v83, 0
    v_mov_b32 v84, 0
    v_mov_b32 v85, 0
    v_mov_b32 v86, 0
    v_mov_b32 v87, 0
    v_mov_b32 v88, 0
    v_mov_b32 v89, 0
    v_mov_b32 v90, 0
    v_mov_b32 v91, 0
    v_mov_b32 v92, 0
    v_mov_b32 v93, 0
    v_mov_b32 v94, 0
    v_mov_b32 v95, 0
    v_mov_b32 v96, 0
    v_mov_b32 v97, 0
    v_mov_b32 v98, 0
    v_mov_b32 v99, 0
    v_mov_b32 v100, 0
    v_mov_b32 v101, 0
    v_mov_b32 v102, 0
    v_mov_b32 v103, 0
    v_mov_b32 v104, 0
    v_mov_b32 v105, 0
    v_mov_b32 v106, 0
    v_mov_b32 v107, 0
    v_mov_b32 v108, 0
    v_mov_b32 v109, 0
    v_mov_b32 v110, 0
    v_mov_b32 v111, 0
    v_mov_b32 v112, 0
    v_mov_b32 v113, 0
    v_mov_b32 v114, 0
    v_mov_b32 v115, 0
    v_mov_b32 v116, 0
    v_mov_b32 v117, 0
    v_mov_b32 v118, 0
    v_mov_b32 v119, 0
    s_mov_b32 s20, s80
    s_mov_b32 s21, s81
    s_mov_b32 s22, 0x700000
    s_mov_b32 s23, 0x00020000
    v_lshrrev_b32 v2, 5, v0
    v_lshlrev_b32 v2, 2, v2
    v_bfe_u32 v3, v0, 2, 2
    v_add_u32 v2, v2, v3
    s_mov_b32 s92, 2048
    v_mul_lo_u32 v120, v2, s92
    v_bfe_u32 v2, v0, 4, 1
    v_lshlrev_b32 v2, 6, v2
    v_and_b32 v3, 3, v0
    v_lshlrev_b32 v3, 4, v3
    v_add3_u32 v120, v120, v2, v3
    s_lshl_b32 s54, s32, 15
    s_and_b32 s55, s90, 1
    s_mul_i32 s55, s55, 3670016
    s_add_u32 s54, s54, s55
    s_and_b32 s55, s91, 7
    s_mul_i32 s55, s55, 2
    s_add_u32 s44, s55, 1
    s_and_b32 s55, s55, 15
    s_and_b32 s44, s44, 15
    s_mul_i32 s55, s55, 128
    s_mul_i32 s44, s44, 128
    v_add_u32 v122, s44, v120
    v_add_u32 v120, s55, v120
    v_add_u32 v121, 16384, v120
    v_add_u32 v123, 16384, v122
    s_lshl_b32 s55, s32, 11
    s_lshl_b32 s44, s30, 5
    s_add_u32 s44, s44, s31
    s_mov_b64 exec, 0
    s_cmp_eq_u32 s3, 4
    s_cbranch_scc1 padc15
    s_cmp_eq_u32 s3, 5
    s_cbranch_scc1 padc16
    s_cmp_eq_u32 s3, 6
    s_cbranch_scc1 padc17
    s_cmp_eq_u32 s3, 7
    s_cbranch_scc1 padc18
gu_warm_ret:
    s_mov_b64 exec, -1
pad12_1:
    s_cbranch_execz pad12_2
    s_cmp_eq_u32 s3, 4
    s_cbranch_scc0 qkv_pl23
    s_lshl_b32 s58, s44, 7
    s_add_u32 s56, s86, s58
    s_addc_u32 s57, s87, 0
    s_add_u32 s56, s56, 0x4400020
    s_addc_u32 s57, s57, 0
    s_mov_b32 s58, 0x40000
qkv_pll24:
    s_load_dwordx8 s[24:31], s[56:57], 0 glc
    s_waitcnt lgkmcnt(0)
    s_and_b32 s24, s24, s25
    s_and_b32 s26, s26, s27
    s_and_b32 s28, s28, s29
    s_and_b32 s30, s30, s31
    s_and_b32 s24, s24, s26
    s_and_b32 s28, s28, s30
    s_and_b32 s24, s24, s28
    s_cmp_eq_u32 s24, 0x01010101
    s_cbranch_scc1 qkv_pl23x
    s_sub_u32 s58, s58, 1
    s_cbranch_scc0 qkv_pll24
qkv_pl23x:
qkv_pl23:
    s_barrier
    s_add_u32 m0, s42, 92160
    s_nop 0
    buffer_load_dwordx4 v10, s[8:11], s40 offen sc1 lds
    s_add_u32 s40, s40, 2048
    s_add_u32 m0, s42, 122880
    s_nop 0
    buffer_load_dwordx4 v10, s[8:11], s40 offen sc1 lds
    s_add_u32 s40, s40, 2048
    v_lshlrev_b32 v2, 3, v0
    buffer_load_dwordx2 v[216:217], v2, s[16:19], s38 offen offset:0 sc1
    buffer_load_dwordx2 v[218:219], v2, s[16:19], s38 offen offset:512 sc1
    buffer_load_dwordx2 v[220:221], v2, s[16:19], s38 offen offset:1024 sc1
    buffer_load_dwordx2 v[222:223], v2, s[16:19], s38 offen offset:1536 sc1
    buffer_load_dwordx2 v[224:225], v2, s[16:19], s38 offen offset:2048 sc1
    buffer_load_dwordx2 v[226:227], v2, s[16:19], s38 offen offset:2560 sc1
    buffer_load_dwordx2 v[228:229], v2, s[16:19], s38 offen offset:3072 sc1
    buffer_load_dwordx2 v[230:231], v2, s[16:19], s38 offen offset:3584 sc1
    s_waitcnt vmcnt(9)
    s_barrier
    ds_read_b128 v[152:155], v4 offset:0
    ds_read_b64_tr_b16 v[184:185], v5 offset:4096
    ds_read_b64_tr_b16 v[186:187], v5 offset:5120
    ds_read_b128 v[156:159], v4 offset:256
    ds_read_b128 v[160:163], v4 offset:2048
    ds_read_b128 v[164:167], v4 offset:2304
    ds_read_b64_tr_b16 v[188:189], v5 offset:11264
    ds_read_b64_tr_b16 v[190:191], v5 offset:12288
    ds_read_b64_tr_b16 v[192:193], v6 offset:4096
    ds_read_b64_tr_b16 v[194:195], v6 offset:5120
    ds_read_b64_tr_b16 v[196:197], v6 offset:11264
    ds_read_b64_tr_b16 v[198:199], v6 offset:12288
    ds_read_b64_tr_b16 v[200:201], v5 offset:6144
    ds_read_b64_tr_b16 v[202:203], v6 offset:6144
    ds_read_b64_tr_b16 v[204:205], v5 offset:13312
    ds_read_b64_tr_b16 v[206:207], v6 offset:13312
    s_waitcnt vmcnt(0)
    v_pk_add_f32 v[216:217], v[216:217], v[218:219]
    v_pk_add_f32 v[220:221], v[220:221], v[222:223]
    v_pk_add_f32 v[224:225], v[224:225], v[226:227]
    v_pk_add_f32 v[228:229], v[228:229], v[230:231]
    v_pk_add_f32 v[216:217], v[216:217], v[220:221]
    v_pk_add_f32 v[224:225], v[224:225], v[228:229]
    v_mov_b32 v218, v216
    v_mov_b32 v219, v217
    v_mov_b32 v226, v224
    v_mov_b32 v227, v225
    v_permlane16_swap_b32 v216, v218
    v_permlane16_swap_b32 v217, v219
    v_permlane16_swap_b32 v224, v226
    v_permlane16_swap_b32 v225, v227
    v_add_f32 v216, v216, v218
    v_add_f32 v217, v217, v219
    v_add_f32 v224, v224, v226
    v_add_f32 v225, v225, v227
    v_mov_b32 v218, v216
    v_mov_b32 v219, v217
pad12_2:
    s_cbranch_execz pad12_3
    v_mov_b32 v226, v224
    v_mov_b32 v227, v225
    v_permlane32_swap_b32 v216, v218
    v_permlane32_swap_b32 v217, v219
    v_permlane32_swap_b32 v224, v226
    v_permlane32_swap_b32 v225, v227
    v_add_f32 v216, v216, v218
    v_add_f32 v217, v217, v219
    v_add_f32 v224, v224, v226
    v_add_f32 v225, v225, v227
    v_mov_b32 v17, 0x3727c5ac
    v_mov_b32 v19, 0x3727c5ac
    v_mov_b32 v21, 0x3727c5ac
    v_mov_b32 v23, 0x3727c5ac
    v_fmac_f32 v17, 0x3a800000, v216
    v_fmac_f32 v19, 0x3a800000, v217
    v_fmac_f32 v21, 0x3a800000, v224
    v_fmac_f32 v23, 0x3a800000, v225
    v_rsq_f32 v16, v17
    v_rsq_f32 v18, v19
    v_rsq_f32 v20, v21
    v_rsq_f32 v22, v23
    v_mul_f32 v16, 0xbfb8aa3b, v16
    v_mul_f32 v18, 0xbfb8aa3b, v18
    v_mul_f32 v20, 0xbfb8aa3b, v20
    v_mul_f32 v22, 0xbfb8aa3b, v22
    s_waitcnt lgkmcnt(13)
    v_mfma_f32_16x16x32_bf16 v[24:27], v[184:187], v[152:155], v[24:27]
    s_add_u32 s60, s60, 30720
    s_cmp_ge_u32 s60, 153600
    s_cselect_b32 s60, 0, s60
    v_add_u32 v4, s60, v7
    v_add_u32 v5, s60, v8
    v_xor_b32 v6, 32, v5
    s_add_u32 m0, s42, 0
    s_nop 0
    buffer_load_dwordx4 v10, s[8:11], s40 offen sc1 lds
    s_waitcnt lgkmcnt(12)
    v_mfma_f32_16x16x32_bf16 v[28:31], v[184:187], v[156:159], v[28:31]
    s_add_u32 s40, s40, 2048
    s_add_u32 s42, s42, 30720
    s_add_u32 s43, s43, 30720
    s_add_u32 s49, s49, 30720
    s_mov_b32 s62, 1
    s_cmp_eq_u32 s47, 0
    s_cselect_b32 s49, s43, 150528
    s_waitcnt lgkmcnt(0)
    s_waitcnt vmcnt(1)
    s_barrier
    v_mfma_f32_16x16x32_bf16 v[72:75], v[184:187], v[160:163], v[72:75]
    ds_read_b128 v[168:171], v4 offset:0
    v_mfma_f32_16x16x32_bf16 v[76:79], v[184:187], v[164:167], v[76:79]
    s_add_u32 m0, s42, 0
    ds_read_b64_tr_b16 v[216:217], v5 offset:4096
    v_mfma_f32_16x16x32_bf16 v[32:35], v[188:191], v[152:155], v[32:35]
    buffer_load_dwordx4 v10, s[8:11], s40 offen sc1 lds
    ds_read_b64_tr_b16 v[218:219], v5 offset:5120
    v_mfma_f32_16x16x32_bf16 v[36:39], v[188:191], v[156:159], v[36:39]
    ds_read_b128 v[172:175], v4 offset:256
    v_mfma_f32_16x16x32_bf16 v[80:83], v[188:191], v[160:163], v[80:83]
    s_add_u32 m0, s43, 0
    ds_read_b128 v[176:179], v4 offset:2048
    v_mfma_f32_16x16x32_bf16 v[84:87], v[188:191], v[164:167], v[84:87]
    buffer_load_dwordx4 v11, s[12:15], s41 offen lds
    ds_read_b128 v[180:183], v4 offset:2304
    v_mfma_f32_16x16x32_bf16 v[40:43], v[192:195], v[152:155], v[40:43]
    ds_read_b64_tr_b16 v[220:221], v5 offset:11264
    v_mfma_f32_16x16x32_bf16 v[44:47], v[192:195], v[156:159], v[44:47]
    s_add_u32 m0, s43, 1024
    ds_read_b64_tr_b16 v[222:223], v5 offset:12288
    v_mfma_f32_16x16x32_bf16 v[88:91], v[192:195], v[160:163], v[88:91]
    buffer_load_dwordx4 v12, s[12:15], s41 offen lds
    ds_read_b64_tr_b16 v[224:225], v6 offset:4096
    v_mfma_f32_16x16x32_bf16 v[92:95], v[192:195], v[164:167], v[92:95]
    ds_read_b64_tr_b16 v[226:227], v6 offset:5120
    v_mfma_f32_16x16x32_bf16 v[48:51], v[196:199], v[152:155], v[48:51]
    s_add_u32 m0, s43, 2048
    ds_read_b64_tr_b16 v[228:229], v6 offset:11264
pad12_3:
    s_cbranch_execz pad12_4
    v_mfma_f32_16x16x32_bf16 v[52:55], v[196:199], v[156:159], v[52:55]
    buffer_load_dwordx4 v13, s[12:15], s41 offen lds
    ds_read_b64_tr_b16 v[230:231], v6 offset:12288
    v_mfma_f32_16x16x32_bf16 v[96:99], v[196:199], v[160:163], v[96:99]
    ds_read_b64_tr_b16 v[232:233], v5 offset:6144
    v_mfma_f32_16x16x32_bf16 v[100:103], v[196:199], v[164:167], v[100:103]
    s_add_u32 m0, s49, 3072
    ds_read_b64_tr_b16 v[234:235], v6 offset:6144
    v_mfma_f32_16x16x32_bf16 v[56:59], v[200:203], v[152:155], v[56:59]
    buffer_load_dwordx4 v14, s[12:15], s41 offen lds
    ds_read_b64_tr_b16 v[236:237], v5 offset:13312
    v_mfma_f32_16x16x32_bf16 v[60:63], v[200:203], v[156:159], v[60:63]
    s_add_u32 s40, s40, 2048
    s_add_u32 s41, s41, 229376
    ds_read_b64_tr_b16 v[238:239], v6 offset:13312
    v_mfma_f32_16x16x32_bf16 v[104:107], v[200:203], v[160:163], v[104:107]
    s_add_u32 s62, s62, 1
    s_cmp_ge_u32 s62, 5
    v_mfma_f32_16x16x32_bf16 v[108:111], v[200:203], v[164:167], v[108:111]
    s_cselect_b32 s62, 0, s62
    s_cselect_b32 s63, s65, s64
    v_mfma_f32_16x16x32_bf16 v[64:67], v[204:207], v[152:155], v[64:67]
    s_add_u32 s42, s42, s63
    s_add_u32 s43, s43, s63
    v_mfma_f32_16x16x32_bf16 v[68:71], v[204:207], v[156:159], v[68:71]
    s_add_u32 s49, s49, s63
    s_cmp_eq_u32 s47, 0
    v_mfma_f32_16x16x32_bf16 v[112:115], v[204:207], v[160:163], v[112:115]
    s_cselect_b32 s49, s43, 150528
    v_mfma_f32_16x16x32_bf16 v[116:119], v[204:207], v[164:167], v[116:119]
    s_waitcnt lgkmcnt(13)
    v_mfma_f32_16x16x32_bf16 v[24:27], v[216:219], v[168:171], v[24:27]
    s_add_u32 s60, s60, 30720
    s_cmp_ge_u32 s60, 153600
    s_cselect_b32 s60, 0, s60
    v_add_u32 v4, s60, v7
    v_add_u32 v5, s60, v8
    v_xor_b32 v6, 32, v5
    s_add_u32 m0, s42, 0
    s_nop 0
    buffer_load_dwordx4 v10, s[8:11], s40 offen sc1 lds
    s_waitcnt lgkmcnt(12)
    v_mfma_f32_16x16x32_bf16 v[28:31], v[216:219], v[172:175], v[28:31]
    s_add_u32 m0, s43, 0
    s_nop 0
    buffer_load_dwordx4 v11, s[12:15], s41 offen lds
    s_add_u32 m0, s43, 1024
    s_nop 0
    buffer_load_dwordx4 v12, s[12:15], s41 offen lds
    s_add_u32 m0, s43, 2048
    s_nop 0
    buffer_load_dwordx4 v13, s[12:15], s41 offen lds
    s_add_u32 m0, s49, 3072
    s_nop 0
    buffer_load_dwordx4 v14, s[12:15], s41 offen lds
    s_add_u32 s40, s40, 2048
    s_add_u32 s41, s41, 229376
    s_add_u32 s62, s62, 1
    s_cmp_ge_u32 s62, 5
    s_cselect_b32 s62, 0, s62
    s_cselect_b32 s63, s65, s64
    s_add_u32 s42, s42, s63
    s_add_u32 s43, s43, s63
    s_add_u32 s49, s49, s63
    s_cmp_eq_u32 s47, 0
    s_cselect_b32 s49, s43, 150528
    s_waitcnt lgkmcnt(0)
    s_waitcnt vmcnt(10)
    s_barrier
    v_mfma_f32_16x16x32_bf16 v[72:75], v[216:219], v[176:179], v[72:75]
    ds_read_b128 v[152:155], v4 offset:0
    v_mfma_f32_16x16x32_bf16 v[76:79], v[216:219], v[180:183], v[76:79]
    s_add_u32 m0, s42, 0
    ds_read_b64_tr_b16 v[184:185], v5 offset:4096
    v_mfma_f32_16x16x32_bf16 v[32:35], v[220:223], v[168:171], v[32:35]
    buffer_load_dwordx4 v10, s[8:11], s40 offen sc1 lds
    ds_read_b64_tr_b16 v[186:187], v5 offset:5120
    v_mfma_f32_16x16x32_bf16 v[36:39], v[220:223], v[172:175], v[36:39]
    ds_read_b128 v[156:159], v4 offset:256
    v_mfma_f32_16x16x32_bf16 v[80:83], v[220:223], v[176:179], v[80:83]
pad12_4:
    s_cbranch_execz wo_warm_ret2
    s_add_u32 m0, s43, 0
    ds_read_b128 v[160:163], v4 offset:2048
    v_mfma_f32_16x16x32_bf16 v[84:87], v[220:223], v[180:183], v[84:87]
    buffer_load_dwordx4 v11, s[12:15], s41 offen lds
    ds_read_b128 v[164:167], v4 offset:2304
    v_mfma_f32_16x16x32_bf16 v[40:43], v[224:227], v[168:171], v[40:43]
    ds_read_b64_tr_b16 v[188:189], v5 offset:11264
    v_mfma_f32_16x16x32_bf16 v[44:47], v[224:227], v[172:175], v[44:47]
    s_add_u32 m0, s43, 1024
    ds_read_b64_tr_b16 v[190:191], v5 offset:12288
    v_mfma_f32_16x16x32_bf16 v[88:91], v[224:227], v[176:179], v[88:91]
    buffer_load_dwordx4 v12, s[12:15], s41 offen lds
    ds_read_b64_tr_b16 v[192:193], v6 offset:4096
    v_mfma_f32_16x16x32_bf16 v[92:95], v[224:227], v[180:183], v[92:95]
    ds_read_b64_tr_b16 v[194:195], v6 offset:5120
    v_mfma_f32_16x16x32_bf16 v[48:51], v[228:231], v[168:171], v[48:51]
    s_add_u32 m0, s43, 2048
    ds_read_b64_tr_b16 v[196:197], v6 offset:11264
    v_mfma_f32_16x16x32_bf16 v[52:55], v[228:231], v[172:175], v[52:55]
    buffer_load_dwordx4 v13, s[12:15], s41 offen lds
    ds_read_b64_tr_b16 v[198:199], v6 offset:12288
    v_mfma_f32_16x16x32_bf16 v[96:99], v[228:231], v[176:179], v[96:99]
    ds_read_b64_tr_b16 v[200:201], v5 offset:6144
    v_mfma_f32_16x16x32_bf16 v[100:103], v[228:231], v[180:183], v[100:103]
    s_add_u32 m0, s49, 3072
    ds_read_b64_tr_b16 v[202:203], v6 offset:6144
    v_mfma_f32_16x16x32_bf16 v[56:59], v[232:235], v[168:171], v[56:59]
    buffer_load_dwordx4 v14, s[12:15], s41 offen lds
    ds_read_b64_tr_b16 v[204:205], v5 offset:13312
    v_mfma_f32_16x16x32_bf16 v[60:63], v[232:235], v[172:175], v[60:63]
    s_add_u32 s40, s40, 2048
    s_add_u32 s41, s41, 229376
    ds_read_b64_tr_b16 v[206:207], v6 offset:13312
    v_mfma_f32_16x16x32_bf16 v[104:107], v[232:235], v[176:179], v[104:107]
    s_add_u32 s62, s62, 1
    s_cmp_ge_u32 s62, 5
    v_mfma_f32_16x16x32_bf16 v[108:111], v[232:235], v[180:183], v[108:111]
    s_cselect_b32 s62, 0, s62
    s_cselect_b32 s63, s65, s64
    v_mfma_f32_16x16x32_bf16 v[64:67], v[236:239], v[168:171], v[64:67]
    s_add_u32 s42, s42, s63
    s_add_u32 s43, s43, s63
    v_mfma_f32_16x16x32_bf16 v[68:71], v[236:239], v[172:175], v[68:71]
    s_add_u32 s49, s49, s63
    s_cmp_eq_u32 s47, 0
    v_mfma_f32_16x16x32_bf16 v[112:115], v[236:239], v[176:179], v[112:115]
    s_cselect_b32 s49, s43, 150528
    v_mfma_f32_16x16x32_bf16 v[116:119], v[236:239], v[180:183], v[116:119]
    s_waitcnt lgkmcnt(13)
    v_mfma_f32_16x16x32_bf16 v[24:27], v[184:187], v[152:155], v[24:27]
    s_add_u32 s60, s60, 30720
    s_cmp_ge_u32 s60, 153600
    s_cselect_b32 s60, 0, s60
    v_add_u32 v4, s60, v7
    v_add_u32 v5, s60, v8
    v_xor_b32 v6, 32, v5
    s_add_u32 m0, s42, 0
    s_nop 0
    buffer_load_dwordx4 v10, s[8:11], s40 offen sc1 lds
    s_waitcnt lgkmcnt(12)
    v_mfma_f32_16x16x32_bf16 v[28:31], v[184:187], v[156:159], v[28:31]
    s_add_u32 m0, s43, 0
    s_nop 0
    buffer_load_dwordx4 v11, s[12:15], s41 offen lds
    s_add_u32 m0, s43, 1024
    s_nop 0
    buffer_load_dwordx4 v12, s[12:15], s41 offen lds
    s_add_u32 m0, s43, 2048
    s_nop 0
    buffer_load_dwordx4 v13, s[12:15], s41 offen lds
    s_add_u32 m0, s49, 3072
    s_nop 0
    buffer_load_dwordx4 v14, s[12:15], s41 offen lds
    s_add_u32 s40, s40, 2048
    s_add_u32 s41, s41, 229376
padc13:
    s_cbranch_execz pad13_1
    s_add_u32 s62, s62, 1
    s_cmp_ge_u32 s62, 5
    s_cselect_b32 s62, 0, s62
    s_cselect_b32 s63, s65, s64
    s_add_u32 s42, s42, s63
    s_add_u32 s43, s43, s63
    s_add_u32 s49, s49, s63
    s_cmp_eq_u32 s47, 0
    s_cselect_b32 s49, s43, 150528
    s_waitcnt lgkmcnt(0)
    s_waitcnt vmcnt(15)
    s_barrier
    v_mfma_f32_16x16x32_bf16 v[72:75], v[184:187], v[160:163], v[72:75]
    ds_read_b128 v[168:171], v4 offset:0
    v_mfma_f32_16x16x32_bf16 v[76:79], v[184:187], v[164:167], v[76:79]
    s_add_u32 m0, s42, 0
    ds_read_b64_tr_b16 v[216:217], v5 offset:4096
    v_mfma_f32_16x16x32_bf16 v[32:35], v[188:191], v[152:155], v[32:35]
    buffer_load_dwordx4 v10, s[8:11], s40 offen sc1 lds
    ds_read_b64_tr_b16 v[218:219], v5 offset:5120
    v_mfma_f32_16x16x32_bf16 v[36:39], v[188:191], v[156:159], v[36:39]
    ds_read_b128 v[172:175], v4 offset:256
    v_mfma_f32_16x16x32_bf16 v[80:83], v[188:191], v[160:163], v[80:83]
    s_add_u32 m0, s43, 0
    ds_read_b128 v[176:179], v4 offset:2048
    v_mfma_f32_16x16x32_bf16 v[84:87], v[188:191], v[164:167], v[84:87]
    buffer_load_dwordx4 v11, s[12:15], s41 offen lds
    ds_read_b128 v[180:183], v4 offset:2304
    v_mfma_f32_16x16x32_bf16 v[40:43], v[192:195], v[152:155], v[40:43]
    ds_read_b64_tr_b16 v[220:221], v5 offset:11264
    v_mfma_f32_16x16x32_bf16 v[44:47], v[192:195], v[156:159], v[44:47]
    s_add_u32 m0, s43, 1024
    ds_read_b64_tr_b16 v[222:223], v5 offset:12288
    v_mfma_f32_16x16x32_bf16 v[88:91], v[192:195], v[160:163], v[88:91]
    buffer_load_dwordx4 v12, s[12:15], s41 offen lds
    ds_read_b64_tr_b16 v[224:225], v6 offset:4096
    v_mfma_f32_16x16x32_bf16 v[92:95], v[192:195], v[164:167], v[92:95]
    ds_read_b64_tr_b16 v[226:227], v6 offset:5120
    v_mfma_f32_16x16x32_bf16 v[48:51], v[196:199], v[152:155], v[48:51]
    s_add_u32 m0, s43, 2048
    ds_read_b64_tr_b16 v[228:229], v6 offset:11264
    v_mfma_f32_16x16x32_bf16 v[52:55], v[196:199], v[156:159], v[52:55]
    buffer_load_dwordx4 v13, s[12:15], s41 offen lds
    ds_read_b64_tr_b16 v[230:231], v6 offset:12288
    v_mfma_f32_16x16x32_bf16 v[96:99], v[196:199], v[160:163], v[96:99]
    ds_read_b64_tr_b16 v[232:233], v5 offset:6144
    v_mfma_f32_16x16x32_bf16 v[100:103], v[196:199], v[164:167], v[100:103]
    s_add_u32 m0, s49, 3072
    ds_read_b64_tr_b16 v[234:235], v6 offset:6144
    v_mfma_f32_16x16x32_bf16 v[56:59], v[200:203], v[152:155], v[56:59]
    buffer_load_dwordx4 v14, s[12:15], s41 offen lds
    ds_read_b64_tr_b16 v[236:237], v5 offset:13312
    v_mfma_f32_16x16x32_bf16 v[60:63], v[200:203], v[156:159], v[60:63]
    s_add_u32 s40, s40, 2048
    s_add_u32 s41, s41, 229376
    ds_read_b64_tr_b16 v[238:239], v6 offset:13312
    v_mfma_f32_16x16x32_bf16 v[104:107], v[200:203], v[160:163], v[104:107]
    s_add_u32 s62, s62, 1
    s_cmp_ge_u32 s62, 5
    v_mfma_f32_16x16x32_bf16 v[108:111], v[200:203], v[164:167], v[108:111]
    s_cselect_b32 s62, 0, s62
    s_cselect_b32 s63, s65, s64
    v_mfma_f32_16x16x32_bf16 v[64:67], v[204:207], v[152:155], v[64:67]
    s_add_u32 s42, s42, s63
    s_add_u32 s43, s43, s63
    v_mfma_f32_16x16x32_bf16 v[68:71], v[204:207], v[156:159], v[68:71]
    s_add_u32 s49, s49, s63
    s_cmp_eq_u32 s47, 0
    v_mfma_f32_16x16x32_bf16 v[112:115], v[204:207], v[160:163], v[112:115]
    s_cselect_b32 s49, s43, 150528
    v_mfma_f32_16x16x32_bf16 v[116:119], v[204:207], v[164:167], v[116:119]
    s_mov_b32 s61, 12
    .p2align 4
qkv_loop25:
    s_waitcnt lgkmcnt(13)
    v_mfma_f32_16x16x32_bf16 v[24:27], v[216:219], v[168:171], v[24:27]
    s_add_u32 s60, s60, 30720
    s_cmp_ge_u32 s60, 153600
    s_cselect_b32 s60, 0, s60
    v_add_u32 v4, s60, v7
    v_add_u32 v5, s60, v8
    v_xor_b32 v6, 32, v5
    s_waitcnt lgkmcnt(12)
    v_mfma_f32_16x16x32_bf16 v[28:31], v[216:219], v[172:175], v[28:31]
    s_waitcnt lgkmcnt(0)
    s_waitcnt vmcnt(15)
    s_barrier
    v_mfma_f32_16x16x32_bf16 v[72:75], v[216:219], v[176:179], v[72:75]
    ds_read_b128 v[152:155], v4 offset:0
    v_mfma_f32_16x16x32_bf16 v[76:79], v[216:219], v[180:183], v[76:79]
    s_add_u32 m0, s42, 0
    ds_read_b64_tr_b16 v[184:185], v5 offset:4096
    v_mfma_f32_16x16x32_bf16 v[32:35], v[220:223], v[168:171], v[32:35]
    buffer_load_dwordx4 v10, s[8:11], s40 offen sc1 lds
    ds_read_b64_tr_b16 v[186:187], v5 offset:5120
    v_mfma_f32_16x16x32_bf16 v[36:39], v[220:223], v[172:175], v[36:39]
    ds_read_b128 v[156:159], v4 offset:256
    v_mfma_f32_16x16x32_bf16 v[80:83], v[220:223], v[176:179], v[80:83]
    s_add_u32 m0, s43, 0
    ds_read_b128 v[160:163], v4 offset:2048
    v_mfma_f32_16x16x32_bf16 v[84:87], v[220:223], v[180:183], v[84:87]
    buffer_load_dwordx4 v11, s[12:15], s41 offen lds
    ds_read_b128 v[164:167], v4 offset:2304
    v_mfma_f32_16x16x32_bf16 v[40:43], v[224:227], v[168:171], v[40:43]
    ds_read_b64_tr_b16 v[188:189], v5 offset:11264
    v_mfma_f32_16x16x32_bf16 v[44:47], v[224:227], v[172:175], v[44:47]
    s_add_u32 m0, s43, 1024
    ds_read_b64_tr_b16 v[190:191], v5 offset:12288
    v_mfma_f32_16x16x32_bf16 v[88:91], v[224:227], v[176:179], v[88:91]
    buffer_load_dwordx4 v12, s[12:15], s41 offen lds
    ds_read_b64_tr_b16 v[192:193], v6 offset:4096
    v_mfma_f32_16x16x32_bf16 v[92:95], v[224:227], v[180:183], v[92:95]
    ds_read_b64_tr_b16 v[194:195], v6 offset:5120
    v_mfma_f32_16x16x32_bf16 v[48:51], v[228:231], v[168:171], v[48:51]
    s_add_u32 m0, s43, 2048
    ds_read_b64_tr_b16 v[196:197], v6 offset:11264
    v_mfma_f32_16x16x32_bf16 v[52:55], v[228:231], v[172:175], v[52:55]
    buffer_load_dwordx4 v13, s[12:15], s41 offen lds
    ds_read_b64_tr_b16 v[198:199], v6 offset:12288
    v_mfma_f32_16x16x32_bf16 v[96:99], v[228:231], v[176:179], v[96:99]
    ds_read_b64_tr_b16 v[200:201], v5 offset:6144
    v_mfma_f32_16x16x32_bf16 v[100:103], v[228:231], v[180:183], v[100:103]
    s_add_u32 m0, s49, 3072
    ds_read_b64_tr_b16 v[202:203], v6 offset:6144
    v_mfma_f32_16x16x32_bf16 v[56:59], v[232:235], v[168:171], v[56:59]
    buffer_load_dwordx4 v14, s[12:15], s41 offen lds
    ds_read_b64_tr_b16 v[204:205], v5 offset:13312
    v_mfma_f32_16x16x32_bf16 v[60:63], v[232:235], v[172:175], v[60:63]
    s_add_u32 s40, s40, 2048
    s_add_u32 s41, s41, 229376
    ds_read_b64_tr_b16 v[206:207], v6 offset:13312
    v_mfma_f32_16x16x32_bf16 v[104:107], v[232:235], v[176:179], v[104:107]
    s_add_u32 s62, s62, 1
    s_cmp_ge_u32 s62, 5
    v_mfma_f32_16x16x32_bf16 v[108:111], v[232:235], v[180:183], v[108:111]
    s_cselect_b32 s62, 0, s62
    s_cselect_b32 s63, s65, s64
    v_mfma_f32_16x16x32_bf16 v[64:67], v[236:239], v[168:171], v[64:67]
    s_add_u32 s42, s42, s63
    s_add_u32 s43, s43, s63
    v_mfma_f32_16x16x32_bf16 v[68:71], v[236:239], v[172:175], v[68:71]
    s_add_u32 s49, s49, s63
    s_cmp_eq_u32 s47, 0
    v_mfma_f32_16x16x32_bf16 v[112:115], v[236:239], v[176:179], v[112:115]
    s_cselect_b32 s49, s43, 150528
    v_mfma_f32_16x16x32_bf16 v[116:119], v[236:239], v[180:183], v[116:119]
    s_waitcnt lgkmcnt(13)
    v_mfma_f32_16x16x32_bf16 v[24:27], v[184:187], v[152:155], v[24:27]
    s_add_u32 s60, s60, 30720
    s_cmp_ge_u32 s60, 153600
    s_cselect_b32 s60, 0, s60
    v_add_u32 v4, s60, v7
    v_add_u32 v5, s60, v8
    v_xor_b32 v6, 32, v5
    s_waitcnt lgkmcnt(12)
    v_mfma_f32_16x16x32_bf16 v[28:31], v[184:187], v[156:159], v[28:31]
    s_waitcnt lgkmcnt(0)
    s_waitcnt vmcnt(15)
    s_barrier
    v_mfma_f32_16x16x32_bf16 v[72:75], v[184:187], v[160:163], v[72:75]
    ds_read_b128 v[168:171], v4 offset:0
    v_mfma_f32_16x16x32_bf16 v[76:79], v[184:187], v[164:167], v[76:79]
    s_add_u32 m0, s42, 0
    ds_read_b64_tr_b16 v[216:217], v5 offset:4096
    v_mfma_f32_16x16x32_bf16 v[32:35], v[188:191], v[152:155], v[32:35]
    buffer_load_dwordx4 v10, s[8:11], s40 offen sc1 lds
    ds_read_b64_tr_b16 v[218:219], v5 offset:5120
    v_mfma_f32_16x16x32_bf16 v[36:39], v[188:191], v[156:159], v[36:39]
    ds_read_b128 v[172:175], v4 offset:256
    v_mfma_f32_16x16x32_bf16 v[80:83], v[188:191], v[160:163], v[80:83]
    s_add_u32 m0, s43, 0
    ds_read_b128 v[176:179], v4 offset:2048
    v_mfma_f32_16x16x32_bf16 v[84:87], v[188:191], v[164:167], v[84:87]
    buffer_load_dwordx4 v11, s[12:15], s41 offen lds
    ds_read_b128 v[180:183], v4 offset:2304
    v_mfma_f32_16x16x32_bf16 v[40:43], v[192:195], v[152:155], v[40:43]
    ds_read_b64_tr_b16 v[220:221], v5 offset:11264
    v_mfma_f32_16x16x32_bf16 v[44:47], v[192:195], v[156:159], v[44:47]
    s_add_u32 m0, s43, 1024
    ds_read_b64_tr_b16 v[222:223], v5 offset:12288
    v_mfma_f32_16x16x32_bf16 v[88:91], v[192:195], v[160:163], v[88:91]
    buffer_load_dwordx4 v12, s[12:15], s41 offen lds
    ds_read_b64_tr_b16 v[224:225], v6 offset:4096
    v_mfma_f32_16x16x32_bf16 v[92:95], v[192:195], v[164:167], v[92:95]
    ds_read_b64_tr_b16 v[226:227], v6 offset:5120
    v_mfma_f32_16x16x32_bf16 v[48:51], v[196:199], v[152:155], v[48:51]
    s_add_u32 m0, s43, 2048
    ds_read_b64_tr_b16 v[228:229], v6 offset:11264
    v_mfma_f32_16x16x32_bf16 v[52:55], v[196:199], v[156:159], v[52:55]
    buffer_load_dwordx4 v13, s[12:15], s41 offen lds
    ds_read_b64_tr_b16 v[230:231], v6 offset:12288
    v_mfma_f32_16x16x32_bf16 v[96:99], v[196:199], v[160:163], v[96:99]
    ds_read_b64_tr_b16 v[232:233], v5 offset:6144
    v_mfma_f32_16x16x32_bf16 v[100:103], v[196:199], v[164:167], v[100:103]
    s_add_u32 m0, s49, 3072
    ds_read_b64_tr_b16 v[234:235], v6 offset:6144
    v_mfma_f32_16x16x32_bf16 v[56:59], v[200:203], v[152:155], v[56:59]
    buffer_load_dwordx4 v14, s[12:15], s41 offen lds
    ds_read_b64_tr_b16 v[236:237], v5 offset:13312
    v_mfma_f32_16x16x32_bf16 v[60:63], v[200:203], v[156:159], v[60:63]
    s_add_u32 s40, s40, 2048
    s_add_u32 s41, s41, 229376
    ds_read_b64_tr_b16 v[238:239], v6 offset:13312
    v_mfma_f32_16x16x32_bf16 v[104:107], v[200:203], v[160:163], v[104:107]
    s_add_u32 s62, s62, 1
    s_cmp_ge_u32 s62, 5
    v_mfma_f32_16x16x32_bf16 v[108:111], v[200:203], v[164:167], v[108:111]
    s_cselect_b32 s62, 0, s62
    s_cselect_b32 s63, s65, s64
    v_mfma_f32_16x16x32_bf16 v[64:67], v[204:207], v[152:155], v[64:67]
    s_add_u32 s42, s42, s63
    s_add_u32 s43, s43, s63
    v_mfma_f32_16x16x32_bf16 v[68:71], v[204:207], v[156:159], v[68:71]
    s_add_u32 s49, s49, s63
    s_cmp_eq_u32 s47, 0
    v_mfma_f32_16x16x32_bf16 v[112:115], v[204:207], v[160:163], v[112:115]
    s_cselect_b32 s49, s43, 150528
    v_mfma_f32_16x16x32_bf16 v[116:119], v[204:207], v[164:167], v[116:119]
    s_sub_u32 s61, s61, 1
    s_cmp_lg_u32 s61, 0
    s_cbranch_scc1 qkv_loop25
pad13_1:
    s_cbranch_execz pad13_2
    s_waitcnt lgkmcnt(13)
    v_mfma_f32_16x16x32_bf16 v[24:27], v[216:219], v[168:171], v[24:27]
    s_add_u32 s60, s60, 30720
    s_cmp_ge_u32 s60, 153600
    s_cselect_b32 s60, 0, s60
    v_add_u32 v4, s60, v7
    v_add_u32 v5, s60, v8
    v_xor_b32 v6, 32, v5
    s_waitcnt lgkmcnt(12)
    v_mfma_f32_16x16x32_bf16 v[28:31], v[216:219], v[172:175], v[28:31]
    s_waitcnt lgkmcnt(0)
    s_waitcnt vmcnt(15)
    s_barrier
    v_mfma_f32_16x16x32_bf16 v[72:75], v[216:219], v[176:179], v[72:75]
    ds_read_b128 v[152:155], v4 offset:0
    v_mfma_f32_16x16x32_bf16 v[76:79], v[216:219], v[180:183], v[76:79]
    s_add_u32 m0, s55, 0
    ds_read_b64_tr_b16 v[184:185], v5 offset:4096
    v_mfma_f32_16x16x32_bf16 v[32:35], v[220:223], v[168:171], v[32:35]
    buffer_load_dwordx4 v120, s[20:23], s54 offen lds
    ds_read_b64_tr_b16 v[186:187], v5 offset:5120
    v_mfma_f32_16x16x32_bf16 v[36:39], v[220:223], v[172:175], v[36:39]
    ds_read_b128 v[156:159], v4 offset:256
    v_mfma_f32_16x16x32_bf16 v[80:83], v[220:223], v[176:179], v[80:83]
    s_add_u32 m0, s55, 1024
    ds_read_b128 v[160:163], v4 offset:2048
    v_mfma_f32_16x16x32_bf16 v[84:87], v[220:223], v[180:183], v[84:87]
    buffer_load_dwordx4 v121, s[20:23], s54 offen lds
    ds_read_b128 v[164:167], v4 offset:2304
    v_mfma_f32_16x16x32_bf16 v[40:43], v[224:227], v[168:171], v[40:43]
    ds_read_b64_tr_b16 v[188:189], v5 offset:11264
    v_mfma_f32_16x16x32_bf16 v[44:47], v[224:227], v[172:175], v[44:47]
    s_add_u32 m0, s55, 8192
    ds_read_b64_tr_b16 v[190:191], v5 offset:12288
    v_mfma_f32_16x16x32_bf16 v[88:91], v[224:227], v[176:179], v[88:91]
    buffer_load_dwordx4 v122, s[20:23], s54 offen lds
    ds_read_b64_tr_b16 v[192:193], v6 offset:4096
    v_mfma_f32_16x16x32_bf16 v[92:95], v[224:227], v[180:183], v[92:95]
    ds_read_b64_tr_b16 v[194:195], v6 offset:5120
    v_mfma_f32_16x16x32_bf16 v[48:51], v[228:231], v[168:171], v[48:51]
    s_add_u32 m0, s55, 9216
    ds_read_b64_tr_b16 v[196:197], v6 offset:11264
    v_mfma_f32_16x16x32_bf16 v[52:55], v[228:231], v[172:175], v[52:55]
    buffer_load_dwordx4 v123, s[20:23], s54 offen lds
    ds_read_b64_tr_b16 v[198:199], v6 offset:12288
    v_mfma_f32_16x16x32_bf16 v[96:99], v[228:231], v[176:179], v[96:99]
    s_add_u32 s54, s54, 131072
    ds_read_b64_tr_b16 v[200:201], v5 offset:6144
    v_mfma_f32_16x16x32_bf16 v[100:103], v[228:231], v[180:183], v[100:103]
    ds_read_b64_tr_b16 v[202:203], v6 offset:6144
    v_mfma_f32_16x16x32_bf16 v[56:59], v[232:235], v[168:171], v[56:59]
    ds_read_b64_tr_b16 v[204:205], v5 offset:13312
    v_mfma_f32_16x16x32_bf16 v[60:63], v[232:235], v[172:175], v[60:63]
    ds_read_b64_tr_b16 v[206:207], v6 offset:13312
    v_mfma_f32_16x16x32_bf16 v[104:107], v[232:235], v[176:179], v[104:107]
    v_mfma_f32_16x16x32_bf16 v[108:111], v[232:235], v[180:183], v[108:111]
    v_mfma_f32_16x16x32_bf16 v[64:67], v[236:239], v[168:171], v[64:67]
    v_mfma_f32_16x16x32_bf16 v[68:71], v[236:239], v[172:175], v[68:71]
    v_mfma_f32_16x16x32_bf16 v[112:115], v[236:239], v[176:179], v[112:115]
    v_mfma_f32_16x16x32_bf16 v[116:119], v[236:239], v[180:183], v[116:119]
    s_waitcnt lgkmcnt(13)
    v_mfma_f32_16x16x32_bf16 v[24:27], v[184:187], v[152:155], v[24:27]
    s_add_u32 s60, s60, 30720
    s_cmp_ge_u32 s60, 153600
    s_cselect_b32 s60, 0, s60
pad13_2:
    s_cbranch_execz pad13_3
    v_add_u32 v4, s60, v7
    v_add_u32 v5, s60, v8
    v_xor_b32 v6, 32, v5
    s_waitcnt lgkmcnt(12)
    v_mfma_f32_16x16x32_bf16 v[28:31], v[184:187], v[156:159], v[28:31]
    s_waitcnt lgkmcnt(0)
    s_waitcnt vmcnt(4)
    s_barrier
    v_mfma_f32_16x16x32_bf16 v[72:75], v[184:187], v[160:163], v[72:75]
    ds_read_b128 v[168:171], v4 offset:0
    v_mfma_f32_16x16x32_bf16 v[76:79], v[184:187], v[164:167], v[76:79]
    s_add_u32 m0, s55, 16384
    ds_read_b64_tr_b16 v[216:217], v5 offset:4096
    v_mfma_f32_16x16x32_bf16 v[32:35], v[188:191], v[152:155], v[32:35]
    buffer_load_dwordx4 v120, s[20:23], s54 offen lds
    ds_read_b64_tr_b16 v[218:219], v5 offset:5120
    v_mfma_f32_16x16x32_bf16 v[36:39], v[188:191], v[156:159], v[36:39]
    ds_read_b128 v[172:175], v4 offset:256
    v_mfma_f32_16x16x32_bf16 v[80:83], v[188:191], v[160:163], v[80:83]
    s_add_u32 m0, s55, 17408
    ds_read_b128 v[176:179], v4 offset:2048
    v_mfma_f32_16x16x32_bf16 v[84:87], v[188:191], v[164:167], v[84:87]
    buffer_load_dwordx4 v121, s[20:23], s54 offen lds
    ds_read_b128 v[180:183], v4 offset:2304
    v_mfma_f32_16x16x32_bf16 v[40:43], v[192:195], v[152:155], v[40:43]
    ds_read_b64_tr_b16 v[220:221], v5 offset:11264
    v_mfma_f32_16x16x32_bf16 v[44:47], v[192:195], v[156:159], v[44:47]
    s_add_u32 m0, s55, 24576
    ds_read_b64_tr_b16 v[222:223], v5 offset:12288
    v_mfma_f32_16x16x32_bf16 v[88:91], v[192:195], v[160:163], v[88:91]
    buffer_load_dwordx4 v122, s[20:23], s54 offen lds
    ds_read_b64_tr_b16 v[224:225], v6 offset:4096
    v_mfma_f32_16x16x32_bf16 v[92:95], v[192:195], v[164:167], v[92:95]
    ds_read_b64_tr_b16 v[226:227], v6 offset:5120
    v_mfma_f32_16x16x32_bf16 v[48:51], v[196:199], v[152:155], v[48:51]
    s_add_u32 m0, s55, 25600
    ds_read_b64_tr_b16 v[228:229], v6 offset:11264
    v_mfma_f32_16x16x32_bf16 v[52:55], v[196:199], v[156:159], v[52:55]
    buffer_load_dwordx4 v123, s[20:23], s54 offen lds
    ds_read_b64_tr_b16 v[230:231], v6 offset:12288
    v_mfma_f32_16x16x32_bf16 v[96:99], v[196:199], v[160:163], v[96:99]
    s_add_u32 s54, s54, 131072
    ds_read_b64_tr_b16 v[232:233], v5 offset:6144
    v_mfma_f32_16x16x32_bf16 v[100:103], v[196:199], v[164:167], v[100:103]
    ds_read_b64_tr_b16 v[234:235], v6 offset:6144
    v_mfma_f32_16x16x32_bf16 v[56:59], v[200:203], v[152:155], v[56:59]
    ds_read_b64_tr_b16 v[236:237], v5 offset:13312
    v_mfma_f32_16x16x32_bf16 v[60:63], v[200:203], v[156:159], v[60:63]
    ds_read_b64_tr_b16 v[238:239], v6 offset:13312
    v_mfma_f32_16x16x32_bf16 v[104:107], v[200:203], v[160:163], v[104:107]
    v_mfma_f32_16x16x32_bf16 v[108:111], v[200:203], v[164:167], v[108:111]
    v_mfma_f32_16x16x32_bf16 v[64:67], v[204:207], v[152:155], v[64:67]
    v_mfma_f32_16x16x32_bf16 v[68:71], v[204:207], v[156:159], v[68:71]
    v_mfma_f32_16x16x32_bf16 v[112:115], v[204:207], v[160:163], v[112:115]
    v_mfma_f32_16x16x32_bf16 v[116:119], v[204:207], v[164:167], v[116:119]
    s_waitcnt lgkmcnt(13)
    v_mfma_f32_16x16x32_bf16 v[24:27], v[216:219], v[168:171], v[24:27]
    s_add_u32 s60, s60, 30720
    s_cmp_ge_u32 s60, 153600
    s_cselect_b32 s60, 0, s60
    v_add_u32 v4, s60, v7
    v_add_u32 v5, s60, v8
    v_xor_b32 v6, 32, v5
    s_waitcnt lgkmcnt(12)
    v_mfma_f32_16x16x32_bf16 v[28:31], v[216:219], v[172:175], v[28:31]
    s_waitcnt lgkmcnt(0)
    v_mfma_f32_16x16x32_bf16 v[72:75], v[216:219], v[176:179], v[72:75]
    ds_read_b128 v[152:155], v4 offset:0
    v_mfma_f32_16x16x32_bf16 v[76:79], v[216:219], v[180:183], v[76:79]
    s_add_u32 m0, s55, 32768
    ds_read_b64_tr_b16 v[184:185], v5 offset:4096
pad13_3:
    s_cbranch_execz wo_warm_ret2
    v_mfma_f32_16x16x32_bf16 v[32:35], v[220:223], v[168:171], v[32:35]
    buffer_load_dwordx4 v120, s[20:23], s54 offen lds
    ds_read_b64_tr_b16 v[186:187], v5 offset:5120
    v_mfma_f32_16x16x32_bf16 v[36:39], v[220:223], v[172:175], v[36:39]
    ds_read_b128 v[156:159], v4 offset:256
    v_mfma_f32_16x16x32_bf16 v[80:83], v[220:223], v[176:179], v[80:83]
    s_add_u32 m0, s55, 33792
    ds_read_b128 v[160:163], v4 offset:2048
    v_mfma_f32_16x16x32_bf16 v[84:87], v[220:223], v[180:183], v[84:87]
    buffer_load_dwordx4 v121, s[20:23], s54 offen lds
    ds_read_b128 v[164:167], v4 offset:2304
    v_mfma_f32_16x16x32_bf16 v[40:43], v[224:227], v[168:171], v[40:43]
    ds_read_b64_tr_b16 v[188:189], v5 offset:11264
    v_mfma_f32_16x16x32_bf16 v[44:47], v[224:227], v[172:175], v[44:47]
    s_add_u32 m0, s55, 40960
    ds_read_b64_tr_b16 v[190:191], v5 offset:12288
    v_mfma_f32_16x16x32_bf16 v[88:91], v[224:227], v[176:179], v[88:91]
    buffer_load_dwordx4 v122, s[20:23], s54 offen lds
    ds_read_b64_tr_b16 v[192:193], v6 offset:4096
    v_mfma_f32_16x16x32_bf16 v[92:95], v[224:227], v[180:183], v[92:95]
    ds_read_b64_tr_b16 v[194:195], v6 offset:5120
    v_mfma_f32_16x16x32_bf16 v[48:51], v[228:231], v[168:171], v[48:51]
    s_add_u32 m0, s55, 41984
    ds_read_b64_tr_b16 v[196:197], v6 offset:11264
    v_mfma_f32_16x16x32_bf16 v[52:55], v[228:231], v[172:175], v[52:55]
    buffer_load_dwordx4 v123, s[20:23], s54 offen lds
    ds_read_b64_tr_b16 v[198:199], v6 offset:12288
    v_mfma_f32_16x16x32_bf16 v[96:99], v[228:231], v[176:179], v[96:99]
    s_add_u32 s54, s54, 131072
    ds_read_b64_tr_b16 v[200:201], v5 offset:6144
    v_mfma_f32_16x16x32_bf16 v[100:103], v[228:231], v[180:183], v[100:103]
    ds_read_b64_tr_b16 v[202:203], v6 offset:6144
    v_mfma_f32_16x16x32_bf16 v[56:59], v[232:235], v[168:171], v[56:59]
    ds_read_b64_tr_b16 v[204:205], v5 offset:13312
    v_mfma_f32_16x16x32_bf16 v[60:63], v[232:235], v[172:175], v[60:63]
    ds_read_b64_tr_b16 v[206:207], v6 offset:13312
    v_mfma_f32_16x16x32_bf16 v[104:107], v[232:235], v[176:179], v[104:107]
    v_mfma_f32_16x16x32_bf16 v[108:111], v[232:235], v[180:183], v[108:111]
    v_mfma_f32_16x16x32_bf16 v[64:67], v[236:239], v[168:171], v[64:67]
    v_mfma_f32_16x16x32_bf16 v[68:71], v[236:239], v[172:175], v[68:71]
    v_mfma_f32_16x16x32_bf16 v[112:115], v[236:239], v[176:179], v[112:115]
    v_mfma_f32_16x16x32_bf16 v[116:119], v[236:239], v[180:183], v[116:119]
    s_waitcnt lgkmcnt(13)
    v_mfma_f32_16x16x32_bf16 v[24:27], v[184:187], v[152:155], v[24:27]
    s_add_u32 s60, s60, 30720
    s_cmp_ge_u32 s60, 153600
    s_cselect_b32 s60, 0, s60
    v_add_u32 v4, s60, v7
    v_add_u32 v5, s60, v8
    v_xor_b32 v6, 32, v5
    s_waitcnt lgkmcnt(12)
    v_mfma_f32_16x16x32_bf16 v[28:31], v[184:187], v[156:159], v[28:31]
    s_waitcnt lgkmcnt(0)
    v_mfma_f32_16x16x32_bf16 v[72:75], v[184:187], v[160:163], v[72:75]
    ds_read_b128 v[168:171], v4 offset:0
    v_mfma_f32_16x16x32_bf16 v[76:79], v[184:187], v[164:167], v[76:79]
    ds_read_b64_tr_b16 v[216:217], v5 offset:4096
    v_mfma_f32_16x16x32_bf16 v[32:35], v[188:191], v[152:155], v[32:35]
    ds_read_b64_tr_b16 v[218:219], v5 offset:5120
    v_mfma_f32_16x16x32_bf16 v[36:39], v[188:191], v[156:159], v[36:39]
    ds_read_b128 v[172:175], v4 offset:256
    v_mfma_f32_16x16x32_bf16 v[80:83], v[188:191], v[160:163], v[80:83]
    ds_read_b128 v[176:179], v4 offset:2048
    v_mfma_f32_16x16x32_bf16 v[84:87], v[188:191], v[164:167], v[84:87]
    ds_read_b128 v[180:183], v4 offset:2304
    v_mfma_f32_16x16x32_bf16 v[40:43], v[192:195], v[152:155], v[40:43]
    ds_read_b64_tr_b16 v[220:221], v5 offset:11264
padc14:
    s_cbranch_execz pad14_1
    v_mfma_f32_16x16x32_bf16 v[44:47], v[192:195], v[156:159], v[44:47]
    ds_read_b64_tr_b16 v[222:223], v5 offset:12288
    v_mfma_f32_16x16x32_bf16 v[88:91], v[192:195], v[160:163], v[88:91]
    ds_read_b64_tr_b16 v[224:225], v6 offset:4096
    v_mfma_f32_16x16x32_bf16 v[92:95], v[192:195], v[164:167], v[92:95]
    ds_read_b64_tr_b16 v[226:227], v6 offset:5120
    v_mfma_f32_16x16x32_bf16 v[48:51], v[196:199], v[152:155], v[48:51]
    ds_read_b64_tr_b16 v[228:229], v6 offset:11264
    v_mfma_f32_16x16x32_bf16 v[52:55], v[196:199], v[156:159], v[52:55]
    ds_read_b64_tr_b16 v[230:231], v6 offset:12288
    v_mfma_f32_16x16x32_bf16 v[96:99], v[196:199], v[160:163], v[96:99]
    ds_read_b64_tr_b16 v[232:233], v5 offset:6144
    v_mfma_f32_16x16x32_bf16 v[100:103], v[196:199], v[164:167], v[100:103]
    ds_read_b64_tr_b16 v[234:235], v6 offset:6144
    v_mfma_f32_16x16x32_bf16 v[56:59], v[200:203], v[152:155], v[56:59]
    ds_read_b64_tr_b16 v[236:237], v5 offset:13312
    v_mfma_f32_16x16x32_bf16 v[60:63], v[200:203], v[156:159], v[60:63]
    ds_read_b64_tr_b16 v[238:239], v6 offset:13312
    v_mfma_f32_16x16x32_bf16 v[104:107], v[200:203], v[160:163], v[104:107]
    v_mfma_f32_16x16x32_bf16 v[108:111], v[200:203], v[164:167], v[108:111]
    v_mfma_f32_16x16x32_bf16 v[64:67], v[204:207], v[152:155], v[64:67]
    v_mfma_f32_16x16x32_bf16 v[68:71], v[204:207], v[156:159], v[68:71]
    v_mfma_f32_16x16x32_bf16 v[112:115], v[204:207], v[160:163], v[112:115]
    v_mfma_f32_16x16x32_bf16 v[116:119], v[204:207], v[164:167], v[116:119]
    s_waitcnt lgkmcnt(13)
    v_mfma_f32_16x16x32_bf16 v[24:27], v[216:219], v[168:171], v[24:27]
    s_waitcnt lgkmcnt(12)
    v_mfma_f32_16x16x32_bf16 v[28:31], v[216:219], v[172:175], v[28:31]
    s_waitcnt lgkmcnt(11)
    v_mfma_f32_16x16x32_bf16 v[72:75], v[216:219], v[176:179], v[72:75]
    s_waitcnt lgkmcnt(10)
    v_mfma_f32_16x16x32_bf16 v[76:79], v[216:219], v[180:183], v[76:79]
    s_waitcnt lgkmcnt(8)
    v_mfma_f32_16x16x32_bf16 v[32:35], v[220:223], v[168:171], v[32:35]
    v_mfma_f32_16x16x32_bf16 v[36:39], v[220:223], v[172:175], v[36:39]
    v_mfma_f32_16x16x32_bf16 v[80:83], v[220:223], v[176:179], v[80:83]
    v_mfma_f32_16x16x32_bf16 v[84:87], v[220:223], v[180:183], v[84:87]
    s_waitcnt lgkmcnt(6)
    v_mfma_f32_16x16x32_bf16 v[40:43], v[224:227], v[168:171], v[40:43]
    v_mfma_f32_16x16x32_bf16 v[44:47], v[224:227], v[172:175], v[44:47]
    v_mfma_f32_16x16x32_bf16 v[88:91], v[224:227], v[176:179], v[88:91]
    v_mfma_f32_16x16x32_bf16 v[92:95], v[224:227], v[180:183], v[92:95]
    s_waitcnt lgkmcnt(4)
    v_mfma_f32_16x16x32_bf16 v[48:51], v[228:231], v[168:171], v[48:51]
    v_mfma_f32_16x16x32_bf16 v[52:55], v[228:231], v[172:175], v[52:55]
    v_mfma_f32_16x16x32_bf16 v[96:99], v[228:231], v[176:179], v[96:99]
    v_mfma_f32_16x16x32_bf16 v[100:103], v[228:231], v[180:183], v[100:103]
    s_waitcnt lgkmcnt(2)
    v_mfma_f32_16x16x32_bf16 v[56:59], v[232:235], v[168:171], v[56:59]
    v_mfma_f32_16x16x32_bf16 v[60:63], v[232:235], v[172:175], v[60:63]
    v_mfma_f32_16x16x32_bf16 v[104:107], v[232:235], v[176:179], v[104:107]
    v_mfma_f32_16x16x32_bf16 v[108:111], v[232:235], v[180:183], v[108:111]
    s_waitcnt lgkmcnt(0)
    v_mfma_f32_16x16x32_bf16 v[64:67], v[236:239], v[168:171], v[64:67]
    v_mfma_f32_16x16x32_bf16 v[68:71], v[236:239], v[172:175], v[68:71]
    v_mfma_f32_16x16x32_bf16 v[112:115], v[236:239], v[176:179], v[112:115]
    v_mfma_f32_16x16x32_bf16 v[116:119], v[236:239], v[180:183], v[116:119]
    s_add_u32 s8, s86, 0x1800000
    s_addc_u32 s9, s87, 0
    s_mov_b32 s10, 0xe00000
    s_mov_b32 s11, 0x00020000
    s_mul_i32 s37, s37, 224*1024
    s_add_u32 s44, s35, 64
    s_lshl_b32 s44, s44, 6
    s_add_u32 s44, s44, s37
    s_add_u32 s45, s44, 224*1024
    v_mul_f32 v152, v24, v16
    v_mul_f32 v153, v25, v16
    v_mul_f32 v154, v26, v16
    v_mul_f32 v155, v27, v16
    v_mul_f32 v156, v28, v18
    v_mul_f32 v157, v29, v18
    v_mul_f32 v158, v30, v18
pad14_1:
    s_cbranch_execz pad14_2
    v_mul_f32 v159, v31, v18
    v_exp_f32 v152, v152
    v_exp_f32 v153, v153
    v_exp_f32 v154, v154
    v_exp_f32 v155, v155
    v_exp_f32 v156, v156
    v_exp_f32 v157, v157
    v_exp_f32 v158, v158
    v_exp_f32 v159, v159
    v_mul_f32 v24, v24, v32
    v_mul_f32 v25, v25, v33
    v_mul_f32 v26, v26, v34
    v_mul_f32 v27, v27, v35
    v_mul_f32 v28, v28, v36
    v_mul_f32 v29, v29, v37
    v_mul_f32 v30, v30, v38
    v_mul_f32 v31, v31, v39
    v_fma_f32 v152, v152, v17, v17
    v_fma_f32 v153, v153, v17, v17
    v_fma_f32 v154, v154, v17, v17
    v_fma_f32 v155, v155, v17, v17
    v_fma_f32 v156, v156, v19, v19
    v_fma_f32 v157, v157, v19, v19
    v_fma_f32 v158, v158, v19, v19
    v_fma_f32 v159, v159, v19, v19
    v_rcp_f32 v152, v152
    v_rcp_f32 v153, v153
    v_rcp_f32 v154, v154
    v_rcp_f32 v155, v155
    v_rcp_f32 v156, v156
    v_rcp_f32 v157, v157
    v_rcp_f32 v158, v158
    v_rcp_f32 v159, v159
    v_mul_f32 v24, v24, v152
    v_mul_f32 v25, v25, v153
    v_mul_f32 v26, v26, v154
    v_mul_f32 v27, v27, v155
    v_mul_f32 v28, v28, v156
    v_mul_f32 v29, v29, v157
    v_mul_f32 v30, v30, v158
    v_mul_f32 v31, v31, v159
    v_cvt_pk_bf16_f32 v32, v24, v25
    v_cvt_pk_bf16_f32 v33, v26, v27
    v_cvt_pk_bf16_f32 v34, v28, v29
    v_cvt_pk_bf16_f32 v35, v30, v31
    s_nop 0
    v_permlane16_swap_b32 v32, v34
    v_permlane16_swap_b32 v33, v35
    buffer_store_dwordx4 v[32:35], v9, s[8:11], s44 offen sc1
    v_mul_f32 v152, v72, v20
    v_mul_f32 v153, v73, v20
    v_mul_f32 v154, v74, v20
    v_mul_f32 v155, v75, v20
    v_mul_f32 v156, v76, v22
    v_mul_f32 v157, v77, v22
    v_mul_f32 v158, v78, v22
    v_mul_f32 v159, v79, v22
    v_exp_f32 v152, v152
    v_exp_f32 v153, v153
    v_exp_f32 v154, v154
    v_exp_f32 v155, v155
    v_exp_f32 v156, v156
    v_exp_f32 v157, v157
    v_exp_f32 v158, v158
    v_exp_f32 v159, v159
    v_mul_f32 v72, v72, v80
    v_mul_f32 v73, v73, v81
    v_mul_f32 v74, v74, v82
    v_mul_f32 v75, v75, v83
    v_mul_f32 v76, v76, v84
    v_mul_f32 v77, v77, v85
    v_mul_f32 v78, v78, v86
    v_mul_f32 v79, v79, v87
    v_fma_f32 v152, v152, v21, v21
    v_fma_f32 v153, v153, v21, v21
    v_fma_f32 v154, v154, v21, v21
    v_fma_f32 v155, v155, v21, v21
    v_fma_f32 v156, v156, v23, v23
    v_fma_f32 v157, v157, v23, v23
    v_fma_f32 v158, v158, v23, v23
    v_fma_f32 v159, v159, v23, v23
    v_rcp_f32 v152, v152
    v_rcp_f32 v153, v153
    v_rcp_f32 v154, v154
    v_rcp_f32 v155, v155
    v_rcp_f32 v156, v156
    v_rcp_f32 v157, v157
    v_rcp_f32 v158, v158
    v_rcp_f32 v159, v159
    v_mul_f32 v72, v72, v152
    v_mul_f32 v73, v73, v153
    v_mul_f32 v74, v74, v154
    v_mul_f32 v75, v75, v155
    v_mul_f32 v76, v76, v156
    v_mul_f32 v77, v77, v157
    v_mul_f32 v78, v78, v158
    v_mul_f32 v79, v79, v159
    v_cvt_pk_bf16_f32 v80, v72, v73
    v_cvt_pk_bf16_f32 v81, v74, v75
    v_cvt_pk_bf16_f32 v82, v76, v77
    v_cvt_pk_bf16_f32 v83, v78, v79
    s_nop 0
pad14_2:
    s_cbranch_execz pad14_3
    v_permlane16_swap_b32 v80, v82
    v_permlane16_swap_b32 v81, v83
    buffer_store_dwordx4 v[80:83], v9, s[8:11], s45 offen sc1
    s_add_u32 s44, s35, 80
    s_lshl_b32 s44, s44, 6
    s_add_u32 s44, s44, s37
    s_add_u32 s45, s44, 224*1024
    v_mul_f32 v152, v40, v16
    v_mul_f32 v153, v41, v16
    v_mul_f32 v154, v42, v16
    v_mul_f32 v155, v43, v16
    v_mul_f32 v156, v44, v18
    v_mul_f32 v157, v45, v18
    v_mul_f32 v158, v46, v18
    v_mul_f32 v159, v47, v18
    v_exp_f32 v152, v152
    v_exp_f32 v153, v153
    v_exp_f32 v154, v154
    v_exp_f32 v155, v155
    v_exp_f32 v156, v156
    v_exp_f32 v157, v157
    v_exp_f32 v158, v158
    v_exp_f32 v159, v159
    v_mul_f32 v40, v40, v48
    v_mul_f32 v41, v41, v49
    v_mul_f32 v42, v42, v50
    v_mul_f32 v43, v43, v51
    v_mul_f32 v44, v44, v52
    v_mul_f32 v45, v45, v53
    v_mul_f32 v46, v46, v54
    v_mul_f32 v47, v47, v55
    v_fma_f32 v152, v152, v17, v17
    v_fma_f32 v153, v153, v17, v17
    v_fma_f32 v154, v154, v17, v17
    v_fma_f32 v155, v155, v17, v17
    v_fma_f32 v156, v156, v19, v19
    v_fma_f32 v157, v157, v19, v19
    v_fma_f32 v158, v158, v19, v19
    v_fma_f32 v159, v159, v19, v19
    v_rcp_f32 v152, v152
    v_rcp_f32 v153, v153
    v_rcp_f32 v154, v154
    v_rcp_f32 v155, v155
    v_rcp_f32 v156, v156
    v_rcp_f32 v157, v157
    v_rcp_f32 v158, v158
    v_rcp_f32 v159, v159
    v_mul_f32 v40, v40, v152
    v_mul_f32 v41, v41, v153
    v_mul_f32 v42, v42, v154
    v_mul_f32 v43, v43, v155
    v_mul_f32 v44, v44, v156
    v_mul_f32 v45, v45, v157
    v_mul_f32 v46, v46, v158
    v_mul_f32 v47, v47, v159
    v_cvt_pk_bf16_f32 v48, v40, v41
    v_cvt_pk_bf16_f32 v49, v42, v43
    v_cvt_pk_bf16_f32 v50, v44, v45
    v_cvt_pk_bf16_f32 v51, v46, v47
    s_nop 0
    v_permlane16_swap_b32 v48, v50
    v_permlane16_swap_b32 v49, v51
    buffer_store_dwordx4 v[48:51], v9, s[8:11], s44 offen sc1
    v_mul_f32 v152, v88, v20
    v_mul_f32 v153, v89, v20
    v_mul_f32 v154, v90, v20
    v_mul_f32 v155, v91, v20
    v_mul_f32 v156, v92, v22
    v_mul_f32 v157, v93, v22
    v_mul_f32 v158, v94, v22
    v_mul_f32 v159, v95, v22
    v_exp_f32 v152, v152
    v_exp_f32 v153, v153
    v_exp_f32 v154, v154
    v_exp_f32 v155, v155
    v_exp_f32 v156, v156
    v_exp_f32 v157, v157
    v_exp_f32 v158, v158
    v_exp_f32 v159, v159
    v_mul_f32 v88, v88, v96
    v_mul_f32 v89, v89, v97
    v_mul_f32 v90, v90, v98
    v_mul_f32 v91, v91, v99
    v_mul_f32 v92, v92, v100
    v_mul_f32 v93, v93, v101
    v_mul_f32 v94, v94, v102
    v_mul_f32 v95, v95, v103
    v_fma_f32 v152, v152, v21, v21
    v_fma_f32 v153, v153, v21, v21
    v_fma_f32 v154, v154, v21, v21
    v_fma_f32 v155, v155, v21, v21
    v_fma_f32 v156, v156, v23, v23
    v_fma_f32 v157, v157, v23, v23
    v_fma_f32 v158, v158, v23, v23
    v_fma_f32 v159, v159, v23, v23
    v_rcp_f32 v152, v152
    v_rcp_f32 v153, v153
    v_rcp_f32 v154, v154
    v_rcp_f32 v155, v155
    v_rcp_f32 v156, v156
    v_rcp_f32 v157, v157
    v_rcp_f32 v158, v158
    v_rcp_f32 v159, v159
pad14_3:
    s_cbranch_execz pad14_4
    v_mul_f32 v88, v88, v152
    v_mul_f32 v89, v89, v153
    v_mul_f32 v90, v90, v154
    v_mul_f32 v91, v91, v155
    v_mul_f32 v92, v92, v156
    v_mul_f32 v93, v93, v157
    v_mul_f32 v94, v94, v158
    v_mul_f32 v95, v95, v159
    v_cvt_pk_bf16_f32 v96, v88, v89
    v_cvt_pk_bf16_f32 v97, v90, v91
    v_cvt_pk_bf16_f32 v98, v92, v93
    v_cvt_pk_bf16_f32 v99, v94, v95
    s_nop 0
    v_permlane16_swap_b32 v96, v98
    v_permlane16_swap_b32 v97, v99
    buffer_store_dwordx4 v[96:99], v9, s[8:11], s45 offen sc1
    s_mov_b32 s44, s36
    s_lshl_b32 s44, s44, 6
    s_add_u32 s44, s44, s37
    s_add_u32 s45, s44, 224*1024
    v_mul_f32 v152, v56, v16
    v_mul_f32 v153, v57, v16
    v_mul_f32 v154, v58, v16
    v_mul_f32 v155, v59, v16
    v_mul_f32 v156, v60, v18
    v_mul_f32 v157, v61, v18
    v_mul_f32 v158, v62, v18
    v_mul_f32 v159, v63, v18
    v_exp_f32 v152, v152
    v_exp_f32 v153, v153
    v_exp_f32 v154, v154
    v_exp_f32 v155, v155
    v_exp_f32 v156, v156
    v_exp_f32 v157, v157
    v_exp_f32 v158, v158
    v_exp_f32 v159, v159
    v_mul_f32 v56, v56, v64
    v_mul_f32 v57, v57, v65
    v_mul_f32 v58, v58, v66
    v_mul_f32 v59, v59, v67
    v_mul_f32 v60, v60, v68
    v_mul_f32 v61, v61, v69
    v_mul_f32 v62, v62, v70
    v_mul_f32 v63, v63, v71
    v_fma_f32 v152, v152, v17, v17
    v_fma_f32 v153, v153, v17, v17
    v_fma_f32 v154, v154, v17, v17
    v_fma_f32 v155, v155, v17, v17
    v_fma_f32 v156, v156, v19, v19
    v_fma_f32 v157, v157, v19, v19
    v_fma_f32 v158, v158, v19, v19
    v_fma_f32 v159, v159, v19, v19
    v_rcp_f32 v152, v152
    v_rcp_f32 v153, v153
    v_rcp_f32 v154, v154
    v_rcp_f32 v155, v155
    v_rcp_f32 v156, v156
    v_rcp_f32 v157, v157
    v_rcp_f32 v158, v158
    v_rcp_f32 v159, v159
    v_mul_f32 v56, v56, v152
    v_mul_f32 v57, v57, v153
    v_mul_f32 v58, v58, v154
    v_mul_f32 v59, v59, v155
    v_mul_f32 v60, v60, v156
    v_mul_f32 v61, v61, v157
    v_mul_f32 v62, v62, v158
    v_mul_f32 v63, v63, v159
    v_cvt_pk_bf16_f32 v64, v56, v57
    v_cvt_pk_bf16_f32 v65, v58, v59
    v_cvt_pk_bf16_f32 v66, v60, v61
    v_cvt_pk_bf16_f32 v67, v62, v63
    s_nop 0
    v_permlane16_swap_b32 v64, v66
    v_permlane16_swap_b32 v65, v67
    buffer_store_dwordx4 v[64:67], v9, s[8:11], s44 offen sc1
    v_mul_f32 v152, v104, v20
    v_mul_f32 v153, v105, v20
    v_mul_f32 v154, v106, v20
    v_mul_f32 v155, v107, v20
    v_mul_f32 v156, v108, v22
    v_mul_f32 v157, v109, v22
    v_mul_f32 v158, v110, v22
    v_mul_f32 v159, v111, v22
    v_exp_f32 v152, v152
    v_exp_f32 v153, v153
    v_exp_f32 v154, v154
    v_exp_f32 v155, v155
    v_exp_f32 v156, v156
    v_exp_f32 v157, v157
    v_exp_f32 v158, v158
    v_exp_f32 v159, v159
    v_mul_f32 v104, v104, v112
    v_mul_f32 v105, v105, v113
    v_mul_f32 v106, v106, v114
    v_mul_f32 v107, v107, v115
    v_mul_f32 v108, v108, v116
    v_mul_f32 v109, v109, v117
    v_mul_f32 v110, v110, v118
    v_mul_f32 v111, v111, v119
    v_fma_f32 v152, v152, v21, v21
    v_fma_f32 v153, v153, v21, v21
    v_fma_f32 v154, v154, v21, v21
    v_fma_f32 v155, v155, v21, v21
pad14_4:
    s_cbranch_execz wo_warm_ret2
    v_fma_f32 v156, v156, v23, v23
    v_fma_f32 v157, v157, v23, v23
    v_fma_f32 v158, v158, v23, v23
    v_fma_f32 v159, v159, v23, v23
    v_rcp_f32 v152, v152
    v_rcp_f32 v153, v153
    v_rcp_f32 v154, v154
    v_rcp_f32 v155, v155
    v_rcp_f32 v156, v156
    v_rcp_f32 v157, v157
    v_rcp_f32 v158, v158
    v_rcp_f32 v159, v159
    v_mul_f32 v104, v104, v152
    v_mul_f32 v105, v105, v153
    v_mul_f32 v106, v106, v154
    v_mul_f32 v107, v107, v155
    v_mul_f32 v108, v108, v156
    v_mul_f32 v109, v109, v157
    v_mul_f32 v110, v110, v158
    v_mul_f32 v111, v111, v159
    v_cvt_pk_bf16_f32 v112, v104, v105
    v_cvt_pk_bf16_f32 v113, v106, v107
    v_cvt_pk_bf16_f32 v114, v108, v109
    v_cvt_pk_bf16_f32 v115, v110, v111
    s_nop 0
    v_permlane16_swap_b32 v112, v114
    v_permlane16_swap_b32 v113, v115
    buffer_store_dwordx4 v[112:115], v9, s[8:11], s45 offen sc1
    s_add_u32 s96, s86, 0x4400000
    s_addc_u32 s97, s87, 0
    s_mov_b32 s98, 0x8000
    s_mov_b32 s99, 0x00020000
    v_mov_b32 v1, 163592
    v_mov_b32 v2, 1
    v_mul_u32_u24 v3, 256, v0
    s_mov_b64 exec, 1
    s_waitcnt vmcnt(0)
    ds_add_rtn_u32 v1, v1, v2
    s_waitcnt lgkmcnt(0)
    v_readfirstlane_b32 s89, v1
    s_nop 0
    s_cmp_eq_u32 s89, 7
    s_cbranch_scc0 qkv_sg26
    s_mov_b32 exec_lo, 0xffff
    buffer_store_byte v2, v3, s[96:99], s88 offen sc1
qkv_sg26:
    s_mov_b64 exec, -1
    s_branch down_begin
down_begin:
padc15:
    s_cbranch_execz pad15_1
    s_mov_b64 exec, -1
    s_xor_b32 s3, s93, 4
    s_mov_b64 s[4:5], s[80:81]
    s_mov_b64 s[6:7], s[86:87]
    s_mov_b64 s[24:25], s[82:83]
    s_lshr_b32 s30, s90, 1
    s_lshl_b32 s30, s30, 2
    s_lshr_b32 s92, s91, 3
    s_add_u32 s30, s30, s92
    s_and_b32 s31, s91, 7
    s_lshl_b32 s28, s31, 1
    s_and_b32 s29, s90, 1
    s_lshl_b32 s26, s30, 4
    s_add_u32 s26, s26, s28
    s_add_u32 s26, s26, s29
    s_mul_i32 s28, s31, 2
    s_and_b32 s28, s28, 15
    s_add_u32 s27, s28, 1
    s_and_b32 s27, s27, 15
    s_waitcnt lgkmcnt(0)
    s_cmp_ge_u32 s3, 4
    s_cbranch_scc0 down_comp
    s_add_u32 s8, s6, 0x1800000
    s_addc_u32 s9, s7, 0
    s_mov_b32 s10, 0xe00000
    s_mov_b32 s11, 0x00020000
    s_mov_b32 s12, s4
    s_mov_b32 s13, s5
    s_mov_b32 s14, 0x700000
    s_mov_b32 s15, 0x00020000
    s_sub_u32 s3, s3, 4
    s_xor_b32 s32, s3, s29
    s_xor_b32 s32, s32, 1
    s_lshl_b32 s33, s30, 2
    s_add_u32 s32, s32, s33
    s_mul_i32 s32, s32, 229376
    s_mul_i32 s33, s29, 114688
    s_add_u32 s32, s32, s33
    v_lshlrev_b32 v1, 4, v0
    v_add_u32 v8, s32, v1
    v_add_u32 v9, 1024, v8
    v_add_u32 v10, 2048, v8
    v_add_u32 v11, 3072, v8
    v_lshrrev_b32 v3, 5, v0
    v_lshlrev_b32 v3, 2, v3
    v_bfe_u32 v4, v0, 2, 2
    v_add_u32 v3, v3, v4
    s_mov_b32 s92, 2048
    v_mul_lo_u32 v2, v3, s92
    v_bfe_u32 v3, v0, 4, 1
    v_lshlrev_b32 v3, 6, v3
    v_and_b32 v4, 3, v0
    v_lshlrev_b32 v4, 4, v4
    v_add3_u32 v2, v2, v3, v4
    s_lshl_b32 s33, s3, 15
    s_mul_i32 s34, s29, 3670016
    s_add_u32 s33, s33, s34
    s_lshl_b32 s34, s28, 7
    s_add_u32 s34, s34, s33
    s_lshl_b32 s35, s27, 7
    s_add_u32 s35, s35, s33
    v_add_u32 v12, s34, v2
    v_add_u32 v13, 8*2048, v12
    v_add_u32 v14, s35, v2
    v_add_u32 v15, 8*2048, v14
    s_mov_b32 s40, 0
    s_mov_b32 s41, 393216
    s_lshl_b32 s42, s3, 12
    s_lshl_b32 s43, s3, 11
    s_mov_b32 s62, 0
    s_mov_b32 s64, 16384
    s_mov_b32 s65, -65536
    s_barrier
    s_add_u32 m0, s42, 81920
    s_nop 0
    buffer_load_dwordx4 v8, s[8:11], s40 offen sc1 lds
    s_add_u32 m0, s42, 82944
    s_nop 0
    buffer_load_dwordx4 v9, s[8:11], s40 offen sc1 lds
    s_add_u32 m0, s42, 83968
    s_nop 0
    buffer_load_dwordx4 v10, s[8:11], s40 offen sc1 lds
    s_add_u32 m0, s42, 84992
    s_nop 0
    buffer_load_dwordx4 v11, s[8:11], s40 offen sc1 lds
    s_add_u32 s40, s40, 4096
    s_add_u32 m0, s42, 98304
    s_nop 0
    buffer_load_dwordx4 v8, s[8:11], s40 offen sc1 lds
    s_add_u32 m0, s42, 99328
    s_nop 0
    buffer_load_dwordx4 v9, s[8:11], s40 offen sc1 lds
pad15_1:
    s_cbranch_execz pad15_2
    s_add_u32 m0, s42, 100352
    s_nop 0
    buffer_load_dwordx4 v10, s[8:11], s40 offen sc1 lds
    s_add_u32 m0, s42, 101376
    s_nop 0
    buffer_load_dwordx4 v11, s[8:11], s40 offen sc1 lds
    s_add_u32 s40, s40, 4096
    s_waitcnt vmcnt(4)
    s_barrier
    s_add_u32 m0, s42, 114688
    s_nop 0
    buffer_load_dwordx4 v8, s[8:11], s40 offen sc1 lds
    s_add_u32 m0, s42, 115712
    s_nop 0
    buffer_load_dwordx4 v9, s[8:11], s40 offen sc1 lds
    s_add_u32 m0, s42, 116736
    s_nop 0
    buffer_load_dwordx4 v10, s[8:11], s40 offen sc1 lds
    s_add_u32 m0, s42, 117760
    s_nop 0
    buffer_load_dwordx4 v11, s[8:11], s40 offen sc1 lds
    s_add_u32 s40, s40, 4096
    s_add_u32 s42, s42, 49152
    s_add_u32 s43, s43, 49152
    s_mov_b32 s62, 3
    s_add_u32 m0, s42, 81920
    s_nop 0
    buffer_load_dwordx4 v8, s[8:11], s40 offen sc1 lds
    s_add_u32 m0, s42, 82944
    s_nop 0
    buffer_load_dwordx4 v9, s[8:11], s40 offen sc1 lds
    s_add_u32 m0, s42, 83968
    s_nop 0
    buffer_load_dwordx4 v10, s[8:11], s40 offen sc1 lds
    s_add_u32 m0, s42, 84992
    s_nop 0
    buffer_load_dwordx4 v11, s[8:11], s40 offen sc1 lds
    s_add_u32 m0, s43, 0
    s_nop 0
    buffer_load_dwordx4 v12, s[12:15], s41 offen lds
    s_add_u32 m0, s43, 1024
    s_nop 0
    buffer_load_dwordx4 v13, s[12:15], s41 offen lds
    s_add_u32 m0, s43, 8192
    s_nop 0
    buffer_load_dwordx4 v14, s[12:15], s41 offen lds
    s_add_u32 m0, s43, 9216
    s_nop 0
    buffer_load_dwordx4 v15, s[12:15], s41 offen lds
    s_add_u32 s40, s40, 4096
    s_add_u32 s41, s41, 131072
    s_add_u32 s62, s62, 1
    s_cmp_ge_u32 s62, 5
    s_cselect_b32 s62, 0, s62
    s_cselect_b32 s63, s65, s64
    s_add_u32 s42, s42, s63
    s_add_u32 s43, s43, s63
    s_waitcnt vmcnt(12)
    s_barrier
    s_add_u32 m0, s42, 81920
    s_nop 0
    buffer_load_dwordx4 v8, s[8:11], s40 offen sc1 lds
    s_add_u32 m0, s42, 82944
    s_nop 0
    buffer_load_dwordx4 v9, s[8:11], s40 offen sc1 lds
    s_add_u32 m0, s42, 83968
    s_nop 0
    buffer_load_dwordx4 v10, s[8:11], s40 offen sc1 lds
    s_add_u32 m0, s42, 84992
    s_nop 0
    buffer_load_dwordx4 v11, s[8:11], s40 offen sc1 lds
    s_add_u32 m0, s43, 0
    s_nop 0
    buffer_load_dwordx4 v12, s[12:15], s41 offen lds
    s_add_u32 m0, s43, 1024
    s_nop 0
    buffer_load_dwordx4 v13, s[12:15], s41 offen lds
    s_add_u32 m0, s43, 8192
    s_nop 0
    buffer_load_dwordx4 v14, s[12:15], s41 offen lds
    s_add_u32 m0, s43, 9216
pad15_2:
    s_cbranch_execz gu_warm_ret
    s_nop 0
    buffer_load_dwordx4 v15, s[12:15], s41 offen lds
    s_add_u32 s40, s40, 4096
    s_add_u32 s41, s41, 131072
    s_add_u32 s62, s62, 1
    s_cmp_ge_u32 s62, 5
    s_cselect_b32 s62, 0, s62
    s_cselect_b32 s63, s65, s64
    s_add_u32 s42, s42, s63
    s_add_u32 s43, s43, s63
    s_add_u32 m0, s42, 81920
    s_nop 0
    buffer_load_dwordx4 v8, s[8:11], s40 offen sc1 lds
    s_add_u32 m0, s42, 82944
    s_nop 0
    buffer_load_dwordx4 v9, s[8:11], s40 offen sc1 lds
    s_add_u32 m0, s42, 83968
    s_nop 0
    buffer_load_dwordx4 v10, s[8:11], s40 offen sc1 lds
    s_add_u32 m0, s42, 84992
    s_nop 0
    buffer_load_dwordx4 v11, s[8:11], s40 offen sc1 lds
    s_add_u32 m0, s43, 0
    s_nop 0
    buffer_load_dwordx4 v12, s[12:15], s41 offen lds
    s_add_u32 m0, s43, 1024
    s_nop 0
    buffer_load_dwordx4 v13, s[12:15], s41 offen lds
    s_add_u32 m0, s43, 8192
    s_nop 0
    buffer_load_dwordx4 v14, s[12:15], s41 offen lds
    s_add_u32 m0, s43, 9216
    s_nop 0
    buffer_load_dwordx4 v15, s[12:15], s41 offen lds
    s_add_u32 s40, s40, 4096
    s_add_u32 s41, s41, 131072
    s_add_u32 s62, s62, 1
    s_cmp_ge_u32 s62, 5
    s_cselect_b32 s62, 0, s62
    s_cselect_b32 s63, s65, s64
    s_add_u32 s42, s42, s63
    s_add_u32 s43, s43, s63
    s_waitcnt vmcnt(24)
    s_barrier
    s_mov_b32 s61, 22
qkv_ld27:
    s_add_u32 m0, s42, 81920
    s_nop 0
    buffer_load_dwordx4 v8, s[8:11], s40 offen sc1 lds
    s_add_u32 m0, s42, 82944
    s_nop 0
    buffer_load_dwordx4 v9, s[8:11], s40 offen sc1 lds
    s_add_u32 m0, s42, 83968
    s_nop 0
    buffer_load_dwordx4 v10, s[8:11], s40 offen sc1 lds
    s_add_u32 m0, s42, 84992
    s_nop 0
    buffer_load_dwordx4 v11, s[8:11], s40 offen sc1 lds
    s_add_u32 m0, s43, 0
    s_nop 0
    buffer_load_dwordx4 v12, s[12:15], s41 offen lds
    s_add_u32 m0, s43, 1024
    s_nop 0
    buffer_load_dwordx4 v13, s[12:15], s41 offen lds
    s_add_u32 m0, s43, 8192
    s_nop 0
    buffer_load_dwordx4 v14, s[12:15], s41 offen lds
    s_add_u32 m0, s43, 9216
    s_nop 0
    buffer_load_dwordx4 v15, s[12:15], s41 offen lds
    s_add_u32 s40, s40, 4096
    s_add_u32 s41, s41, 131072
    s_add_u32 s62, s62, 1
    s_cmp_ge_u32 s62, 5
    s_cselect_b32 s62, 0, s62
    s_cselect_b32 s63, s65, s64
    s_add_u32 s42, s42, s63
    s_add_u32 s43, s43, s63
    s_waitcnt vmcnt(24)
    s_barrier
    s_sub_u32 s61, s61, 1
    s_cmp_lg_u32 s61, 0
    s_cbranch_scc1 qkv_ld27
    s_waitcnt vmcnt(16)
    s_barrier
    s_waitcnt vmcnt(8)
    s_barrier
    s_waitcnt vmcnt(0)
    s_barrier
    s_endpgm
down_comp:
padc16:
    s_cbranch_execz pad16_1
    s_lshr_b32 s32, s3, 1
    s_and_b32 s33, s3, 1
    s_lshl_b32 s34, s30, 2
    s_lshl_b32 s35, s32, 1
    s_add_u32 s34, s34, s35
    s_add_u32 s34, s34, s29
    v_lshlrev_b32 v190, 4, v0
    s_cmp_eq_u32 s33, 0
    s_cselect_b32 s28, s28, s27
    s_lshl_b32 s35, s34, 6
    s_lshl_b32 s36, s28, 2
    s_add_u32 s35, s35, s36
    s_lshl_b32 s35, s35, 10
    s_add_u32 s12, s6, 0x2800000
    s_addc_u32 s13, s7, 0
    s_mov_b32 s14, 0x600000
    s_mov_b32 s15, 0x00020000
    s_add_u32 s35, s35, 2097152
    s_lshl_b32 s38, s34, 7
    s_add_u32 s38, s38, 131072
    v_and_b32 v184, 31, v0
    v_lshlrev_b32 v184, 2, v184
    s_mov_b32 s8, s24
    s_mov_b32 s9, s25
    s_mov_b32 s10, 0x400000
    s_mov_b32 s11, 0x00020000
    s_add_u32 s16, s6, 0x4000000
    s_addc_u32 s17, s7, 0
    s_mov_b32 s18, 0x400000
    s_mov_b32 s19, 0x00020000
    v_and_b32 v2, 31, v0
    v_lshlrev_b32 v2, 11, v2
    v_lshrrev_b32 v3, 5, v0
    v_lshlrev_b32 v3, 4, v3
    v_add_u32 v191, v2, v3
    s_lshl_b32 s34, s34, 16
    s_lshl_b32 s36, s28, 7
    s_add_u32 s34, s34, s36
    s_lshl_b32 s36, s26, 2
    s_add_u32 s36, s36, s3
    s_lshl_b32 s36, s36, 12
    s_xor_b32 s37, s36, 0x4000
    s_lshl_b32 s32, s32, 13
    s_add_u32 s32, s32, 81920
    v_add_u32 v188, s32, v190
    v_lshrrev_b32 v2, 5, v0
    v_mul_u32_u24 v189, 1024, v2
    v_bfe_u32 v2, v0, 2, 2
    v_lshlrev_b32 v2, 6, v2
    v_add_u32 v189, v189, v2
    v_bfe_u32 v2, v0, 4, 1
    v_mul_u32_u24 v2, 32, v2
    v_add_u32 v189, v189, v2
    v_and_b32 v2, 1, v0
    v_lshlrev_b32 v2, 4, v2
    v_bfe_u32 v3, v0, 1, 1
    v_lshlrev_b32 v3, 3, v3
    v_add3_u32 v189, v189, v2, v3
    s_lshl_b32 s33, s33, 13
    s_add_u32 s33, s33, 0
    v_add_u32 v189, s33, v189
    s_mov_b32 s60, 0
    v_add_u32 v186, s60, v188
    v_add_u32 v187, s60, v189
    v_mov_b32 v8, 0
    v_mov_b32 v9, 0
    v_mov_b32 v10, 0
    v_mov_b32 v11, 0
    v_mov_b32 v12, 0
    v_mov_b32 v13, 0
    v_mov_b32 v14, 0
    v_mov_b32 v15, 0
    v_mov_b32 v16, 0
    v_mov_b32 v17, 0
    v_mov_b32 v18, 0
    v_mov_b32 v19, 0
    v_mov_b32 v20, 0
    v_mov_b32 v21, 0
    v_mov_b32 v22, 0
    v_mov_b32 v23, 0
    v_mov_b32 v24, 0
    v_mov_b32 v25, 0
    v_mov_b32 v26, 0
    v_mov_b32 v27, 0
    v_mov_b32 v28, 0
    v_mov_b32 v29, 0
    v_mov_b32 v30, 0
    v_mov_b32 v31, 0
    v_mov_b32 v32, 0
    v_mov_b32 v33, 0
    v_mov_b32 v34, 0
    v_mov_b32 v35, 0
    v_mov_b32 v36, 0
    v_mov_b32 v37, 0
    v_mov_b32 v38, 0
    v_mov_b32 v39, 0
    v_mov_b32 v40, 0
    v_mov_b32 v41, 0
    v_mov_b32 v42, 0
    v_mov_b32 v43, 0
    v_mov_b32 v44, 0
    v_mov_b32 v45, 0
    v_mov_b32 v46, 0
    v_mov_b32 v47, 0
    v_mov_b32 v48, 0
    v_mov_b32 v49, 0
    v_mov_b32 v50, 0
    v_mov_b32 v51, 0
    v_mov_b32 v52, 0
    v_mov_b32 v53, 0
pad16_1:
    s_cbranch_execz pad16_2
    v_mov_b32 v54, 0
    v_mov_b32 v55, 0
    v_mov_b32 v56, 0
    v_mov_b32 v57, 0
    v_mov_b32 v58, 0
    v_mov_b32 v59, 0
    v_mov_b32 v60, 0
    v_mov_b32 v61, 0
    v_mov_b32 v62, 0
    v_mov_b32 v63, 0
    v_mov_b32 v64, 0
    v_mov_b32 v65, 0
    v_mov_b32 v66, 0
    v_mov_b32 v67, 0
    v_mov_b32 v68, 0
    v_mov_b32 v69, 0
    v_mov_b32 v70, 0
    v_mov_b32 v71, 0
    s_cmp_eq_u32 s3, 0
    s_cbranch_scc0 qkv_pl28
    s_lshl_b32 s58, s26, 7
    s_add_u32 s56, s86, s58
    s_addc_u32 s57, s87, 0
    s_add_u32 s56, s56, 0x4400040
    s_addc_u32 s57, s57, 0
    s_mov_b32 s58, 0x40000
qkv_pll29:
    s_load_dwordx4 s[48:51], s[56:57], 0 glc
    s_waitcnt lgkmcnt(0)
    s_and_b32 s48, s48, s49
    s_and_b32 s50, s50, s51
    s_and_b32 s48, s48, s50
    s_cmp_eq_u32 s48, 0x01010101
    s_cbranch_scc1 qkv_pl28x
    s_sub_u32 s58, s58, 1
    s_cbranch_scc0 qkv_pll29
qkv_pl28x:
qkv_pl28:
    s_barrier
    buffer_load_dwordx4 v[136:139], v190, s[12:15], s35 offen offset:0 sc1
    buffer_load_dwordx4 v[140:143], v190, s[12:15], s35 offen offset:1024 sc1
    buffer_load_dwordx4 v[144:147], v190, s[12:15], s35 offen offset:2048 sc1
    buffer_load_dwordx4 v[148:151], v190, s[12:15], s35 offen offset:3072 sc1
    buffer_load_dword v184, v184, s[12:15], s38 offen sc1
    s_waitcnt vmcnt(5)
    s_barrier
    ds_read_b128 v[72:75], v186 offset:0
    ds_read_b64_tr_b16 v[104:105], v187 offset:0
    ds_read_b64_tr_b16 v[106:107], v187 offset:512
    ds_read_b128 v[76:79], v186 offset:4096
    ds_read_b64_tr_b16 v[108:109], v187 offset:256
    ds_read_b64_tr_b16 v[110:111], v187 offset:768
    ds_read_b128 v[80:83], v186 offset:1024
    ds_read_b64_tr_b16 v[112:113], v187 offset:2048
    ds_read_b64_tr_b16 v[114:115], v187 offset:2560
    ds_read_b128 v[84:87], v186 offset:5120
    ds_read_b64_tr_b16 v[116:117], v187 offset:2304
    ds_read_b64_tr_b16 v[118:119], v187 offset:2816
    s_mov_b32 s61, 26
    .p2align 4
qkv_loop30:
    s_waitcnt lgkmcnt(9)
    v_mfma_f32_32x32x16_bf16 v[8:23], v[104:107], v[72:75], v[8:23]
    ds_read_b128 v[88:91], v186 offset:2048
    ds_read_b64_tr_b16 v[120:121], v187 offset:4096
    ds_read_b64_tr_b16 v[122:123], v187 offset:4608
    s_waitcnt lgkmcnt(11)
    v_mfma_f32_32x32x16_bf16 v[40:55], v[104:107], v[76:79], v[40:55]
    ds_read_b128 v[92:95], v186 offset:6144
    ds_read_b64_tr_b16 v[124:125], v187 offset:4352
    ds_read_b64_tr_b16 v[126:127], v187 offset:4864
    s_waitcnt lgkmcnt(12)
    v_mfma_f32_32x32x16_bf16 v[24:39], v[108:111], v[72:75], v[24:39]
    ds_read_b128 v[96:99], v186 offset:3072
    ds_read_b64_tr_b16 v[128:129], v187 offset:6144
    ds_read_b64_tr_b16 v[130:131], v187 offset:6656
    v_mfma_f32_32x32x16_bf16 v[56:71], v[108:111], v[76:79], v[56:71]
    ds_read_b128 v[100:103], v186 offset:7168
    ds_read_b64_tr_b16 v[132:133], v187 offset:6400
    ds_read_b64_tr_b16 v[134:135], v187 offset:6912
    s_waitcnt lgkmcnt(15)
    v_mfma_f32_32x32x16_bf16 v[8:23], v[112:115], v[80:83], v[8:23]
    s_add_u32 s60, s60, 16384
    s_cmp_ge_u32 s60, 81920
    s_cselect_b32 s60, 0, s60
    v_add_u32 v186, s60, v188
    v_add_u32 v187, s60, v189
    s_waitcnt lgkmcnt(14)
    v_mfma_f32_32x32x16_bf16 v[40:55], v[112:115], v[84:87], v[40:55]
    s_waitcnt lgkmcnt(12)
    v_mfma_f32_32x32x16_bf16 v[24:39], v[116:119], v[80:83], v[24:39]
    v_mfma_f32_32x32x16_bf16 v[56:71], v[116:119], v[84:87], v[56:71]
    s_waitcnt lgkmcnt(0)
    s_barrier
    v_mfma_f32_32x32x16_bf16 v[8:23], v[120:123], v[88:91], v[8:23]
    ds_read_b128 v[72:75], v186 offset:0
    ds_read_b64_tr_b16 v[104:105], v187 offset:0
    ds_read_b64_tr_b16 v[106:107], v187 offset:512
    v_mfma_f32_32x32x16_bf16 v[40:55], v[120:123], v[92:95], v[40:55]
    ds_read_b128 v[76:79], v186 offset:4096
    ds_read_b64_tr_b16 v[108:109], v187 offset:256
    ds_read_b64_tr_b16 v[110:111], v187 offset:768
    v_mfma_f32_32x32x16_bf16 v[24:39], v[124:127], v[88:91], v[24:39]
    ds_read_b128 v[80:83], v186 offset:1024
    ds_read_b64_tr_b16 v[112:113], v187 offset:2048
    ds_read_b64_tr_b16 v[114:115], v187 offset:2560
    v_mfma_f32_32x32x16_bf16 v[56:71], v[124:127], v[92:95], v[56:71]
    ds_read_b128 v[84:87], v186 offset:5120
    ds_read_b64_tr_b16 v[116:117], v187 offset:2304
    ds_read_b64_tr_b16 v[118:119], v187 offset:2816
    v_mfma_f32_32x32x16_bf16 v[8:23], v[128:131], v[96:99], v[8:23]
    v_mfma_f32_32x32x16_bf16 v[40:55], v[128:131], v[100:103], v[40:55]
    v_mfma_f32_32x32x16_bf16 v[24:39], v[132:135], v[96:99], v[24:39]
    v_mfma_f32_32x32x16_bf16 v[56:71], v[132:135], v[100:103], v[56:71]
    s_sub_u32 s61, s61, 1
    s_cmp_lg_u32 s61, 0
    s_cbranch_scc1 qkv_loop30
pad16_2:
    s_cbranch_execz gu_warm_ret
    buffer_load_dwordx4 v[152:155], v190, s[16:19], s37 offen offset:0 sc1
    buffer_load_dwordx4 v[156:159], v190, s[16:19], s37 offen offset:1024 sc1
    buffer_load_dwordx4 v[160:163], v190, s[16:19], s37 offen offset:2048 sc1
    buffer_load_dwordx4 v[164:167], v190, s[16:19], s37 offen offset:3072 sc1
    s_waitcnt lgkmcnt(9)
    v_mfma_f32_32x32x16_bf16 v[8:23], v[104:107], v[72:75], v[8:23]
    ds_read_b128 v[88:91], v186 offset:2048
    ds_read_b64_tr_b16 v[120:121], v187 offset:4096
    ds_read_b64_tr_b16 v[122:123], v187 offset:4608
    s_waitcnt lgkmcnt(11)
    v_mfma_f32_32x32x16_bf16 v[40:55], v[104:107], v[76:79], v[40:55]
    ds_read_b128 v[92:95], v186 offset:6144
    ds_read_b64_tr_b16 v[124:125], v187 offset:4352
    ds_read_b64_tr_b16 v[126:127], v187 offset:4864
    s_waitcnt lgkmcnt(12)
    v_mfma_f32_32x32x16_bf16 v[24:39], v[108:111], v[72:75], v[24:39]
    ds_read_b128 v[96:99], v186 offset:3072
    ds_read_b64_tr_b16 v[128:129], v187 offset:6144
    ds_read_b64_tr_b16 v[130:131], v187 offset:6656
    v_mfma_f32_32x32x16_bf16 v[56:71], v[108:111], v[76:79], v[56:71]
    ds_read_b128 v[100:103], v186 offset:7168
    ds_read_b64_tr_b16 v[132:133], v187 offset:6400
    ds_read_b64_tr_b16 v[134:135], v187 offset:6912
    s_waitcnt lgkmcnt(15)
    v_mfma_f32_32x32x16_bf16 v[8:23], v[112:115], v[80:83], v[8:23]
    s_add_u32 s60, s60, 16384
    s_cmp_ge_u32 s60, 81920
    s_cselect_b32 s60, 0, s60
    v_add_u32 v186, s60, v188
    v_add_u32 v187, s60, v189
    s_waitcnt lgkmcnt(14)
    v_mfma_f32_32x32x16_bf16 v[40:55], v[112:115], v[84:87], v[40:55]
    s_waitcnt lgkmcnt(12)
    v_mfma_f32_32x32x16_bf16 v[24:39], v[116:119], v[80:83], v[24:39]
    v_mfma_f32_32x32x16_bf16 v[56:71], v[116:119], v[84:87], v[56:71]
    s_waitcnt lgkmcnt(0)
    s_barrier
    v_mfma_f32_32x32x16_bf16 v[8:23], v[120:123], v[88:91], v[8:23]
    ds_read_b128 v[72:75], v186 offset:0
    ds_read_b64_tr_b16 v[104:105], v187 offset:0
    ds_read_b64_tr_b16 v[106:107], v187 offset:512
    v_mfma_f32_32x32x16_bf16 v[40:55], v[120:123], v[92:95], v[40:55]
    ds_read_b128 v[76:79], v186 offset:4096
    ds_read_b64_tr_b16 v[108:109], v187 offset:256
    ds_read_b64_tr_b16 v[110:111], v187 offset:768
    v_mfma_f32_32x32x16_bf16 v[24:39], v[124:127], v[88:91], v[24:39]
    ds_read_b128 v[80:83], v186 offset:1024
    ds_read_b64_tr_b16 v[112:113], v187 offset:2048
    ds_read_b64_tr_b16 v[114:115], v187 offset:2560
    v_mfma_f32_32x32x16_bf16 v[56:71], v[124:127], v[92:95], v[56:71]
    ds_read_b128 v[84:87], v186 offset:5120
    ds_read_b64_tr_b16 v[116:117], v187 offset:2304
    ds_read_b64_tr_b16 v[118:119], v187 offset:2816
    v_mfma_f32_32x32x16_bf16 v[8:23], v[128:131], v[96:99], v[8:23]
    v_mfma_f32_32x32x16_bf16 v[40:55], v[128:131], v[100:103], v[40:55]
    v_mfma_f32_32x32x16_bf16 v[24:39], v[132:135], v[96:99], v[24:39]
    v_mfma_f32_32x32x16_bf16 v[56:71], v[132:135], v[100:103], v[56:71]
    buffer_load_dwordx4 v[168:171], v190, s[16:19], s37 offen offset:0 sc1
    buffer_load_dwordx4 v[172:175], v190, s[16:19], s37 offen offset:1024 sc1
    buffer_load_dwordx4 v[176:179], v190, s[16:19], s37 offen offset:2048 sc1
    buffer_load_dwordx4 v[180:183], v190, s[16:19], s37 offen offset:3072 sc1
    s_waitcnt lgkmcnt(9)
    v_mfma_f32_32x32x16_bf16 v[8:23], v[104:107], v[72:75], v[8:23]
    ds_read_b128 v[88:91], v186 offset:2048
    ds_read_b64_tr_b16 v[120:121], v187 offset:4096
    ds_read_b64_tr_b16 v[122:123], v187 offset:4608
    ds_read_b64_tr_b16 v[124:125], v187 offset:4352
    s_waitcnt lgkmcnt(10)
    v_mfma_f32_32x32x16_bf16 v[24:39], v[108:111], v[72:75], v[24:39]
padc17:
    s_cbranch_execz pad17_1
    ds_read_b64_tr_b16 v[126:127], v187 offset:4864
    ds_read_b128 v[96:99], v186 offset:3072
    ds_read_b64_tr_b16 v[128:129], v187 offset:6144
    ds_read_b64_tr_b16 v[130:131], v187 offset:6656
    s_waitcnt lgkmcnt(11)
    v_mfma_f32_32x32x16_bf16 v[8:23], v[112:115], v[80:83], v[8:23]
    ds_read_b64_tr_b16 v[132:133], v187 offset:6400
    ds_read_b64_tr_b16 v[134:135], v187 offset:6912
    ds_read_b128 v[92:95], v186 offset:6144
    ds_read_b128 v[100:103], v186 offset:7168
    s_waitcnt lgkmcnt(12)
    v_mfma_f32_32x32x16_bf16 v[24:39], v[116:119], v[80:83], v[24:39]
    v_mfma_f32_32x32x16_bf16 v[40:55], v[104:107], v[76:79], v[40:55]
    v_mfma_f32_32x32x16_bf16 v[56:71], v[108:111], v[76:79], v[56:71]
    s_waitcnt lgkmcnt(9)
    v_mfma_f32_32x32x16_bf16 v[8:23], v[120:123], v[88:91], v[8:23]
    s_waitcnt lgkmcnt(7)
    v_mfma_f32_32x32x16_bf16 v[24:39], v[124:127], v[88:91], v[24:39]
    s_waitcnt lgkmcnt(4)
    v_mfma_f32_32x32x16_bf16 v[8:23], v[128:131], v[96:99], v[8:23]
    s_waitcnt lgkmcnt(2)
    v_mfma_f32_32x32x16_bf16 v[24:39], v[132:135], v[96:99], v[24:39]
    v_mfma_f32_32x32x16_bf16 v[40:55], v[112:115], v[84:87], v[40:55]
    v_mfma_f32_32x32x16_bf16 v[56:71], v[116:119], v[84:87], v[56:71]
    s_nop 7
    v_cvt_pk_bf16_f32 v8, v8, v9
    v_cvt_pk_bf16_f32 v9, v10, v11
    v_cvt_pk_bf16_f32 v10, v12, v13
    v_cvt_pk_bf16_f32 v11, v14, v15
    buffer_store_dwordx4 v[8:11], v190, s[16:19], s36 offen offset:0 sc1
    s_waitcnt lgkmcnt(1)
    v_mfma_f32_32x32x16_bf16 v[40:55], v[120:123], v[92:95], v[40:55]
    v_cvt_pk_bf16_f32 v12, v16, v17
    v_cvt_pk_bf16_f32 v13, v18, v19
    v_cvt_pk_bf16_f32 v14, v20, v21
    v_cvt_pk_bf16_f32 v15, v22, v23
    buffer_store_dwordx4 v[12:15], v190, s[16:19], s36 offen offset:1024 sc1
    v_mfma_f32_32x32x16_bf16 v[56:71], v[124:127], v[92:95], v[56:71]
    v_cvt_pk_bf16_f32 v16, v24, v25
    v_cvt_pk_bf16_f32 v17, v26, v27
    v_cvt_pk_bf16_f32 v18, v28, v29
    v_cvt_pk_bf16_f32 v19, v30, v31
    buffer_store_dwordx4 v[16:19], v190, s[16:19], s36 offen offset:2048 sc1
    s_waitcnt lgkmcnt(0)
    v_mfma_f32_32x32x16_bf16 v[40:55], v[128:131], v[100:103], v[40:55]
    v_cvt_pk_bf16_f32 v20, v32, v33
    v_cvt_pk_bf16_f32 v21, v34, v35
    v_cvt_pk_bf16_f32 v22, v36, v37
    v_cvt_pk_bf16_f32 v23, v38, v39
    buffer_store_dwordx4 v[20:23], v190, s[16:19], s36 offen offset:3072 sc1
    v_mfma_f32_32x32x16_bf16 v[56:71], v[132:135], v[100:103], v[56:71]
    s_mov_b32 s40, 0x40000
    s_waitcnt vmcnt(8)
    v_max3_u32 v2, v152, v153, v154
    v_max3_u32 v3, v155, v156, v157
    v_max3_u32 v2, v158, v159, v2
    v_max3_u32 v3, v160, v161, v3
    v_max3_u32 v2, v162, v163, v2
    v_max3_u32 v3, v164, v165, v3
    v_max3_u32 v2, v166, v167, v2
    v_max_u32 v2, v2, v3
    v_cmp_eq_u32 vcc, -1, v2
    s_cbranch_vccnz down_late
    v_lshlrev_b32 v72, 16, v136
    v_and_b32 v73, 0xffff0000, v136
    v_pk_add_f32 v[40:41], v[40:41], v[184:185] op_sel_hi:[1,0]
    v_pk_add_f32 v[40:41], v[40:41], v[72:73]
    v_lshlrev_b32 v74, 16, v137
    v_and_b32 v75, 0xffff0000, v137
    v_pk_add_f32 v[42:43], v[42:43], v[184:185] op_sel_hi:[1,0]
    v_pk_add_f32 v[42:43], v[42:43], v[74:75]
pad17_1:
    s_cbranch_execz pad17_2
    v_lshlrev_b32 v76, 16, v138
    v_and_b32 v77, 0xffff0000, v138
    v_pk_add_f32 v[44:45], v[44:45], v[184:185] op_sel_hi:[1,0]
    v_pk_add_f32 v[44:45], v[44:45], v[76:77]
    v_lshlrev_b32 v78, 16, v139
    v_and_b32 v79, 0xffff0000, v139
    v_pk_add_f32 v[46:47], v[46:47], v[184:185] op_sel_hi:[1,0]
    v_pk_add_f32 v[46:47], v[46:47], v[78:79]
    v_lshlrev_b32 v72, 16, v140
    v_and_b32 v73, 0xffff0000, v140
    v_pk_add_f32 v[48:49], v[48:49], v[184:185] op_sel_hi:[1,0]
    v_pk_add_f32 v[48:49], v[48:49], v[72:73]
    v_lshlrev_b32 v74, 16, v141
    v_and_b32 v75, 0xffff0000, v141
    v_pk_add_f32 v[50:51], v[50:51], v[184:185] op_sel_hi:[1,0]
    v_pk_add_f32 v[50:51], v[50:51], v[74:75]
    v_lshlrev_b32 v76, 16, v142
    v_and_b32 v77, 0xffff0000, v142
    v_pk_add_f32 v[52:53], v[52:53], v[184:185] op_sel_hi:[1,0]
    v_pk_add_f32 v[52:53], v[52:53], v[76:77]
    v_lshlrev_b32 v78, 16, v143
    v_and_b32 v79, 0xffff0000, v143
    v_pk_add_f32 v[54:55], v[54:55], v[184:185] op_sel_hi:[1,0]
    v_pk_add_f32 v[54:55], v[54:55], v[78:79]
    v_lshlrev_b32 v72, 16, v144
    v_and_b32 v73, 0xffff0000, v144
    v_pk_add_f32 v[56:57], v[56:57], v[184:185] op_sel_hi:[1,0]
    v_pk_add_f32 v[56:57], v[56:57], v[72:73]
    v_lshlrev_b32 v74, 16, v145
    v_and_b32 v75, 0xffff0000, v145
    v_pk_add_f32 v[58:59], v[58:59], v[184:185] op_sel_hi:[1,0]
    v_pk_add_f32 v[58:59], v[58:59], v[74:75]
    v_lshlrev_b32 v76, 16, v146
    v_and_b32 v77, 0xffff0000, v146
    v_pk_add_f32 v[60:61], v[60:61], v[184:185] op_sel_hi:[1,0]
    v_pk_add_f32 v[60:61], v[60:61], v[76:77]
    v_lshlrev_b32 v78, 16, v147
    v_and_b32 v79, 0xffff0000, v147
    v_pk_add_f32 v[62:63], v[62:63], v[184:185] op_sel_hi:[1,0]
    v_pk_add_f32 v[62:63], v[62:63], v[78:79]
    v_lshlrev_b32 v72, 16, v148
    v_and_b32 v73, 0xffff0000, v148
    v_pk_add_f32 v[64:65], v[64:65], v[184:185] op_sel_hi:[1,0]
    v_pk_add_f32 v[64:65], v[64:65], v[72:73]
    v_lshlrev_b32 v74, 16, v149
    v_and_b32 v75, 0xffff0000, v149
    v_pk_add_f32 v[66:67], v[66:67], v[184:185] op_sel_hi:[1,0]
    v_pk_add_f32 v[66:67], v[66:67], v[74:75]
    v_lshlrev_b32 v76, 16, v150
    v_and_b32 v77, 0xffff0000, v150
    v_pk_add_f32 v[68:69], v[68:69], v[184:185] op_sel_hi:[1,0]
    v_pk_add_f32 v[68:69], v[68:69], v[76:77]
    v_lshlrev_b32 v78, 16, v151
    v_and_b32 v79, 0xffff0000, v151
    v_pk_add_f32 v[70:71], v[70:71], v[184:185] op_sel_hi:[1,0]
    v_pk_add_f32 v[70:71], v[70:71], v[78:79]
    s_branch down_have
down_late:
    buffer_load_dwordx4 v[152:155], v190, s[16:19], s37 offen offset:0 sc1
    buffer_load_dwordx4 v[156:159], v190, s[16:19], s37 offen offset:1024 sc1
    buffer_load_dwordx4 v[160:163], v190, s[16:19], s37 offen offset:2048 sc1
    buffer_load_dwordx4 v[164:167], v190, s[16:19], s37 offen offset:3072 sc1
    v_lshlrev_b32 v72, 16, v136
    v_and_b32 v73, 0xffff0000, v136
    v_pk_add_f32 v[40:41], v[40:41], v[184:185] op_sel_hi:[1,0]
    v_pk_add_f32 v[40:41], v[40:41], v[72:73]
    v_lshlrev_b32 v74, 16, v137
    v_and_b32 v75, 0xffff0000, v137
    v_pk_add_f32 v[42:43], v[42:43], v[184:185] op_sel_hi:[1,0]
    v_pk_add_f32 v[42:43], v[42:43], v[74:75]
    v_lshlrev_b32 v76, 16, v138
    v_and_b32 v77, 0xffff0000, v138
    v_pk_add_f32 v[44:45], v[44:45], v[184:185] op_sel_hi:[1,0]
    v_pk_add_f32 v[44:45], v[44:45], v[76:77]
pad17_2:
    s_cbranch_execz gu_warm_ret
    v_lshlrev_b32 v78, 16, v139
    v_and_b32 v79, 0xffff0000, v139
    v_pk_add_f32 v[46:47], v[46:47], v[184:185] op_sel_hi:[1,0]
    v_pk_add_f32 v[46:47], v[46:47], v[78:79]
    v_lshlrev_b32 v72, 16, v140
    v_and_b32 v73, 0xffff0000, v140
    v_pk_add_f32 v[48:49], v[48:49], v[184:185] op_sel_hi:[1,0]
    v_pk_add_f32 v[48:49], v[48:49], v[72:73]
    v_lshlrev_b32 v74, 16, v141
    v_and_b32 v75, 0xffff0000, v141
    v_pk_add_f32 v[50:51], v[50:51], v[184:185] op_sel_hi:[1,0]
    v_pk_add_f32 v[50:51], v[50:51], v[74:75]
    v_lshlrev_b32 v76, 16, v142
    v_and_b32 v77, 0xffff0000, v142
    v_pk_add_f32 v[52:53], v[52:53], v[184:185] op_sel_hi:[1,0]
    v_pk_add_f32 v[52:53], v[52:53], v[76:77]
    v_lshlrev_b32 v78, 16, v143
    v_and_b32 v79, 0xffff0000, v143
    v_pk_add_f32 v[54:55], v[54:55], v[184:185] op_sel_hi:[1,0]
    v_pk_add_f32 v[54:55], v[54:55], v[78:79]
    v_lshlrev_b32 v72, 16, v144
    v_and_b32 v73, 0xffff0000, v144
    v_pk_add_f32 v[56:57], v[56:57], v[184:185] op_sel_hi:[1,0]
    v_pk_add_f32 v[56:57], v[56:57], v[72:73]
    v_lshlrev_b32 v74, 16, v145
    v_and_b32 v75, 0xffff0000, v145
    v_pk_add_f32 v[58:59], v[58:59], v[184:185] op_sel_hi:[1,0]
    v_pk_add_f32 v[58:59], v[58:59], v[74:75]
    v_lshlrev_b32 v76, 16, v146
    v_and_b32 v77, 0xffff0000, v146
    v_pk_add_f32 v[60:61], v[60:61], v[184:185] op_sel_hi:[1,0]
    v_pk_add_f32 v[60:61], v[60:61], v[76:77]
    v_lshlrev_b32 v78, 16, v147
    v_and_b32 v79, 0xffff0000, v147
    v_pk_add_f32 v[62:63], v[62:63], v[184:185] op_sel_hi:[1,0]
    v_pk_add_f32 v[62:63], v[62:63], v[78:79]
    v_lshlrev_b32 v72, 16, v148
    v_and_b32 v73, 0xffff0000, v148
    v_pk_add_f32 v[64:65], v[64:65], v[184:185] op_sel_hi:[1,0]
    v_pk_add_f32 v[64:65], v[64:65], v[72:73]
    v_lshlrev_b32 v74, 16, v149
    v_and_b32 v75, 0xffff0000, v149
    v_pk_add_f32 v[66:67], v[66:67], v[184:185] op_sel_hi:[1,0]
    v_pk_add_f32 v[66:67], v[66:67], v[74:75]
    v_lshlrev_b32 v76, 16, v150
    v_and_b32 v77, 0xffff0000, v150
    v_pk_add_f32 v[68:69], v[68:69], v[184:185] op_sel_hi:[1,0]
    v_pk_add_f32 v[68:69], v[68:69], v[76:77]
    v_lshlrev_b32 v78, 16, v151
    v_and_b32 v79, 0xffff0000, v151
    v_pk_add_f32 v[70:71], v[70:71], v[184:185] op_sel_hi:[1,0]
    v_pk_add_f32 v[70:71], v[70:71], v[78:79]
    s_waitcnt vmcnt(8)
    v_max3_u32 v2, v168, v169, v170
    v_max3_u32 v3, v171, v172, v173
    v_max3_u32 v2, v174, v175, v2
    v_max3_u32 v3, v176, v177, v3
    v_max3_u32 v2, v178, v179, v2
    v_max3_u32 v3, v180, v181, v3
    v_max3_u32 v2, v182, v183, v2
    v_max_u32 v2, v2, v3
    v_cmp_eq_u32 vcc, -1, v2
    s_cbranch_vccnz down_chk
    v_lshlrev_b32 v72, 16, v168
    v_and_b32 v73, 0xffff0000, v168
    v_pk_add_f32 v[40:41], v[40:41], v[72:73]
    v_cvt_pk_bf16_f32 v136, v40, v41
    v_lshlrev_b32 v74, 16, v169
    v_and_b32 v75, 0xffff0000, v169
    v_pk_add_f32 v[42:43], v[42:43], v[74:75]
    v_cvt_pk_bf16_f32 v137, v42, v43
    v_lshlrev_b32 v76, 16, v170
    v_and_b32 v77, 0xffff0000, v170
padc18:
    s_cbranch_execz pad18_1
    v_pk_add_f32 v[44:45], v[44:45], v[76:77]
    v_cvt_pk_bf16_f32 v138, v44, v45
    v_lshlrev_b32 v78, 16, v171
    v_and_b32 v79, 0xffff0000, v171
    v_pk_add_f32 v[46:47], v[46:47], v[78:79]
    v_cvt_pk_bf16_f32 v139, v46, v47
    buffer_store_dwordx4 v[136:139], v191, s[8:11], s34 offen offset:0
    v_lshlrev_b32 v72, 16, v172
    v_and_b32 v73, 0xffff0000, v172
    v_pk_add_f32 v[48:49], v[48:49], v[72:73]
    v_cvt_pk_bf16_f32 v140, v48, v49
    v_lshlrev_b32 v74, 16, v173
    v_and_b32 v75, 0xffff0000, v173
    v_pk_add_f32 v[50:51], v[50:51], v[74:75]
    v_cvt_pk_bf16_f32 v141, v50, v51
    v_lshlrev_b32 v76, 16, v174
    v_and_b32 v77, 0xffff0000, v174
    v_pk_add_f32 v[52:53], v[52:53], v[76:77]
    v_cvt_pk_bf16_f32 v142, v52, v53
    v_lshlrev_b32 v78, 16, v175
    v_and_b32 v79, 0xffff0000, v175
    v_pk_add_f32 v[54:55], v[54:55], v[78:79]
    v_cvt_pk_bf16_f32 v143, v54, v55
    buffer_store_dwordx4 v[140:143], v191, s[8:11], s34 offen offset:32
    v_lshlrev_b32 v72, 16, v176
    v_and_b32 v73, 0xffff0000, v176
    v_pk_add_f32 v[56:57], v[56:57], v[72:73]
    v_cvt_pk_bf16_f32 v144, v56, v57
    v_lshlrev_b32 v74, 16, v177
    v_and_b32 v75, 0xffff0000, v177
    v_pk_add_f32 v[58:59], v[58:59], v[74:75]
    v_cvt_pk_bf16_f32 v145, v58, v59
    v_lshlrev_b32 v76, 16, v178
    v_and_b32 v77, 0xffff0000, v178
    v_pk_add_f32 v[60:61], v[60:61], v[76:77]
    v_cvt_pk_bf16_f32 v146, v60, v61
    v_lshlrev_b32 v78, 16, v179
    v_and_b32 v79, 0xffff0000, v179
    v_pk_add_f32 v[62:63], v[62:63], v[78:79]
    v_cvt_pk_bf16_f32 v147, v62, v63
    buffer_store_dwordx4 v[144:147], v191, s[8:11], s34 offen offset:64
    v_lshlrev_b32 v72, 16, v180
    v_and_b32 v73, 0xffff0000, v180
    v_pk_add_f32 v[64:65], v[64:65], v[72:73]
    v_cvt_pk_bf16_f32 v148, v64, v65
    v_lshlrev_b32 v74, 16, v181
    v_and_b32 v75, 0xffff0000, v181
    v_pk_add_f32 v[66:67], v[66:67], v[74:75]
    v_cvt_pk_bf16_f32 v149, v66, v67
    v_lshlrev_b32 v76, 16, v182
    v_and_b32 v77, 0xffff0000, v182
    v_pk_add_f32 v[68:69], v[68:69], v[76:77]
    v_cvt_pk_bf16_f32 v150, v68, v69
    v_lshlrev_b32 v78, 16, v183
    v_and_b32 v79, 0xffff0000, v183
    v_pk_add_f32 v[70:71], v[70:71], v[78:79]
    v_cvt_pk_bf16_f32 v151, v70, v71
    buffer_store_dwordx4 v[148:151], v191, s[8:11], s34 offen offset:96
    s_branch down_done
down_poll:
    buffer_load_dwordx4 v[152:155], v190, s[16:19], s37 offen offset:0 sc1
    buffer_load_dwordx4 v[156:159], v190, s[16:19], s37 offen offset:1024 sc1
    buffer_load_dwordx4 v[160:163], v190, s[16:19], s37 offen offset:2048 sc1
    buffer_load_dwordx4 v[164:167], v190, s[16:19], s37 offen offset:3072 sc1
down_chk:
    s_waitcnt vmcnt(0)
    v_max3_u32 v2, v152, v153, v154
    v_max3_u32 v3, v155, v156, v157
    v_max3_u32 v2, v158, v159, v2
    v_max3_u32 v3, v160, v161, v3
    v_max3_u32 v2, v162, v163, v2
    v_max3_u32 v3, v164, v165, v3
    v_max3_u32 v2, v166, v167, v2
pad18_1:
    s_cbranch_execz pad18_2
    v_max_u32 v2, v2, v3
    v_cmp_eq_u32 vcc, -1, v2
    s_sub_u32 s40, s40, 1
    s_cselect_b64 vcc, 0, vcc
    s_nop 0
    s_cbranch_vccnz down_poll
down_have:
    v_lshlrev_b32 v72, 16, v152
    v_and_b32 v73, 0xffff0000, v152
    v_pk_add_f32 v[40:41], v[40:41], v[72:73]
    v_cvt_pk_bf16_f32 v136, v40, v41
    v_lshlrev_b32 v74, 16, v153
    v_and_b32 v75, 0xffff0000, v153
    v_pk_add_f32 v[42:43], v[42:43], v[74:75]
    v_cvt_pk_bf16_f32 v137, v42, v43
    v_lshlrev_b32 v76, 16, v154
    v_and_b32 v77, 0xffff0000, v154
    v_pk_add_f32 v[44:45], v[44:45], v[76:77]
    v_cvt_pk_bf16_f32 v138, v44, v45
    v_lshlrev_b32 v78, 16, v155
    v_and_b32 v79, 0xffff0000, v155
    v_pk_add_f32 v[46:47], v[46:47], v[78:79]
    v_cvt_pk_bf16_f32 v139, v46, v47
    buffer_store_dwordx4 v[136:139], v191, s[8:11], s34 offen offset:0
    v_lshlrev_b32 v72, 16, v156
    v_and_b32 v73, 0xffff0000, v156
    v_pk_add_f32 v[48:49], v[48:49], v[72:73]
    v_cvt_pk_bf16_f32 v140, v48, v49
    v_lshlrev_b32 v74, 16, v157
    v_and_b32 v75, 0xffff0000, v157
    v_pk_add_f32 v[50:51], v[50:51], v[74:75]
    v_cvt_pk_bf16_f32 v141, v50, v51
    v_lshlrev_b32 v76, 16, v158
    v_and_b32 v77, 0xffff0000, v158
    v_pk_add_f32 v[52:53], v[52:53], v[76:77]
    v_cvt_pk_bf16_f32 v142, v52, v53
    v_lshlrev_b32 v78, 16, v159
    v_and_b32 v79, 0xffff0000, v159
    v_pk_add_f32 v[54:55], v[54:55], v[78:79]
    v_cvt_pk_bf16_f32 v143, v54, v55
    buffer_store_dwordx4 v[140:143], v191, s[8:11], s34 offen offset:32
    v_lshlrev_b32 v72, 16, v160
    v_and_b32 v73, 0xffff0000, v160
    v_pk_add_f32 v[56:57], v[56:57], v[72:73]
    v_cvt_pk_bf16_f32 v144, v56, v57
    v_lshlrev_b32 v74, 16, v161
    v_and_b32 v75, 0xffff0000, v161
    v_pk_add_f32 v[58:59], v[58:59], v[74:75]
    v_cvt_pk_bf16_f32 v145, v58, v59
    v_lshlrev_b32 v76, 16, v162
    v_and_b32 v77, 0xffff0000, v162
    v_pk_add_f32 v[60:61], v[60:61], v[76:77]
    v_cvt_pk_bf16_f32 v146, v60, v61
    v_lshlrev_b32 v78, 16, v163
    v_and_b32 v79, 0xffff0000, v163
    v_pk_add_f32 v[62:63], v[62:63], v[78:79]
    v_cvt_pk_bf16_f32 v147, v62, v63
    buffer_store_dwordx4 v[144:147], v191, s[8:11], s34 offen offset:64
    v_lshlrev_b32 v72, 16, v164
    v_and_b32 v73, 0xffff0000, v164
    v_pk_add_f32 v[64:65], v[64:65], v[72:73]
    v_cvt_pk_bf16_f32 v148, v64, v65
    v_lshlrev_b32 v74, 16, v165
    v_and_b32 v75, 0xffff0000, v165
    v_pk_add_f32 v[66:67], v[66:67], v[74:75]
    v_cvt_pk_bf16_f32 v149, v66, v67
    v_lshlrev_b32 v76, 16, v166
    v_and_b32 v77, 0xffff0000, v166
    v_pk_add_f32 v[68:69], v[68:69], v[76:77]
    v_cvt_pk_bf16_f32 v150, v68, v69
    v_lshlrev_b32 v78, 16, v167
    v_and_b32 v79, 0xffff0000, v167
    v_pk_add_f32 v[70:71], v[70:71], v[78:79]
    v_cvt_pk_bf16_f32 v151, v70, v71
    buffer_store_dwordx4 v[148:151], v191, s[8:11], s34 offen offset:96
down_done:
    s_endpgm
qkv_kernel_end:
pad18_2:
    s_cbranch_execz gu_warm_ret
    s_endpgm
code_end:
.section .rodata,"a"
.p2align 6
.amdhsa_kernel qkv_kernel
  .amdhsa_next_free_vgpr 248
  .amdhsa_next_free_sgpr 102
  .amdhsa_accum_offset 248
  .amdhsa_group_segment_fixed_size 0
  .amdhsa_kernarg_size 80
  .amdhsa_user_sgpr_count 2
  .amdhsa_user_sgpr_kernarg_segment_ptr 1
  .amdhsa_system_sgpr_workgroup_id_x 1
.end_amdhsa_kernel
```
